```python
import torch

def _softmax(x, axis=-1):
    return torch.softmax(x, dim=axis)
def _gelu(x):
    return torch.nn.functional.gelu(x, approximate="tanh")
def _silu(x):
    return torch.nn.functional.silu(x)
def _sigmoid(x):
    return torch.sigmoid(x)
def _layernorm(x, axis=-1, eps=1e-5):
    m = x.mean(dim=axis, keepdim=True)
    v = x.var(dim=axis, keepdim=True, unbiased=False)
    return (x - m) / torch.sqrt(v + eps)
def _scatter_add(tgt, idx, src, axis=0):
    return tgt.clone().index_add_(axis, idx, src)
def _segment_sum(src, seg, n):
    out = torch.zeros((n,) + src.shape[1:], dtype=src.dtype)
    return out.index_add_(0, seg, src)
def _pad(x, pw):
    flat = tuple(v for pair in reversed(pw) for v in pair)
    return torch.nn.functional.pad(x, flat)

kernel_name = 'interleave_layers__spectral_fnet__dense_activation_squared_relu__prompt'

def setup_inputs():

    _w = (lambda a: (lambda t: t.to(torch.bfloat16) if t.is_floating_point() else t)(torch.as_tensor(a)))
    def _A_setup():
        B, S, D = 1, 2048, 640
        ns = torch.arange(S)[:, None] * torch.arange(S)[None, :]
        nd = torch.arange(D)[:, None] * torch.arange(D)[None, :]
        Ws_re = torch.cos(-2.0 * torch.pi * ns / S).to(float)
        Ws_im = torch.sin(-2.0 * torch.pi * ns / S).to(float)
        Wd_re = torch.cos(-2.0 * torch.pi * nd / D).to(float)
        Wd_im = torch.sin(-2.0 * torch.pi * nd / D).to(float)
        return {
            "x": _w((lambda *s: torch.randn(*s, dtype=torch.bfloat16) * 0.05)(B, S, D)),
            "dft_seq_re": _w(Ws_re),
            "dft_seq_im": _w(Ws_im),
            "dft_hid_re": _w(Wd_re),
            "dft_hid_im": _w(Wd_im),
        }
    _A_in = _A_setup()

    def _B_setup():
        B, S, D, F = 1, 2048, 640, 1728
        return {
            "x": _w((lambda *s: torch.randn(*s, dtype=torch.bfloat16) * 0.05)(B, S, D)),
            "w1": _w((lambda *s: torch.randn(*s, dtype=torch.bfloat16) * 0.4)(D, F)),
            "b1": _w((lambda *s: torch.randn(*s, dtype=torch.bfloat16) * 0.4)(F)),
            "w2": _w((lambda *s: torch.randn(*s, dtype=torch.bfloat16) * 0.4)(F, D)),
            "b2": _w((lambda *s: torch.randn(*s, dtype=torch.bfloat16) * 0.4)(D)),
        }
    _B_in = _B_setup()

    return {
        "A_x": _A_in["x"],
        "A_dft_seq_re": _A_in["dft_seq_re"],
        "A_dft_seq_im": _A_in["dft_seq_im"],
        "A_dft_hid_re": _A_in["dft_hid_re"],
        "A_dft_hid_im": _A_in["dft_hid_im"],
        "B_x": _B_in["x"],
        "B_w1": _B_in["w1"],
        "B_b1": _B_in["b1"],
        "B_w2": _B_in["w2"],
        "B_b2": _B_in["b2"],
    }

def reference(A_x, A_dft_seq_re, A_dft_seq_im, A_dft_hid_re, A_dft_hid_im, B_x, B_w1, B_b1, B_w2, B_b2):
    def _A_ref(x, dft_seq_re, dft_seq_im, dft_hid_re, dft_hid_im):
        a = torch.einsum("bsd,ed->bse", x, dft_hid_re)
        b = torch.einsum("bsd,ed->bse", x, dft_hid_im)
        y = torch.einsum("ts,bse->bte", dft_seq_re, a) - torch.einsum("ts,bse->bte", dft_seq_im, b)
        return y

    def _B_ref(x, w1, b1, w2, b2):
        h = torch.einsum("bsd,df->bsf", x, w1) + b1
        zero = torch.zeros_like(h)
        r = torch.where(h > zero, h, zero)
        h = r * r
        out = torch.einsum("bsf,fd->bsd", h, w2) + b2
        return out

    x = A_x
    x = x + _A_ref(_layernorm(x, axis=-1), A_dft_seq_re, A_dft_seq_im, A_dft_hid_re, A_dft_hid_im)
    x = x + _B_ref(_layernorm(x, axis=-1), B_w1, B_b1, B_w2, B_b2)
    x = x + _A_ref(_layernorm(x, axis=-1), A_dft_seq_re, A_dft_seq_im, A_dft_hid_re, A_dft_hid_im)
    x = x + _B_ref(_layernorm(x, axis=-1), B_w1, B_b1, B_w2, B_b2)
    return x
```

```asm
; @launch grid=(256,1,1) block=(256,1,1) lds=163840
.amdgcn_target "amdgcn-amd-amdhsa--gfx950"
.text
.globl interleave_layers__spectral_fnet__dense_activation_squared_relu__prompt_kernel
.p2align 8
.type interleave_layers__spectral_fnet__dense_activation_squared_relu__prompt_kernel,@function
interleave_layers__spectral_fnet__dense_activation_squared_relu__prompt_kernel:
    s_cmp_ge_u32 s2, 256
    s_cbranch_scc1 L_end
    s_load_dwordx16 s[52:67], s[0:1], 0
    s_load_dwordx8 s[68:75], s[0:1], 64
    s_load_dwordx2 s[76:77], s[0:1], 96
    v_lshrrev_b32 v14, 6, v0
    v_and_b32 v0, 63, v0
    v_readfirstlane_b32 s4, v14
    v_and_b32 v1, 15, v0
    v_lshrrev_b32 v2, 4, v0
    v_lshlrev_b32 v3, 4, v0
    v_mov_b32 v19, 0
    s_getpc_b64 s[96:97]
L_pc:
    s_lshr_b32 s3, s2, 3
    s_lshl_b32 s3, s3, 2
    s_add_u32 s3, s3, s4
    s_mul_i32 s3, s3, 4
    v_add_lshl_u32 v14, v0, s3, 7
    v_min_u32 v14, L_tab_end-4-L_pc, v14
    v_mov_b32 v15, s97
    v_add_co_u32 v14, vcc, s96, v14
    s_nop 1
    v_addc_co_u32 v15, vcc, 0, v15, vcc
    s_mov_b64 exec, 15
    global_load_dword v231, v[14:15], off
    s_mov_b64 exec, -1
    s_and_b32 s3, s2, 7
    s_lshr_b32 s6, s2, 3
    s_lshr_b32 s5, s6, 3
    s_lshl_b32 s3, s3, 2
    s_add_u32 s5, s5, s3
    s_and_b32 s6, s6, 7
    s_and_b32 s7, s5, 1
    s_lshl_b32 s7, s7, 3
    s_add_u32 s7, s7, s6
    s_lshr_b32 s79, s5, 1
    s_lshl_b32 s78, s5, 2
    s_add_u32 s78, s78, s4
    s_lshl_b32 s89, s79, 2
    s_add_u32 s89, s89, s4
    s_lshl_b32 s89, s89, 1
    s_mul_i32 s80, s7, 112
    s_cmp_gt_u32 s7, 10
    s_cselect_b32 s3, 16, 0
    s_sub_u32 s80, s80, s3
    s_cmp_gt_u32 s7, 11
    s_cselect_b32 s3, 16, 0
    s_sub_u32 s80, s80, s3
    s_cmp_gt_u32 s7, 14
    s_cselect_b32 s3, 16, 0
    s_sub_u32 s80, s80, s3
    s_and_b32 s3, s7, 10
    s_cmp_eq_u32 s3, 10
    s_cselect_b32 s86, 117440512, 0
    s_lshr_b32 s3, s4, 1
    s_lshl_b32 s3, s3, 5
    s_add_u32 s87, s5, s3
    s_sub_u32 s88, 64, s87
    s_and_b32 s88, s88, 63
    s_and_b32 s3, s4, 1
    s_lshl_b32 s3, s3, 10
    s_add_u32 s81, s87, s3
    s_mul_i32 s90, s4, 14
    s_cmp_ge_u32 s4, 3
    s_cselect_b32 s3, 1, 0
    s_sub_u32 s90, s90, s3
    s_mov_b32 s82, 200000
    s_lshl_b32 s3, s6, 2
    s_add_u32 s83, s3, s4
    s_lshl_b32 s83, s83, 2
    s_lshr_b32 s98, s5, 3
    s_add_u32 s83, s83, s98
    s_lshl_b32 s83, s83, 5
    s_and_b32 s98, s5, 7
    s_add_u32 s83, s83, s98
    s_lshl_b32 s83, s83, 2
    s_lshl_b32 s84, s78, 5
    s_add_u32 s84, s84, s3
    s_lshl_b32 s85, s79, 2
    s_add_u32 s85, s85, s4
    s_lshl_b32 s85, s85, 4
    s_add_u32 s85, s85, s7
    s_lshl_b32 s85, s85, 2
    s_waitcnt lgkmcnt(0)
    s_mov_b32 s12, s52
    s_and_b32 s13, s53, 0xffff
    s_mov_b32 s14, 2621440
    s_mov_b32 s15, 0x00020000
    s_mov_b32 s8, s76
    s_and_b32 s9, s77, 0xffff
    s_mov_b32 s10, 67108864
    s_mov_b32 s11, 0x00020000
    s_cmp_lt_u32 s2, 16
    s_cselect_b32 s98, 3, 4
    s_cmp_eq_u32 s4, s98
    s_cbranch_scc0 L_interleave_layers__spectral_fnet__dense_activation_squared_relu__prompt_kernel_third_1
    v_mov_b32 v104, 0
    v_mov_b32 v105, 0
    v_mov_b32 v106, 0
    v_mov_b32 v107, 0
    s_lshl_b32 s3, s2, 12
    buffer_store_dwordx4 v[104:107], v3, s[8:11], s3 offen offset:0 sc1
    buffer_store_dwordx4 v[104:107], v3, s[8:11], s3 offen offset:1024 sc1
    buffer_store_dwordx4 v[104:107], v3, s[8:11], s3 offen offset:2048 sc1
    buffer_store_dwordx4 v[104:107], v3, s[8:11], s3 offen offset:3072 sc1
L_interleave_layers__spectral_fnet__dense_activation_squared_relu__prompt_kernel_third_1:
    s_mov_b32 s16, s58
    s_and_b32 s17, s59, 0xffff
    s_mov_b32 s18, 819200
    s_mov_b32 s19, 0x00020000
    s_mov_b32 s20, s60
    s_and_b32 s21, s61, 0xffff
    s_mov_b32 s22, 819200
    s_mov_b32 s23, 0x00020000
    v_cmp_lt_u32 vcc, 9, v0
    s_nop 1
    v_cndmask_b32 v14, 0, 1, vcc
    s_lshl_b32 s3, s6, 2
    s_add_u32 s3, s3, s4
    s_lshl_b32 s3, s3, 1
    v_add_u32 v15, s3, v14
    v_mul_u32_u24 v14, 10, v14
    v_sub_u32 v14, v0, v14
    v_lshl_add_u32 v15, v15, 5, s5
    v_mul_u32_u24 v15, 10, v15
    v_add_lshl_u32 v15, v15, v14, 7
    s_mov_b64 exec, 0xfffff
    buffer_load_dword v231, v15, s[12:15], 0 offen
    s_mov_b64 exec, -1
    s_lshr_b32 s3, s2, 3
    s_lshl_b32 s3, s3, 2
    s_add_u32 s3, s3, s4
    s_mul_i32 s3, s3, 13
    v_add_u32 v14, s3, v0
    v_mul_u32_u24 v15, 13108, v14
    v_lshrrev_b32 v15, 16, v15
    v_mad_u32_u24 v15, v15, 5, v14
    v_lshlrev_b32 v15, 7, v15
    s_mov_b64 exec, 0x1fff
    buffer_load_dword v231, v15, s[16:19], 0 offen
    buffer_load_dword v231, v15, s[20:23], 0 offen
    s_mov_b64 exec, -1
    s_getpc_b64 s[96:97]
L_pcs:
    s_lshl_b32 s3, s6, 8
    s_add_u32 s3, s3, L_cs-L_pcs
    v_lshl_add_u32 v14, v1, 4, s3
    v_mov_b32 v15, s97
    v_add_co_u32 v14, vcc, s96, v14
    s_nop 1
    v_addc_co_u32 v15, vcc, 0, v15, vcc
    global_load_dwordx4 a[0:3], v[14:15], off
    s_cmp_eq_u32 s4, 0
    s_cselect_b32 s48, s16, s20
    s_cselect_b32 s49, s17, s21
    s_mov_b32 s50, 819200
    s_mov_b32 s51, 0x00020000
    s_mov_b32 s24, s64
    s_and_b32 s25, s65, 0xffff
    s_mov_b32 s26, 2211840
    s_mov_b32 s27, 0x00020000
    s_mov_b32 s32, s66
    s_and_b32 s33, s67, 0xffff
    s_mov_b32 s34, 3456
    s_mov_b32 s35, 0x00020000
    s_mov_b32 s28, s68
    s_and_b32 s29, s69, 0xffff
    s_mov_b32 s30, 2211840
    s_mov_b32 s31, 0x00020000
    s_mov_b32 s36, s70
    s_and_b32 s37, s71, 0xffff
    s_mov_b32 s38, 1280
    s_mov_b32 s39, 0x00020000
    s_mov_b32 s40, s72
    s_and_b32 s41, s73, 0xffff
    s_mov_b32 s42, 2621440
    s_mov_b32 s43, 0x00020000
    s_mov_b32 s44, s74
    s_and_b32 s45, s75, 0xffff
    s_mov_b32 s46, 256
    s_mov_b32 s47, 0x00020000
    v_add_u32 v14, 0, v0
    v_mul_u32_u24 v15, 205, v14
    v_lshrrev_b32 v15, 14, v15
    v_mul_u32_u24 v16, 80, v15
    v_sub_u32 v14, v14, v16
    v_xor_b32 v14, v14, v15
    v_mul_u32_u24 v15, 5120, v15
    v_add_lshl_u32 v100, v14, v15, 4
    v_add_u32 v14, 64, v0
    v_mul_u32_u24 v15, 205, v14
    v_lshrrev_b32 v15, 14, v15
    v_mul_u32_u24 v16, 80, v15
    v_sub_u32 v14, v14, v16
    v_xor_b32 v14, v14, v15
    v_mul_u32_u24 v15, 5120, v15
    v_add_lshl_u32 v101, v14, v15, 4
    v_add_u32 v14, 128, v0
    v_mul_u32_u24 v15, 205, v14
    v_lshrrev_b32 v15, 14, v15
    v_mul_u32_u24 v16, 80, v15
    v_sub_u32 v14, v14, v16
    v_xor_b32 v14, v14, v15
    v_mul_u32_u24 v15, 5120, v15
    v_add_lshl_u32 v102, v14, v15, 4
    v_add_u32 v14, 192, v0
    v_mul_u32_u24 v15, 205, v14
    v_lshrrev_b32 v15, 14, v15
    v_mul_u32_u24 v16, 80, v15
    v_sub_u32 v14, v14, v16
    v_xor_b32 v14, v14, v15
    v_mul_u32_u24 v15, 5120, v15
    v_add_lshl_u32 v103, v14, v15, 4
    v_add_u32 v14, 256, v0
    v_mul_u32_u24 v15, 205, v14
    v_lshrrev_b32 v15, 14, v15
    v_mul_u32_u24 v16, 80, v15
    v_sub_u32 v14, v14, v16
    v_xor_b32 v14, v14, v15
    v_mul_u32_u24 v15, 5120, v15
    v_add_lshl_u32 v104, v14, v15, 4
    s_and_b32 s52, s4, 1
    s_lshl_b32 s52, s52, 2
    v_add_u32 v14, 0, v0
    v_mul_u32_u24 v15, 205, v14
    v_lshrrev_b32 v15, 13, v15
    v_mul_u32_u24 v16, 40, v15
    v_sub_u32 v14, v14, v16
    v_lshrrev_b32 v16, 1, v15
    v_add_u32 v16, s52, v16
    v_xor_b32 v14, v14, v16
    v_mul_u32_u24 v15, 80, v15
    v_add_lshl_u32 v105, v14, v15, 4
    v_add_u32 v14, 64, v0
    v_mul_u32_u24 v15, 205, v14
    v_lshrrev_b32 v15, 13, v15
    v_mul_u32_u24 v16, 40, v15
    v_sub_u32 v14, v14, v16
    v_lshrrev_b32 v16, 1, v15
    v_add_u32 v16, s52, v16
    v_xor_b32 v14, v14, v16
    v_mul_u32_u24 v15, 80, v15
    v_add_lshl_u32 v106, v14, v15, 4
    v_add_u32 v14, 128, v0
    v_mul_u32_u24 v15, 205, v14
    v_lshrrev_b32 v15, 13, v15
    v_mul_u32_u24 v16, 40, v15
    v_sub_u32 v14, v14, v16
    v_lshrrev_b32 v16, 1, v15
    v_add_u32 v16, s52, v16
    v_xor_b32 v14, v14, v16
    v_mul_u32_u24 v15, 80, v15
    v_add_lshl_u32 v107, v14, v15, 4
    v_add_u32 v14, 192, v0
    v_mul_u32_u24 v15, 205, v14
    v_lshrrev_b32 v15, 13, v15
    v_mul_u32_u24 v16, 40, v15
    v_sub_u32 v14, v14, v16
    v_lshrrev_b32 v16, 1, v15
    v_add_u32 v16, s52, v16
    v_xor_b32 v14, v14, v16
    v_mul_u32_u24 v15, 80, v15
    v_add_lshl_u32 v108, v14, v15, 4
    v_add_u32 v14, 256, v0
    v_mul_u32_u24 v15, 205, v14
    v_lshrrev_b32 v15, 13, v15
    v_mul_u32_u24 v16, 40, v15
    v_sub_u32 v14, v14, v16
    v_lshrrev_b32 v16, 1, v15
    v_add_u32 v16, s52, v16
    v_xor_b32 v14, v14, v16
    v_mul_u32_u24 v15, 80, v15
    v_add_lshl_u32 v109, v14, v15, 4
    s_or_b32 s53, s4, s6
    s_cmp_eq_u32 s53, 0
    s_cselect_b32 s53, 409600, 0
    v_cmp_gt_u32 vcc, 40, v0
    v_mov_b32 v15, s53
    s_nop 0
    v_cndmask_b32 v15, 0, v15, vcc
    v_add_u32 v110, v15, v105
    s_lshl_b32 s99, s4, 8
    s_add_u32 s99, s99, s2
    s_and_b32 s60, s4, 1
    s_mul_i32 s60, s60, 20480
    s_lshr_b32 s61, s4, 1
    s_lshl_b32 s61, s61, 12
    s_add_u32 s60, s60, s61
    s_add_u32 s60, s60, 133120
    v_mov_b32 v232, 0
    v_mov_b32 v233, 0
    v_mov_b32 v234, 0
    v_mov_b32 v248, 0
    v_mov_b32 v249, 0
    v_mov_b32 v250, 0
    v_mov_b32 v251, 0
    s_cmp_lt_u32 s99, 540
    s_cbranch_scc0 L_interleave_layers__spectral_fnet__dense_activation_squared_relu__prompt_kernel_third_2
    s_mul_i32 s53, s99, 2428
    s_lshr_b32 s53, s53, 16
    s_mul_i32 s54, s53, 27
    s_sub_u32 s54, s99, s54
    s_mul_i32 s70, s53, 27
    s_add_u32 s70, s70, s54
    s_lshl_b32 s70, s70, 8
    s_add_u32 s70, s70, 524288
    v_lshrrev_b32 v14, 2, v0
    v_and_b32 v15, 3, v0
    v_lshlrev_b32 v15, 3, v15
    v_lshl_add_u32 v14, v14, 7, v15
    v_add_u32 v248, s60, v14
    v_lshlrev_b32 v249, 4, v2
    v_lshl_add_u32 v249, v1, 6, v249
    v_mov_b32 v14, 0x3f803f80
    v_cmp_eq_u32 vcc, 0, v1
    s_nop 1
    v_cndmask_b32 v82, 0, v14, vcc
    v_cndmask_b32 v83, 0, v14, vcc
    v_cndmask_b32 v84, 0, v14, vcc
    v_cndmask_b32 v85, 0, v14, vcc
    v_cmp_eq_u32 vcc, 1, v1
    s_nop 1
    v_cndmask_b32 v86, 0, v14, vcc
    v_cndmask_b32 v87, 0, v14, vcc
    v_cndmask_b32 v88, 0, v14, vcc
    v_cndmask_b32 v89, 0, v14, vcc
    v_cmp_eq_u32 vcc, 2, v1
    s_nop 1
    v_cndmask_b32 v90, 0, v14, vcc
    v_cndmask_b32 v91, 0, v14, vcc
    v_cndmask_b32 v92, 0, v14, vcc
    v_cndmask_b32 v93, 0, v14, vcc
    v_cmp_eq_u32 vcc, 3, v1
    s_nop 1
    v_cndmask_b32 v94, 0, v14, vcc
    v_cndmask_b32 v95, 0, v14, vcc
    v_cndmask_b32 v96, 0, v14, vcc
    v_cndmask_b32 v97, 0, v14, vcc
    s_lshl_b32 s55, s54, 2
    s_add_u32 s55, s55, 0
    s_mul_i32 s56, s55, 9363
    s_lshr_b32 s56, s56, 16
    s_mul_i32 s57, s56, 7
    s_cmp_ge_u32 s55, 70
    s_cselect_b32 s56, 10, s56
    s_cselect_b32 s57, 70, s57
    s_cmp_ge_u32 s55, 76
    s_cselect_b32 s56, 11, s56
    s_cselect_b32 s57, 76, s57
    s_cmp_ge_u32 s55, 82
    s_cselect_b32 s56, 12, s56
    s_cselect_b32 s57, 82, s57
    s_cmp_ge_u32 s55, 89
    s_cselect_b32 s56, 13, s56
    s_cselect_b32 s57, 89, s57
    s_cmp_ge_u32 s55, 96
    s_cselect_b32 s56, 14, s56
    s_cselect_b32 s57, 96, s57
    s_cmp_ge_u32 s55, 102
    s_cselect_b32 s56, 15, s56
    s_cselect_b32 s57, 102, s57
    s_sub_u32 s55, s55, s57
    s_mul_i32 s56, s56, 20
    s_add_u32 s56, s56, s53
    s_mul_i32 s56, s56, 7
    s_add_u32 s55, s55, s56
    s_lshl_b32 s55, s55, 10
    s_add_u32 s71, s55, 37748736
    s_lshl_b32 s55, s54, 2
    s_add_u32 s55, s55, 1
    s_mul_i32 s56, s55, 9363
    s_lshr_b32 s56, s56, 16
    s_mul_i32 s57, s56, 7
    s_cmp_ge_u32 s55, 70
    s_cselect_b32 s56, 10, s56
    s_cselect_b32 s57, 70, s57
    s_cmp_ge_u32 s55, 76
    s_cselect_b32 s56, 11, s56
    s_cselect_b32 s57, 76, s57
    s_cmp_ge_u32 s55, 82
    s_cselect_b32 s56, 12, s56
    s_cselect_b32 s57, 82, s57
    s_cmp_ge_u32 s55, 89
    s_cselect_b32 s56, 13, s56
    s_cselect_b32 s57, 89, s57
    s_cmp_ge_u32 s55, 96
    s_cselect_b32 s56, 14, s56
    s_cselect_b32 s57, 96, s57
    s_cmp_ge_u32 s55, 102
    s_cselect_b32 s56, 15, s56
    s_cselect_b32 s57, 102, s57
    s_sub_u32 s55, s55, s57
    s_mul_i32 s56, s56, 20
    s_add_u32 s56, s56, s53
    s_mul_i32 s56, s56, 7
    s_add_u32 s55, s55, s56
    s_lshl_b32 s55, s55, 10
    s_add_u32 s72, s55, 37748736
    s_lshl_b32 s55, s54, 2
    s_add_u32 s55, s55, 2
    s_mul_i32 s56, s55, 9363
    s_lshr_b32 s56, s56, 16
    s_mul_i32 s57, s56, 7
    s_cmp_ge_u32 s55, 70
    s_cselect_b32 s56, 10, s56
    s_cselect_b32 s57, 70, s57
    s_cmp_ge_u32 s55, 76
    s_cselect_b32 s56, 11, s56
    s_cselect_b32 s57, 76, s57
    s_cmp_ge_u32 s55, 82
    s_cselect_b32 s56, 12, s56
    s_cselect_b32 s57, 82, s57
    s_cmp_ge_u32 s55, 89
    s_cselect_b32 s56, 13, s56
    s_cselect_b32 s57, 89, s57
    s_cmp_ge_u32 s55, 96
    s_cselect_b32 s56, 14, s56
    s_cselect_b32 s57, 96, s57
    s_cmp_ge_u32 s55, 102
    s_cselect_b32 s56, 15, s56
    s_cselect_b32 s57, 102, s57
    s_sub_u32 s55, s55, s57
    s_mul_i32 s56, s56, 20
    s_add_u32 s56, s56, s53
    s_mul_i32 s56, s56, 7
    s_add_u32 s55, s55, s56
    s_lshl_b32 s55, s55, 10
    s_add_u32 s73, s55, 37748736
    s_lshl_b32 s55, s54, 2
    s_add_u32 s55, s55, 3
    s_mul_i32 s56, s55, 9363
    s_lshr_b32 s56, s56, 16
    s_mul_i32 s57, s56, 7
    s_cmp_ge_u32 s55, 70
    s_cselect_b32 s56, 10, s56
    s_cselect_b32 s57, 70, s57
    s_cmp_ge_u32 s55, 76
    s_cselect_b32 s56, 11, s56
    s_cselect_b32 s57, 76, s57
    s_cmp_ge_u32 s55, 82
    s_cselect_b32 s56, 12, s56
    s_cselect_b32 s57, 82, s57
    s_cmp_ge_u32 s55, 89
    s_cselect_b32 s56, 13, s56
    s_cselect_b32 s57, 89, s57
    s_cmp_ge_u32 s55, 96
    s_cselect_b32 s56, 14, s56
    s_cselect_b32 s57, 96, s57
    s_cmp_ge_u32 s55, 102
    s_cselect_b32 s56, 15, s56
    s_cselect_b32 s57, 102, s57
    s_sub_u32 s55, s55, s57
    s_mul_i32 s56, s56, 20
    s_add_u32 s56, s56, s53
    s_mul_i32 s56, s56, 7
    s_add_u32 s55, s55, s56
    s_lshl_b32 s55, s55, 10
    s_add_u32 s74, s55, 37748736
    s_and_b32 s55, s54, 1
    s_lshl_b32 s56, s54, 1
    s_and_b32 s56, s56, 4
    s_add_u32 s55, s55, s56
    s_add_u32 s55, s55, 10
    s_mul_i32 s55, s55, 20
    s_add_u32 s55, s55, s53
    s_mul_i32 s55, s55, 7168
    s_add_u32 s55, s55, 37754880
    s_cmp_lt_u32 s54, 4
    s_cselect_b32 s75, s55, 117440512
    v_lshrrev_b32 v14, 5, v0
    v_bfe_u32 v15, v0, 3, 2
    v_lshl_add_u32 v14, v14, 3, v15
    v_sub_u32 v15, 11, v14
    s_lshl_b32 s55, s53, 5
    s_sub_u32 s56, 949, s55
    s_cmp_eq_u32 s53, 10
    s_cselect_b32 s57, 1105920, 0
    s_cmp_ge_u32 s53, 10
    s_cselect_b32 s55, s56, s55
    s_cselect_b64 s[58:59], -1, 0
    s_mov_b32 s56, 3456
    s_cselect_b32 s56, 4294963840, s56
    v_cndmask_b32 v14, v14, v15, s[58:59]
    v_mul_u32_u24 v14, 216, v14
    v_and_b32 v15, 7, v0
    v_add_lshl_u32 v14, v14, v15, 4
    s_mul_i32 s55, s55, 3456
    s_lshl_b32 s54, s54, 7
    s_add_u32 s55, s55, s54
    v_mov_b32 v15, s57
    v_cmp_lt_u32 vcc, 7, v0
    s_nop 1
    v_cndmask_b32 v15, 0, v15, vcc
    v_add_u32 v232, v15, v14
    v_mov_b32 v233, v14
    s_sub_u32 s64, s55, s57
    s_mul_i32 s57, s56, 16
    s_add_u32 s65, s57, s55
    s_mul_i32 s57, s56, 4
    s_add_u32 s66, s57, s55
    s_mul_i32 s57, s56, 20
    s_add_u32 s67, s57, s55
L_interleave_layers__spectral_fnet__dense_activation_squared_relu__prompt_kernel_third_2:
    s_cmp_ge_u32 s99, 540
    s_cbranch_scc0 L_interleave_layers__spectral_fnet__dense_activation_squared_relu__prompt_kernel_third_3
    s_sub_u32 s62, s99, 540
    s_min_u32 s62, s62, 431
    s_and_b32 s53, s62, 1
    s_lshr_b32 s54, s62, 1
    s_mul_i32 s64, s54, 10240
    s_add_u32 s65, s64, 5120
    s_mul_i32 s61, s53, 216
    s_lshr_b32 s55, s54, 2
    s_add_u32 s61, s61, s55
    s_mul_i32 s61, s61, 5120
    s_and_b32 s55, s54, 3
    s_lshl_b32 s55, s55, 8
    s_add_u32 s61, s61, s55
    s_add_u32 s61, s61, 1048576
    s_mul_i32 s63, s53, 320
    s_sub_u32 s55, 640, s63
    s_cmp_eq_u32 s53, 0
    s_mov_b32 s56, 960
    s_cselect_b32 s56, 640, s56
    v_add_u32 v14, 0, v0
    v_mul_u32_u24 v15, 1366, v14
    v_lshrrev_b32 v15, 16, v15
    v_mul_u32_u24 v16, 48, v15
    v_sub_u32 v14, v14, v16
    v_mov_b32 v16, s55
    v_mov_b32 v17, s63
    v_cmp_gt_u32 vcc, 20, v14
    s_nop 1
    v_cndmask_b32 v16, v16, v17, vcc
    v_lshl_add_u32 v16, v14, 4, v16
    v_mov_b32 v17, s56
    v_cmp_lt_u32 vcc, 39, v14
    s_nop 1
    v_cndmask_b32 v16, v16, v17, vcc
    v_mul_u32_u24 v15, 1280, v15
    v_add_u32 v232, v15, v16
    v_add_u32 v14, 64, v0
    v_mul_u32_u24 v15, 1366, v14
    v_lshrrev_b32 v15, 16, v15
    v_mul_u32_u24 v16, 48, v15
    v_sub_u32 v14, v14, v16
    v_mov_b32 v16, s55
    v_mov_b32 v17, s63
    v_cmp_gt_u32 vcc, 20, v14
    s_nop 1
    v_cndmask_b32 v16, v16, v17, vcc
    v_lshl_add_u32 v16, v14, 4, v16
    v_mov_b32 v17, s56
    v_cmp_lt_u32 vcc, 39, v14
    s_nop 1
    v_cndmask_b32 v16, v16, v17, vcc
    v_mul_u32_u24 v15, 1280, v15
    v_add_u32 v233, v15, v16
    v_add_u32 v14, 128, v0
    v_mul_u32_u24 v15, 1366, v14
    v_lshrrev_b32 v15, 16, v15
    v_mul_u32_u24 v16, 48, v15
    v_sub_u32 v14, v14, v16
    v_mov_b32 v16, s55
    v_mov_b32 v17, s63
    v_cmp_gt_u32 vcc, 20, v14
    s_nop 1
    v_cndmask_b32 v16, v16, v17, vcc
    v_lshl_add_u32 v16, v14, 4, v16
    v_mov_b32 v17, s56
    v_cmp_lt_u32 vcc, 39, v14
    s_nop 1
    v_cndmask_b32 v16, v16, v17, vcc
    v_mul_u32_u24 v15, 1280, v15
    v_add_u32 v234, v15, v16
    v_lshrrev_b32 v14, 2, v1
    v_and_b32 v15, 3, v1
    v_mul_u32_u24 v18, 40, v2
    v_lshl_add_u32 v16, v14, 3, v15
    v_add_lshl_u32 v16, v16, v18, 1
    v_add_u32 v248, s60, v16
    v_sub_u32 v16, 632, v16
    v_add_u32 v249, s60, v16
    v_and_b32 v16, 1, v14
    v_lshl_add_u32 v16, v16, 2, v15
    v_add_lshl_u32 v16, v16, v18, 1
    v_add_u32 v15, 64, v16
    v_sub_u32 v16, 576, v16
    v_cmp_lt_u32 vcc, 1, v14
    s_nop 1
    v_cndmask_b32 v15, v15, v16, vcc
    v_add_u32 v250, s60, v15
    v_mul_u32_u24 v16, 276480, v2
    v_lshl_add_u32 v251, v1, 4, v16
L_interleave_layers__spectral_fnet__dense_activation_squared_relu__prompt_kernel_third_3:
    s_cmp_eq_u32 s4, s98
    s_cbranch_scc0 L_interleave_layers__spectral_fnet__dense_activation_squared_relu__prompt_kernel_third_4
    s_waitcnt vmcnt(4)
    v_mov_b32 v14, 1
    v_mov_b32 v15, 0
    s_lshl_b32 s3, s2, 2
    s_mov_b64 exec, 1
    buffer_store_dword v14, v15, s[44:47], s3 offen sc1
    s_mov_b64 exec, -1
L_interleave_layers__spectral_fnet__dense_activation_squared_relu__prompt_kernel_third_4:
    s_mul_i32 s76, s81, 1280
    s_mul_i32 s77, s4, 20480
    s_add_u32 m0, s77, 0
    s_nop 0
    buffer_load_dwordx4 v100, s[12:15], s76 offen  lds
    s_mul_i32 s52, s4, 2560
    s_add_u32 s52, s52, 143360
    v_mul_u32_u24 v14, 160, v1
    v_lshl_add_u32 v14, v2, 3, v14
    v_add_u32 v98, s52, v14
    v_lshrrev_b32 v14, 2, v0
    v_mul_u32_u24 v14, 160, v14
    v_add_u32 v14, 143360, v14
    v_and_b32 v15, 3, v0
    v_lshl_add_u32 v99, v15, 4, v14
    v_xor_b32 v100, 64, v100
    s_add_u32 m0, s77, 1024
    s_nop 0
    buffer_load_dwordx4 v101, s[12:15], s76 offen  lds
    v_and_b32 v15, 1, v0
    v_lshl_add_u32 v221, v15, 3, v14
    v_mul_u32_u24 v14, 20480, v2
    v_lshl_add_u32 v223, v1, 4, v14
    v_lshl_add_u32 v222, v1, 3, v14
    s_lshl_b32 s69, s6, 2
    s_add_u32 s69, s69, s4
    s_mul_i32 s69, s69, 81920
    s_mul_i32 s53, s5, 640
    s_add_u32 s69, s69, s53
    v_xor_b32 v101, 64, v101
    s_add_u32 m0, s77, 2048
    s_nop 0
    buffer_load_dwordx4 v102, s[12:15], s76 offen  lds
    s_add_u32 s69, s69, 4194304
    s_lshl_b32 s52, s4, 2
    v_lshrrev_b32 v14, 2, v1
    v_add_u32 v14, s52, v14
    v_lshl_add_u32 v15, s52, 2, v1
    v_and_b32 v15, 0x7e, v15
    v_cmp_eq_u32 vcc, 2, v15
    s_nop 1
    v_cndmask_b32 v14, v14, 16, vcc
    v_sub_u32 v15, 64, v14
    v_and_b32 v16, 2, v1
    v_xor_b32 v102, 64, v102
    s_add_u32 m0, s77, 3072
    s_nop 0
    buffer_load_dwordx4 v103, s[12:15], s76 offen  lds
    v_cmp_eq_u32 vcc, 2, v16
    s_nop 1
    v_cndmask_b32 v14, v14, v15, vcc
    v_and_b32 v16, 1, v1
    v_lshlrev_b32 v16, 5, v16
    v_sub_u32 v15, 0, v16
    v_cndmask_b32 v16, v16, v15, vcc
    v_add_u32 v14, v14, v16
    v_lshlrev_b32 v15, 8, v2
    v_add_u32 v15, s5, v15
    v_mul_u32_u24 v15, v14, v15
    v_xor_b32 v103, 64, v103
    s_add_u32 m0, s77, 4096
    s_nop 0
    buffer_load_dwordx4 v104, s[12:15], s76 offen  lds
    v_cvt_f32_u32 v14, v14
    v_cvt_f32_u32 v15, v15
    v_mul_f32 v14, 0.00048828125, v14
    v_mul_f32 v15, 0.00048828125, v15
    v_fmamk_f32 v224, v14, 0.0, v15
    v_fract_f32 v224, v224
    v_fmamk_f32 v225, v14, 64.0, v15
    v_fract_f32 v225, v225
    v_sin_f32 v226, v224
    v_sin_f32 v227, v225
    v_xor_b32 v104, 64, v104
    s_add_u32 s76, s76, 327680
    s_add_u32 m0, s77, 5120
    s_nop 0
    buffer_load_dwordx4 v100, s[12:15], s76 offen  lds
    v_cos_f32 v224, v224
    v_cos_f32 v225, v225
    v_cvt_pk_bf16_f32 v204, v226, v227
    v_cvt_pk_bf16_f32 v188, v224, v225
    v_xor_b32 v196, 0x80008000, v204
    v_fmamk_f32 v224, v14, 128.0, v15
    v_fract_f32 v224, v224
    v_fmamk_f32 v225, v14, 192.0, v15
    v_fract_f32 v225, v225
    v_sin_f32 v226, v224
    v_xor_b32 v100, 192, v100
    s_add_u32 m0, s77, 6144
    s_nop 0
    buffer_load_dwordx4 v101, s[12:15], s76 offen  lds
    v_sin_f32 v227, v225
    v_cos_f32 v224, v224
    v_cos_f32 v225, v225
    v_cvt_pk_bf16_f32 v205, v226, v227
    v_cvt_pk_bf16_f32 v189, v224, v225
    v_xor_b32 v197, 0x80008000, v205
    v_fmamk_f32 v224, v14, 1024.0, v15
    v_fract_f32 v224, v224
    v_fmamk_f32 v225, v14, 1088.0, v15
    v_fract_f32 v225, v225
    v_xor_b32 v101, 192, v101
    s_add_u32 m0, s77, 7168
    s_nop 0
    buffer_load_dwordx4 v102, s[12:15], s76 offen  lds
    v_sin_f32 v226, v224
    v_sin_f32 v227, v225
    v_cos_f32 v224, v224
    v_cos_f32 v225, v225
    v_cvt_pk_bf16_f32 v206, v226, v227
    v_cvt_pk_bf16_f32 v190, v224, v225
    v_xor_b32 v198, 0x80008000, v206
    v_fmamk_f32 v224, v14, 1152.0, v15
    v_fract_f32 v224, v224
    v_fmamk_f32 v225, v14, 1216.0, v15
    v_xor_b32 v102, 192, v102
    s_add_u32 m0, s77, 8192
    s_nop 0
    buffer_load_dwordx4 v103, s[12:15], s76 offen  lds
    v_fract_f32 v225, v225
    v_sin_f32 v226, v224
    v_sin_f32 v227, v225
    v_cos_f32 v224, v224
    v_cos_f32 v225, v225
    v_cvt_pk_bf16_f32 v207, v226, v227
    v_cvt_pk_bf16_f32 v191, v224, v225
    v_xor_b32 v199, 0x80008000, v207
    v_fmamk_f32 v224, v14, 32.0, v15
    v_fract_f32 v224, v224
    v_xor_b32 v103, 192, v103
    s_add_u32 m0, s77, 9216
    s_nop 0
    buffer_load_dwordx4 v104, s[12:15], s76 offen  lds
    v_fmamk_f32 v225, v14, 96.0, v15
    v_fract_f32 v225, v225
    v_sin_f32 v226, v224
    v_sin_f32 v227, v225
    v_cos_f32 v224, v224
    v_cos_f32 v225, v225
    v_cvt_pk_bf16_f32 v208, v226, v227
    v_cvt_pk_bf16_f32 v192, v224, v225
    v_xor_b32 v200, 0x80008000, v208
    v_fmamk_f32 v224, v14, 160.0, v15
    v_xor_b32 v104, 192, v104
    s_add_u32 s76, s76, 327680
    s_add_u32 m0, s77, 10240
    s_nop 0
    buffer_load_dwordx4 v100, s[12:15], s76 offen  lds
    v_fract_f32 v224, v224
    v_fmamk_f32 v225, v14, 224.0, v15
    v_fract_f32 v225, v225
    v_sin_f32 v226, v224
    v_sin_f32 v227, v225
    v_cos_f32 v224, v224
    v_cos_f32 v225, v225
    v_cvt_pk_bf16_f32 v209, v226, v227
    v_cvt_pk_bf16_f32 v193, v224, v225
    v_xor_b32 v201, 0x80008000, v209
    v_xor_b32 v100, 64, v100
    s_add_u32 m0, s77, 11264
    s_nop 0
    buffer_load_dwordx4 v101, s[12:15], s76 offen  lds
    v_fmamk_f32 v224, v14, 1056.0, v15
    v_fract_f32 v224, v224
    v_fmamk_f32 v225, v14, 1120.0, v15
    v_fract_f32 v225, v225
    v_sin_f32 v226, v224
    v_sin_f32 v227, v225
    v_cos_f32 v224, v224
    v_cos_f32 v225, v225
    v_cvt_pk_bf16_f32 v210, v226, v227
    v_cvt_pk_bf16_f32 v194, v224, v225
    v_xor_b32 v101, 64, v101
    s_add_u32 m0, s77, 12288
    s_nop 0
    buffer_load_dwordx4 v102, s[12:15], s76 offen  lds
    v_xor_b32 v202, 0x80008000, v210
    v_fmamk_f32 v224, v14, 1184.0, v15
    v_fract_f32 v224, v224
    v_fmamk_f32 v225, v14, 1248.0, v15
    v_fract_f32 v225, v225
    v_sin_f32 v226, v224
    v_sin_f32 v227, v225
    v_cos_f32 v224, v224
    v_cos_f32 v225, v225
    v_cvt_pk_bf16_f32 v211, v226, v227
    v_xor_b32 v102, 64, v102
    s_add_u32 m0, s77, 13312
    s_nop 0
    buffer_load_dwordx4 v103, s[12:15], s76 offen  lds
    v_cvt_pk_bf16_f32 v195, v224, v225
    v_xor_b32 v203, 0x80008000, v211
    v_lshrrev_b32 v14, 1, v1
    v_xor_b32 v14, v14, v2
    v_mul_u32_u24 v15, 640, v1
    v_lshl_add_u32 v14, v14, 4, v15
    v_add_u32 v212, 81920, v14
    v_xor_b32 v213, 64, v212
    v_and_b32 v14, 0x31, v0
    v_cmp_eq_u32 vcc, 1, v14
    v_xor_b32 v103, 64, v103
    s_add_u32 m0, s77, 14336
    s_nop 0
    buffer_load_dwordx4 v104, s[12:15], s76 offen  lds
    v_mov_b32 v15, 0x8000
    v_cndmask_b32 v214, 0, v15, vcc
    v_and_b32 v14, 0x39, v0
    v_cmp_eq_u32 vcc, 1, v14
    s_nop 1
    v_cndmask_b32 v215, 0, v15, vcc
    v_mov_b32 v216, 0x3f803f80
    v_mov_b32 v217, 0x3f803f80
    v_mov_b32 v218, 0x3f803f80
    v_mov_b32 v219, 0x3f803f80
    v_cmp_lt_u32 vcc, 1, v2
    v_xor_b32 v104, 64, v104
    s_add_u32 s76, s76, 327680
    s_add_u32 m0, s77, 15360
    s_nop 0
    buffer_load_dwordx4 v100, s[12:15], s76 offen  lds
    v_cndmask_b32 v220, 1.0, -1.0, vcc
    s_mul_i32 s52, s4, 20480
    s_add_u32 s52, s52, 0
    v_mul_u32_u24 v14, 1280, v1
    v_add_u32 v14, s52, v14
    v_xor_b32 v15, v1, v2
    v_lshl_add_u32 v52, v15, 4, v14
    v_xor_b32 v53, 64, v52
    v_xor_b32 v54, 128, v52
    v_xor_b32 v55, 192, v52
    s_add_u32 m0, s77, 16384
    s_nop 0
    buffer_load_dwordx4 v101, s[12:15], s76 offen  lds
    v_xor_b32 v56, 48, v52
    v_xor_b32 v57, 48, v53
    v_xor_b32 v58, 48, v54
    v_xor_b32 v59, 48, v55
    v_sub_u32 v15, 80, v2
    v_cmp_eq_u32 vcc, 0, v2
    s_nop 1
    v_cndmask_b32 v15, v15, 40, vcc
    v_xor_b32 v15, v15, v1
    v_lshl_add_u32 v60, v15, 4, v14
    v_sub_u32 v15, 76, v2
    s_add_u32 m0, s77, 17408
    s_nop 0
    buffer_load_dwordx4 v102, s[12:15], s76 offen  lds
    v_xor_b32 v15, v15, v1
    v_lshl_add_u32 v61, v15, 4, v14
    v_sub_u32 v15, 72, v2
    v_xor_b32 v15, v15, v1
    v_lshl_add_u32 v62, v15, 4, v14
    v_sub_u32 v15, 68, v2
    v_xor_b32 v15, v15, v1
    v_lshl_add_u32 v63, v15, 4, v14
    v_sub_u32 v15, 64, v2
    v_xor_b32 v15, v15, v1
    s_add_u32 m0, s77, 18432
    s_nop 0
    buffer_load_dwordx4 v103, s[12:15], s76 offen  lds
    v_lshl_add_u32 v64, v15, 4, v14
    v_sub_u32 v15, 60, v2
    v_xor_b32 v15, v15, v1
    v_lshl_add_u32 v65, v15, 4, v14
    v_sub_u32 v15, 56, v2
    v_xor_b32 v15, v15, v1
    v_lshl_add_u32 v66, v15, 4, v14
    v_sub_u32 v15, 52, v2
    v_xor_b32 v15, v15, v1
    v_lshl_add_u32 v67, v15, 4, v14
    s_add_u32 m0, s77, 19456
    s_nop 0
    buffer_load_dwordx4 v104, s[12:15], s76 offen  lds
    v_sub_u32 v15, 48, v2
    v_xor_b32 v15, v15, v1
    v_lshl_add_u32 v68, v15, 4, v14
    v_sub_u32 v15, 44, v2
    v_xor_b32 v15, v15, v1
    v_lshl_add_u32 v69, v15, 4, v14
    s_mul_i32 s53, s6, 5
    v_add_u32 v15, s53, v2
    v_xor_b32 v16, v15, v1
    v_lshl_add_u32 v140, v16, 4, v14
    v_sub_u32 v16, 79, v15
    v_xor_b32 v16, v16, v1
    v_lshl_add_u32 v141, v16, 4, v14
    v_sub_u32 v16, 80, v15
    v_cmp_eq_u32 vcc, 0, v15
    s_nop 1
    v_cndmask_b32 v16, v16, 40, vcc
    v_xor_b32 v16, v16, v1
    v_lshl_add_u32 v142, v16, 4, v14
    s_add_u32 s54, 4, s53
    v_xor_b32 v16, s54, v1
    v_lshl_add_u32 v143, v16, 4, v14
    s_sub_u32 s54, 75, s53
    v_xor_b32 v16, s54, v1
    v_lshl_add_u32 v144, v16, 4, v14
    s_sub_u32 s54, 76, s53
    v_xor_b32 v16, s54, v1
    v_lshl_add_u32 v145, v16, 4, v14
    s_mul_i32 s54, s6, 51200
    s_mov_b32 s55, s4
    s_mov_b32 s53, s4
    s_mul_i32 s53, s53, 10240
    s_add_u32 s53, s53, s54
    s_mul_i32 s55, s55, 5120
    s_add_u32 m0, s55, 81920
    s_nop 0
    buffer_load_dwordx4 v110, s[16:19], s53 offen  lds
    s_add_u32 m0, s55, 82944
    s_nop 0
    buffer_load_dwordx4 v106, s[16:19], s53 offen  lds
    s_add_u32 m0, s55, 83968
    s_nop 0
    buffer_load_dwordx4 v107, s[16:19], s53 offen  lds
    s_add_u32 m0, s55, 84992
    s_nop 0
    buffer_load_dwordx4 v108, s[16:19], s53 offen  lds
    s_add_u32 m0, s55, 86016
    s_nop 0
    buffer_load_dwordx4 v109, s[16:19], s53 offen  lds
    s_add_u32 s55, s4, 4
    s_sub_u32 s53, s4, 1
    s_cmp_eq_u32 s4, 0
    s_cselect_b32 s53, 4, s53
    s_mul_i32 s53, s53, 10240
    s_add_u32 s53, s53, s54
    s_mul_i32 s55, s55, 5120
    s_add_u32 m0, s55, 81920
    s_nop 0
    buffer_load_dwordx4 v105, s[48:51], s53 offen  lds
    s_add_u32 m0, s55, 82944
    s_nop 0
    buffer_load_dwordx4 v106, s[48:51], s53 offen  lds
    s_add_u32 m0, s55, 83968
    s_nop 0
    buffer_load_dwordx4 v107, s[48:51], s53 offen  lds
    s_add_u32 m0, s55, 84992
    s_nop 0
    buffer_load_dwordx4 v108, s[48:51], s53 offen  lds
    s_add_u32 m0, s55, 86016
    s_nop 0
    buffer_load_dwordx4 v109, s[48:51], s53 offen  lds
    s_cmp_lt_u32 s4, 2
    s_cselect_b32 s55, 8, 4
    s_add_u32 s55, s55, s4
    s_sub_u32 s53, s55, 5
    s_mul_i32 s53, s53, 10240
    s_add_u32 s53, s53, s54
    s_mul_i32 s55, s55, 5120
    s_add_u32 m0, s55, 81920
    s_nop 0
    buffer_load_dwordx4 v105, s[20:23], s53 offen  lds
    s_add_u32 m0, s55, 82944
    s_nop 0
    buffer_load_dwordx4 v106, s[20:23], s53 offen  lds
    s_add_u32 m0, s55, 83968
    s_nop 0
    buffer_load_dwordx4 v107, s[20:23], s53 offen  lds
    s_add_u32 m0, s55, 84992
    s_nop 0
    buffer_load_dwordx4 v108, s[20:23], s53 offen  lds
    s_add_u32 m0, s55, 86016
    s_nop 0
    buffer_load_dwordx4 v109, s[20:23], s53 offen  lds
    v_lshlrev_b32 v229, 2, v1
    buffer_load_dword v230, v229, s[44:47], 0 offen sc1
    s_cmp_lt_u32 s99, 540
    s_cbranch_scc0 L_interleave_layers__spectral_fnet__dense_activation_squared_relu__prompt_kernel_third_5
    s_add_u32 m0, s60, 0
    s_nop 0
    buffer_load_dwordx4 v232, s[24:27], s64 offen  lds
    s_add_u32 m0, s60, 1024
    s_nop 0
    buffer_load_dwordx4 v233, s[24:27], s65 offen  lds
    s_add_u32 m0, s60, 2048
    s_nop 0
    buffer_load_dwordx4 v233, s[24:27], s66 offen  lds
    s_add_u32 m0, s60, 3072
    s_nop 0
    buffer_load_dwordx4 v233, s[24:27], s67 offen  lds
L_interleave_layers__spectral_fnet__dense_activation_squared_relu__prompt_kernel_third_5:
    s_cmp_ge_u32 s99, 540
    s_cbranch_scc0 L_interleave_layers__spectral_fnet__dense_activation_squared_relu__prompt_kernel_third_6
    s_add_u32 m0, s60, 0
    s_nop 0
    buffer_load_dwordx4 v232, s[28:31], s64 offen  lds
    s_add_u32 m0, s60, 1024
    s_nop 0
    buffer_load_dwordx4 v233, s[28:31], s64 offen  lds
    s_add_u32 m0, s60, 2048
    s_nop 0
    buffer_load_dwordx4 v234, s[28:31], s64 offen  lds
    s_add_u32 m0, s60, 3072
    s_nop 0
    buffer_load_dwordx4 v232, s[28:31], s65 offen  lds
    s_add_u32 m0, s60, 4096
    s_nop 0
    buffer_load_dwordx4 v233, s[28:31], s65 offen  lds
    s_add_u32 m0, s60, 5120
    s_nop 0
    buffer_load_dwordx4 v234, s[28:31], s65 offen  lds
L_interleave_layers__spectral_fnet__dense_activation_squared_relu__prompt_kernel_third_6:
    s_mov_b32 s68, 0xffff
    s_waitcnt vmcnt(20)
    ds_read_b128 v[20:23], v52 offset:0
    ds_read_b128 v[70:73], v59 offset:1024
    ds_read_b32 v74, v60
    ds_read_b128 v[28:31], v53 offset:0
    ds_read_b128 v[76:79], v58 offset:1024
    ds_read_b32 v80, v61
    ds_read_b128 v[4:7], v140
    ds_read_b128 v[100:103], v141
    ds_read_b32 v104, v142
    ds_read_b128 v[148:151], v143
    ds_read_b128 v[106:109], v144
    ds_read_b32 v110, v145
    s_waitcnt lgkmcnt(9)
    v_bfi_b32 v24, s68, v74, v73
    v_bfi_b32 v25, s68, v73, v72
    v_bfi_b32 v26, s68, v72, v71
    v_bfi_b32 v27, s68, v71, v70
    s_waitcnt lgkmcnt(0)
    v_bfi_b32 v8, s68, v104, v103
    v_bfi_b32 v140, s68, v110, v109
    v_bfi_b32 v9, s68, v103, v102
    v_bfi_b32 v141, s68, v109, v108
    v_bfi_b32 v10, s68, v102, v101
    v_bfi_b32 v142, s68, v108, v107
    v_bfi_b32 v11, s68, v101, v100
    v_bfi_b32 v143, s68, v107, v106
    v_cmp_lt_u32 vcc, 1, v2
    s_nop 1
    v_cndmask_b32 v148, v148, v140, vcc
    v_cndmask_b32 v149, v149, v141, vcc
    v_cndmask_b32 v150, v150, v142, vcc
    v_cndmask_b32 v151, v151, v143, vcc
    v_and_b32 v14, 1, v2
    v_cmp_eq_u32 vcc, 1, v14
    s_nop 1
    v_cndmask_b32 v12, v148, v150, vcc
    v_cndmask_b32 v13, v149, v151, vcc
    s_waitcnt vmcnt(6)
    s_cmp_lt_u32 s99, 540
    s_cbranch_scc0 L_interleave_layers__spectral_fnet__dense_activation_squared_relu__prompt_kernel_gwait_7
    s_waitcnt vmcnt(4)
L_interleave_layers__spectral_fnet__dense_activation_squared_relu__prompt_kernel_gwait_7:
    s_barrier
    s_cmp_lt_u32 s99, 540
    s_cbranch_scc0 L_interleave_layers__spectral_fnet__dense_activation_squared_relu__prompt_kernel_w2job_8
    ds_read_b128 v[148:151], v212 offset:0
    ds_read_b128 v[152:155], v212 offset:10240
    ds_read_b128 v[156:159], v212 offset:20480
    ds_read_b128 v[160:163], v212 offset:30720
    ds_read_b128 v[164:167], v212 offset:40960
    s_waitcnt lgkmcnt(3)
    v_mfma_f32_16x16x32_bf16 v[100:103], v[148:151], v[20:23], 0
    ds_read_b128 v[168:171], v213 offset:0
    v_xor_b32 v148, v148, v214
    v_mfma_f32_16x16x32_bf16 v[140:143], v[20:23], v[20:23], 0
    v_bfi_b32 v32, s68, v80, v79
    v_bfi_b32 v33, s68, v79, v78
    v_mfma_f32_16x16x32_bf16 v[120:123], v[148:151], v[24:27], 0
    v_bfi_b32 v34, s68, v78, v77
    v_bfi_b32 v35, s68, v77, v76
    v_mfma_f32_16x16x32_bf16 v[104:107], v[152:155], v[20:23], 0
    ds_read_b128 v[172:175], v213 offset:10240
    v_xor_b32 v152, v152, v214
    v_mfma_f32_16x16x32_bf16 v[144:147], v[216:219], v[20:23], 0
    ds_read_b128 v[36:39], v54 offset:0
    ds_read_b128 v[70:73], v57 offset:1024
    v_mfma_f32_16x16x32_bf16 v[124:127], v[152:155], v[24:27], 0
    ds_read_b32 v74, v62
    s_waitcnt lgkmcnt(6)
    v_mfma_f32_16x16x32_bf16 v[108:111], v[156:159], v[20:23], 0
    ds_read_b128 v[176:179], v213 offset:20480
    v_xor_b32 v156, v156, v215
    v_mfma_f32_16x16x32_bf16 v[140:143], v[24:27], v[24:27], v[140:143]
    s_nop 0
    v_mfma_f32_16x16x32_bf16 v[128:131], v[156:159], v[24:27], 0
    v_mfma_f32_16x16x32_bf16 v[112:115], v[160:163], v[20:23], 0
    ds_read_b128 v[180:183], v213 offset:30720
    v_mfma_f32_16x16x32_bf16 v[144:147], v[216:219], v[24:27], v[144:147]
    v_mfma_f32_16x16x32_bf16 v[132:135], v[160:163], v[24:27], 0
    s_waitcnt lgkmcnt(7)
    v_mfma_f32_16x16x32_bf16 v[116:119], v[164:167], v[20:23], 0
    ds_read_b128 v[184:187], v213 offset:40960
    v_mfma_f32_16x16x32_bf16 v[136:139], v[164:167], v[24:27], 0
    s_waitcnt lgkmcnt(6)
    v_mfma_f32_16x16x32_bf16 v[100:103], v[168:171], v[28:31], v[100:103]
    ds_read_b128 v[148:151], v212 offset:128
    s_waitcnt lgkmcnt(4)
    v_mfma_f32_16x16x32_bf16 v[140:143], v[28:31], v[28:31], v[140:143]
    v_bfi_b32 v40, s68, v74, v73
    v_bfi_b32 v41, s68, v73, v72
    v_mfma_f32_16x16x32_bf16 v[120:123], v[168:171], v[32:35], v[120:123]
    v_bfi_b32 v42, s68, v72, v71
    v_bfi_b32 v43, s68, v71, v70
    v_mfma_f32_16x16x32_bf16 v[104:107], v[172:175], v[28:31], v[104:107]
    ds_read_b128 v[152:155], v212 offset:10368
    ds_read_b128 v[44:47], v55 offset:0
    v_mfma_f32_16x16x32_bf16 v[144:147], v[216:219], v[28:31], v[144:147]
    ds_read_b128 v[76:79], v56 offset:1024
    ds_read_b32 v80, v63
    v_mfma_f32_16x16x32_bf16 v[124:127], v[172:175], v[32:35], v[124:127]
    s_waitcnt lgkmcnt(6)
    v_mfma_f32_16x16x32_bf16 v[108:111], v[176:179], v[28:31], v[108:111]
    ds_read_b128 v[156:159], v212 offset:20608
    v_mfma_f32_16x16x32_bf16 v[140:143], v[32:35], v[32:35], v[140:143]
    v_mfma_f32_16x16x32_bf16 v[128:131], v[176:179], v[32:35], v[128:131]
    v_mfma_f32_16x16x32_bf16 v[112:115], v[180:183], v[28:31], v[112:115]
    ds_read_b128 v[160:163], v212 offset:30848
    v_mfma_f32_16x16x32_bf16 v[144:147], v[216:219], v[32:35], v[144:147]
    v_mfma_f32_16x16x32_bf16 v[132:135], v[180:183], v[32:35], v[132:135]
    s_waitcnt lgkmcnt(7)
    v_mfma_f32_16x16x32_bf16 v[116:119], v[184:187], v[28:31], v[116:119]
    ds_read_b128 v[164:167], v212 offset:41088
    v_mfma_f32_16x16x32_bf16 v[136:139], v[184:187], v[32:35], v[136:139]
    s_waitcnt lgkmcnt(6)
    v_mfma_f32_16x16x32_bf16 v[100:103], v[148:151], v[36:39], v[100:103]
    ds_read_b128 v[168:171], v213 offset:128
    s_waitcnt lgkmcnt(4)
    v_mfma_f32_16x16x32_bf16 v[140:143], v[36:39], v[36:39], v[140:143]
    v_bfi_b32 v48, s68, v80, v79
    v_bfi_b32 v49, s68, v79, v78
    v_mfma_f32_16x16x32_bf16 v[120:123], v[148:151], v[40:43], v[120:123]
    v_bfi_b32 v50, s68, v78, v77
    v_bfi_b32 v51, s68, v77, v76
    v_mfma_f32_16x16x32_bf16 v[104:107], v[152:155], v[36:39], v[104:107]
    ds_read_b128 v[172:175], v213 offset:10368
    ds_read_b128 v[20:23], v52 offset:256
    v_mfma_f32_16x16x32_bf16 v[144:147], v[216:219], v[36:39], v[144:147]
    ds_read_b128 v[70:73], v59 offset:768
    ds_read_b32 v74, v64
    v_mfma_f32_16x16x32_bf16 v[124:127], v[152:155], v[40:43], v[124:127]
    s_waitcnt lgkmcnt(6)
    v_mfma_f32_16x16x32_bf16 v[108:111], v[156:159], v[36:39], v[108:111]
    ds_read_b128 v[176:179], v213 offset:20608
    v_mfma_f32_16x16x32_bf16 v[140:143], v[40:43], v[40:43], v[140:143]
    v_mfma_f32_16x16x32_bf16 v[128:131], v[156:159], v[40:43], v[128:131]
    v_mfma_f32_16x16x32_bf16 v[112:115], v[160:163], v[36:39], v[112:115]
    ds_read_b128 v[180:183], v213 offset:30848
    v_mfma_f32_16x16x32_bf16 v[144:147], v[216:219], v[40:43], v[144:147]
    v_mfma_f32_16x16x32_bf16 v[132:135], v[160:163], v[40:43], v[132:135]
    s_waitcnt lgkmcnt(7)
    v_mfma_f32_16x16x32_bf16 v[116:119], v[164:167], v[36:39], v[116:119]
    ds_read_b128 v[184:187], v213 offset:41088
    v_mfma_f32_16x16x32_bf16 v[136:139], v[164:167], v[40:43], v[136:139]
    s_waitcnt lgkmcnt(6)
    v_mfma_f32_16x16x32_bf16 v[100:103], v[168:171], v[44:47], v[100:103]
    ds_read_b128 v[148:151], v212 offset:256
    s_waitcnt lgkmcnt(4)
    v_mfma_f32_16x16x32_bf16 v[140:143], v[44:47], v[44:47], v[140:143]
    v_bfi_b32 v24, s68, v74, v73
    v_bfi_b32 v25, s68, v73, v72
    v_mfma_f32_16x16x32_bf16 v[120:123], v[168:171], v[48:51], v[120:123]
    v_bfi_b32 v26, s68, v72, v71
    v_bfi_b32 v27, s68, v71, v70
    v_mfma_f32_16x16x32_bf16 v[104:107], v[172:175], v[44:47], v[104:107]
    ds_read_b128 v[152:155], v212 offset:10496
    ds_read_b128 v[28:31], v53 offset:256
    v_mfma_f32_16x16x32_bf16 v[144:147], v[216:219], v[44:47], v[144:147]
    ds_read_b128 v[76:79], v58 offset:768
    ds_read_b32 v80, v65
    v_mfma_f32_16x16x32_bf16 v[124:127], v[172:175], v[48:51], v[124:127]
    s_waitcnt lgkmcnt(6)
    v_mfma_f32_16x16x32_bf16 v[108:111], v[176:179], v[44:47], v[108:111]
    ds_read_b128 v[156:159], v212 offset:20736
    v_mfma_f32_16x16x32_bf16 v[140:143], v[48:51], v[48:51], v[140:143]
    v_mfma_f32_16x16x32_bf16 v[128:131], v[176:179], v[48:51], v[128:131]
    v_mfma_f32_16x16x32_bf16 v[112:115], v[180:183], v[44:47], v[112:115]
    ds_read_b128 v[160:163], v212 offset:30976
    v_mfma_f32_16x16x32_bf16 v[144:147], v[216:219], v[48:51], v[144:147]
    v_mfma_f32_16x16x32_bf16 v[132:135], v[180:183], v[48:51], v[132:135]
    s_waitcnt lgkmcnt(7)
    v_mfma_f32_16x16x32_bf16 v[116:119], v[184:187], v[44:47], v[116:119]
    ds_read_b128 v[164:167], v212 offset:41216
    v_mfma_f32_16x16x32_bf16 v[136:139], v[184:187], v[48:51], v[136:139]
    s_waitcnt lgkmcnt(6)
    v_mfma_f32_16x16x32_bf16 v[100:103], v[148:151], v[20:23], v[100:103]
    ds_read_b128 v[168:171], v213 offset:256
    s_waitcnt lgkmcnt(4)
    v_mfma_f32_16x16x32_bf16 v[140:143], v[20:23], v[20:23], v[140:143]
    v_bfi_b32 v32, s68, v80, v79
    v_bfi_b32 v33, s68, v79, v78
    v_mfma_f32_16x16x32_bf16 v[120:123], v[148:151], v[24:27], v[120:123]
    v_bfi_b32 v34, s68, v78, v77
    v_bfi_b32 v35, s68, v77, v76
    v_mfma_f32_16x16x32_bf16 v[104:107], v[152:155], v[20:23], v[104:107]
    ds_read_b128 v[172:175], v213 offset:10496
    ds_read_b128 v[36:39], v54 offset:256
    v_mfma_f32_16x16x32_bf16 v[144:147], v[216:219], v[20:23], v[144:147]
    ds_read_b128 v[70:73], v57 offset:768
    ds_read_b32 v74, v66
    v_mfma_f32_16x16x32_bf16 v[124:127], v[152:155], v[24:27], v[124:127]
    s_waitcnt lgkmcnt(6)
    v_mfma_f32_16x16x32_bf16 v[108:111], v[156:159], v[20:23], v[108:111]
    ds_read_b128 v[176:179], v213 offset:20736
    v_mfma_f32_16x16x32_bf16 v[140:143], v[24:27], v[24:27], v[140:143]
    v_mfma_f32_16x16x32_bf16 v[128:131], v[156:159], v[24:27], v[128:131]
    v_mfma_f32_16x16x32_bf16 v[112:115], v[160:163], v[20:23], v[112:115]
    ds_read_b128 v[180:183], v213 offset:30976
    v_mfma_f32_16x16x32_bf16 v[144:147], v[216:219], v[24:27], v[144:147]
    v_mfma_f32_16x16x32_bf16 v[132:135], v[160:163], v[24:27], v[132:135]
    s_waitcnt lgkmcnt(7)
    v_mfma_f32_16x16x32_bf16 v[116:119], v[164:167], v[20:23], v[116:119]
    ds_read_b128 v[184:187], v213 offset:41216
    v_mfma_f32_16x16x32_bf16 v[136:139], v[164:167], v[24:27], v[136:139]
    s_waitcnt lgkmcnt(6)
    v_mfma_f32_16x16x32_bf16 v[100:103], v[168:171], v[28:31], v[100:103]
    ds_read_b128 v[148:151], v212 offset:384
    s_waitcnt lgkmcnt(4)
    v_mfma_f32_16x16x32_bf16 v[140:143], v[28:31], v[28:31], v[140:143]
    v_bfi_b32 v40, s68, v74, v73
    v_bfi_b32 v41, s68, v73, v72
    v_mfma_f32_16x16x32_bf16 v[120:123], v[168:171], v[32:35], v[120:123]
    v_bfi_b32 v42, s68, v72, v71
    v_bfi_b32 v43, s68, v71, v70
    v_mfma_f32_16x16x32_bf16 v[104:107], v[172:175], v[28:31], v[104:107]
    ds_read_b128 v[152:155], v212 offset:10624
    ds_read_b128 v[44:47], v55 offset:256
    v_mfma_f32_16x16x32_bf16 v[144:147], v[216:219], v[28:31], v[144:147]
    ds_read_b128 v[76:79], v56 offset:768
    ds_read_b32 v80, v67
    v_mfma_f32_16x16x32_bf16 v[124:127], v[172:175], v[32:35], v[124:127]
    s_waitcnt vmcnt(0) lgkmcnt(6)
    v_mfma_f32_16x16x32_bf16 v[108:111], v[176:179], v[28:31], v[108:111]
    ds_read_b128 v[156:159], v212 offset:20864
    ds_read_b64_tr_b16 v[232:233], v248 offset:0
    v_mfma_f32_16x16x32_bf16 v[140:143], v[32:35], v[32:35], v[140:143]
    ds_read_b64_tr_b16 v[234:235], v248 offset:2048
    ds_read_b64_tr_b16 v[236:237], v248 offset:32
    v_mfma_f32_16x16x32_bf16 v[128:131], v[176:179], v[32:35], v[128:131]
    ds_read_b64_tr_b16 v[238:239], v248 offset:2080
    ds_read_b64_tr_b16 v[240:241], v248 offset:64
    v_mfma_f32_16x16x32_bf16 v[112:115], v[180:183], v[28:31], v[112:115]
    ds_read_b128 v[160:163], v212 offset:31104
    ds_read_b64_tr_b16 v[242:243], v248 offset:2112
    v_mfma_f32_16x16x32_bf16 v[144:147], v[216:219], v[32:35], v[144:147]
    ds_read_b64_tr_b16 v[244:245], v248 offset:96
    ds_read_b64_tr_b16 v[246:247], v248 offset:2144
    v_mfma_f32_16x16x32_bf16 v[132:135], v[180:183], v[32:35], v[132:135]
    s_waitcnt lgkmcnt(7)
    v_mfma_f32_16x16x32_bf16 v[116:119], v[184:187], v[28:31], v[116:119]
    ds_read_b128 v[164:167], v212 offset:41344
    buffer_store_dwordx4 v[232:235], v3, s[8:11], s71 offen sc1
    v_mfma_f32_16x16x32_bf16 v[136:139], v[184:187], v[32:35], v[136:139]
    v_mfma_f32_16x16x32_bf16 v[100:103], v[148:151], v[36:39], v[100:103]
    ds_read_b128 v[168:171], v213 offset:384
    v_bfi_b32 v48, s68, v80, v79
    v_mfma_f32_16x16x32_bf16 v[140:143], v[36:39], v[36:39], v[140:143]
    v_bfi_b32 v49, s68, v79, v78
    v_bfi_b32 v50, s68, v78, v77
    v_mfma_f32_16x16x32_bf16 v[120:123], v[148:151], v[40:43], v[120:123]
    v_bfi_b32 v51, s68, v77, v76
    ds_read_b128 v[20:23], v52 offset:512
    v_mfma_f32_16x16x32_bf16 v[104:107], v[152:155], v[36:39], v[104:107]
    ds_read_b128 v[172:175], v213 offset:10624
    ds_read_b128 v[70:73], v59 offset:512
    v_mfma_f32_16x16x32_bf16 v[144:147], v[216:219], v[36:39], v[144:147]
    ds_read_b32 v74, v68
    v_mfma_f32_16x16x32_bf16 v[252:255], v[232:235], v[82:85], 0
    v_mfma_f32_16x16x32_bf16 v[124:127], v[152:155], v[40:43], v[124:127]
    s_waitcnt lgkmcnt(9)
    v_mfma_f32_16x16x32_bf16 v[108:111], v[156:159], v[36:39], v[108:111]
    ds_read_b128 v[176:179], v213 offset:20864
    buffer_store_dwordx4 v[236:239], v3, s[8:11], s72 offen sc1
    v_mfma_f32_16x16x32_bf16 v[140:143], v[40:43], v[40:43], v[140:143]
    v_mfma_f32_16x16x32_bf16 v[252:255], v[236:239], v[86:89], v[252:255]
    s_waitcnt lgkmcnt(9)
    v_mfma_f32_16x16x32_bf16 v[128:131], v[156:159], v[40:43], v[128:131]
    buffer_store_dwordx4 v[240:243], v3, s[8:11], s73 offen sc1
    v_mfma_f32_16x16x32_bf16 v[252:255], v[240:243], v[90:93], v[252:255]
    v_mfma_f32_16x16x32_bf16 v[112:115], v[160:163], v[36:39], v[112:115]
    ds_read_b128 v[180:183], v213 offset:31104
    s_waitcnt lgkmcnt(8)
    v_mfma_f32_16x16x32_bf16 v[144:147], v[216:219], v[40:43], v[144:147]
    buffer_store_dwordx4 v[244:247], v3, s[8:11], s74 offen sc1
    v_mfma_f32_16x16x32_bf16 v[252:255], v[244:247], v[94:97], v[252:255]
    v_mfma_f32_16x16x32_bf16 v[132:135], v[160:163], v[40:43], v[132:135]
    buffer_store_dwordx4 v[232:235], v3, s[8:11], s75 offen sc1
    s_waitcnt lgkmcnt(7)
    v_mfma_f32_16x16x32_bf16 v[116:119], v[164:167], v[36:39], v[116:119]
    ds_read_b128 v[184:187], v213 offset:41344
    v_mfma_f32_16x16x32_bf16 v[136:139], v[164:167], v[40:43], v[136:139]
    s_waitcnt lgkmcnt(5)
    v_mfma_f32_16x16x32_bf16 v[100:103], v[168:171], v[44:47], v[100:103]
    ds_read_b128 v[148:151], v212 offset:512
    s_waitcnt lgkmcnt(4)
    v_mfma_f32_16x16x32_bf16 v[140:143], v[44:47], v[44:47], v[140:143]
    v_bfi_b32 v24, s68, v74, v73
    v_bfi_b32 v25, s68, v73, v72
    v_mfma_f32_16x16x32_bf16 v[120:123], v[168:171], v[48:51], v[120:123]
    v_bfi_b32 v26, s68, v72, v71
    v_bfi_b32 v27, s68, v71, v70
    v_mfma_f32_16x16x32_bf16 v[104:107], v[172:175], v[44:47], v[104:107]
    ds_read_b128 v[152:155], v212 offset:10752
    ds_read_b128 v[28:31], v53 offset:512
    v_mfma_f32_16x16x32_bf16 v[144:147], v[216:219], v[44:47], v[144:147]
    ds_read_b128 v[76:79], v58 offset:512
    ds_read_b32 v80, v69
    v_mfma_f32_16x16x32_bf16 v[124:127], v[172:175], v[48:51], v[124:127]
    s_waitcnt lgkmcnt(6)
    v_mfma_f32_16x16x32_bf16 v[108:111], v[176:179], v[44:47], v[108:111]
    ds_read_b128 v[156:159], v212 offset:20992
    v_mfma_f32_16x16x32_bf16 v[140:143], v[48:51], v[48:51], v[140:143]
    v_mfma_f32_16x16x32_bf16 v[128:131], v[176:179], v[48:51], v[128:131]
    v_mfma_f32_16x16x32_bf16 v[112:115], v[180:183], v[44:47], v[112:115]
    ds_read_b128 v[160:163], v212 offset:31232
    v_mfma_f32_16x16x32_bf16 v[144:147], v[216:219], v[48:51], v[144:147]
    v_mfma_f32_16x16x32_bf16 v[132:135], v[180:183], v[48:51], v[132:135]
    s_waitcnt lgkmcnt(7)
    v_mfma_f32_16x16x32_bf16 v[116:119], v[184:187], v[44:47], v[116:119]
    ds_read_b128 v[164:167], v212 offset:41472
    v_mfma_f32_16x16x32_bf16 v[136:139], v[184:187], v[48:51], v[136:139]
    s_waitcnt lgkmcnt(6)
    v_mfma_f32_16x16x32_bf16 v[100:103], v[148:151], v[20:23], v[100:103]
    ds_read_b128 v[168:171], v213 offset:512
    s_waitcnt lgkmcnt(4)
    v_mfma_f32_16x16x32_bf16 v[140:143], v[20:23], v[20:23], v[140:143]
    v_bfi_b32 v32, s68, v80, v79
    v_bfi_b32 v33, s68, v79, v78
    v_mfma_f32_16x16x32_bf16 v[120:123], v[148:151], v[24:27], v[120:123]
    v_bfi_b32 v34, s68, v78, v77
    v_bfi_b32 v35, s68, v77, v76
    v_mfma_f32_16x16x32_bf16 v[104:107], v[152:155], v[20:23], v[104:107]
    ds_read_b128 v[172:175], v213 offset:10752
    v_mfma_f32_16x16x32_bf16 v[144:147], v[216:219], v[20:23], v[144:147]
    v_mfma_f32_16x16x32_bf16 v[124:127], v[152:155], v[24:27], v[124:127]
    s_waitcnt lgkmcnt(3)
    v_mfma_f32_16x16x32_bf16 v[108:111], v[156:159], v[20:23], v[108:111]
    ds_read_b128 v[176:179], v213 offset:20992
    v_mfma_f32_16x16x32_bf16 v[140:143], v[24:27], v[24:27], v[140:143]
    v_mfma_f32_16x16x32_bf16 v[128:131], v[156:159], v[24:27], v[128:131]
    v_mfma_f32_16x16x32_bf16 v[112:115], v[160:163], v[20:23], v[112:115]
    ds_read_b128 v[180:183], v213 offset:31232
    v_mfma_f32_16x16x32_bf16 v[144:147], v[216:219], v[24:27], v[144:147]
    v_mfma_f32_16x16x32_bf16 v[132:135], v[160:163], v[24:27], v[132:135]
    s_waitcnt lgkmcnt(4)
    v_mfma_f32_16x16x32_bf16 v[116:119], v[164:167], v[20:23], v[116:119]
    ds_read_b128 v[184:187], v213 offset:41472
    v_mfma_f32_16x16x32_bf16 v[136:139], v[164:167], v[24:27], v[136:139]
    v_mfma_f32_16x16x32_bf16 v[140:143], v[28:31], v[28:31], v[140:143]
    v_mov_b32 v148, 0
    v_mov_b32 v149, 0
    v_mfma_f32_16x16x32_bf16 v[140:143], v[32:35], v[32:35], v[140:143]
    v_mov_b32 v151, 0
    v_mov_b32 v152, 0
    v_mfma_f32_16x16x32_bf16 v[144:147], v[216:219], v[28:31], v[144:147]
    v_mov_b32 v153, 0
    v_mov_b32 v154, 0
    v_mfma_f32_16x16x32_bf16 v[144:147], v[216:219], v[32:35], v[144:147]
    v_mov_b32 v156, 0
    s_waitcnt lgkmcnt(3)
    v_mfma_f32_16x16x32_bf16 v[100:103], v[168:171], v[28:31], v[100:103]
    v_mov_b32 v157, 0
    v_cmp_eq_u32 s[58:59], 0, v2
    v_mfma_f32_16x16x32_bf16 v[120:123], v[168:171], v[32:35], v[120:123]
    s_nop 1
    v_mul_f32 v18, -0.0015625, v144
    v_cvt_pk_bf16_f32 v18, v18, v18
    v_mfma_f32_16x16x32_bf16 v[104:107], v[172:175], v[28:31], v[104:107]
    v_cndmask_b32 v150, 0, v18, s[58:59]
    v_cndmask_b32 v155, 0, v18, s[58:59]
    v_mfma_f32_16x16x32_bf16 v[124:127], v[172:175], v[32:35], v[124:127]
    v_and_b32 v14, 3, v1
    s_waitcnt lgkmcnt(1)
    v_mfma_f32_16x16x32_bf16 v[108:111], v[176:179], v[28:31], v[108:111]
    v_lshrrev_b32 v15, 2, v1
    v_lshl_add_u32 v15, v15, 4, v1
    v_mfma_f32_16x16x32_bf16 v[128:131], v[176:179], v[32:35], v[128:131]
    v_lshlrev_b32 v15, 2, v15
    v_mov_b32 v16, v140
    v_mfma_f32_16x16x32_bf16 v[112:115], v[180:183], v[28:31], v[112:115]
    v_cmp_eq_u32 vcc, 1, v14
    s_nop 1
    v_cndmask_b32 v16, v16, v141, vcc
    v_mfma_f32_16x16x32_bf16 v[132:135], v[180:183], v[32:35], v[132:135]
    v_cmp_eq_u32 vcc, 2, v14
    s_waitcnt lgkmcnt(0)
    v_mfma_f32_16x16x32_bf16 v[116:119], v[184:187], v[28:31], v[116:119]
    v_cndmask_b32 v16, v16, v142, vcc
    v_cmp_eq_u32 vcc, 3, v14
    v_mfma_f32_16x16x32_bf16 v[136:139], v[184:187], v[32:35], v[136:139]
    s_nop 0
    v_cndmask_b32 v16, v16, v143, vcc
    ds_bpermute_b32 v16, v15, v16
    v_mfma_f32_16x16x32_bf16 v[100:103], a[0:3], v[150:153], v[100:103]
    s_waitcnt lgkmcnt(0)
    v_mul_f32 v144, 0.0015625, v144
    v_mfma_f32_16x16x32_bf16 v[104:107], a[0:3], v[154:157], v[104:107]
    v_mul_f32 v16, 0.0015625, v16
    v_fma_f32 v16, -v144, v144, v16
    v_mfma_f32_16x16x32_bf16 v[108:111], a[0:3], v[148:151], v[108:111]
    v_max_f32 v16, 0, v16
    v_cvt_pk_bf16_f32 v17, v144, v16
    v_lshlrev_b32 v144, 16, v17
    v_and_b32 v16, 0xffff0000, v17
    v_add_f32 v16, 0x3727c5ac, v16
    v_cvt_pk_bf16_f32 v17, v16, v16
    v_lshlrev_b32 v16, 16, v17
    v_sqrt_f32 v16, v16
    s_nop 0
    v_cvt_pk_bf16_f32 v17, v16, v16
    v_lshlrev_b32 v16, 16, v17
    v_rcp_f32 v16, v16
    s_mov_b32 exec_lo, 0x000f000f
    s_mov_b32 exec_hi, 0x000f000f
    buffer_store_dwordx4 v[252:255], v249, s[8:11], s70 offen sc1
    s_mov_b64 exec, -1
    s_waitcnt lgkmcnt(0)
    s_branch L_interleave_layers__spectral_fnet__dense_activation_squared_relu__prompt_kernel_jobs_9
L_interleave_layers__spectral_fnet__dense_activation_squared_relu__prompt_kernel_w2job_8:
    ds_read_b128 v[148:151], v212 offset:0
    ds_read_b128 v[152:155], v212 offset:10240
    ds_read_b128 v[156:159], v212 offset:20480
    ds_read_b128 v[160:163], v212 offset:30720
    ds_read_b128 v[164:167], v212 offset:40960
    s_waitcnt lgkmcnt(3)
    v_mfma_f32_16x16x32_bf16 v[100:103], v[148:151], v[20:23], 0
    ds_read_b128 v[168:171], v213 offset:0
    v_xor_b32 v148, v148, v214
    v_mfma_f32_16x16x32_bf16 v[140:143], v[20:23], v[20:23], 0
    v_bfi_b32 v32, s68, v80, v79
    v_bfi_b32 v33, s68, v79, v78
    v_mfma_f32_16x16x32_bf16 v[120:123], v[148:151], v[24:27], 0
    v_bfi_b32 v34, s68, v78, v77
    v_bfi_b32 v35, s68, v77, v76
    v_mfma_f32_16x16x32_bf16 v[104:107], v[152:155], v[20:23], 0
    ds_read_b128 v[172:175], v213 offset:10240
    v_xor_b32 v152, v152, v214
    v_mfma_f32_16x16x32_bf16 v[144:147], v[216:219], v[20:23], 0
    ds_read_b128 v[36:39], v54 offset:0
    ds_read_b128 v[70:73], v57 offset:1024
    v_mfma_f32_16x16x32_bf16 v[124:127], v[152:155], v[24:27], 0
    ds_read_b32 v74, v62
    s_waitcnt lgkmcnt(6)
    v_mfma_f32_16x16x32_bf16 v[108:111], v[156:159], v[20:23], 0
    ds_read_b128 v[176:179], v213 offset:20480
    v_xor_b32 v156, v156, v215
    v_mfma_f32_16x16x32_bf16 v[140:143], v[24:27], v[24:27], v[140:143]
    s_nop 0
    v_mfma_f32_16x16x32_bf16 v[128:131], v[156:159], v[24:27], 0
    v_mfma_f32_16x16x32_bf16 v[112:115], v[160:163], v[20:23], 0
    ds_read_b128 v[180:183], v213 offset:30720
    v_mfma_f32_16x16x32_bf16 v[144:147], v[216:219], v[24:27], v[144:147]
    v_mfma_f32_16x16x32_bf16 v[132:135], v[160:163], v[24:27], 0
    s_waitcnt lgkmcnt(7)
    v_mfma_f32_16x16x32_bf16 v[116:119], v[164:167], v[20:23], 0
    ds_read_b128 v[184:187], v213 offset:40960
    v_mfma_f32_16x16x32_bf16 v[136:139], v[164:167], v[24:27], 0
    s_waitcnt lgkmcnt(6)
    v_mfma_f32_16x16x32_bf16 v[100:103], v[168:171], v[28:31], v[100:103]
    ds_read_b128 v[148:151], v212 offset:128
    s_waitcnt lgkmcnt(4)
    v_mfma_f32_16x16x32_bf16 v[140:143], v[28:31], v[28:31], v[140:143]
    v_bfi_b32 v40, s68, v74, v73
    v_bfi_b32 v41, s68, v73, v72
    v_mfma_f32_16x16x32_bf16 v[120:123], v[168:171], v[32:35], v[120:123]
    v_bfi_b32 v42, s68, v72, v71
    v_bfi_b32 v43, s68, v71, v70
    v_mfma_f32_16x16x32_bf16 v[104:107], v[172:175], v[28:31], v[104:107]
    ds_read_b128 v[152:155], v212 offset:10368
    ds_read_b128 v[44:47], v55 offset:0
    v_mfma_f32_16x16x32_bf16 v[144:147], v[216:219], v[28:31], v[144:147]
    ds_read_b128 v[76:79], v56 offset:1024
    ds_read_b32 v80, v63
    v_mfma_f32_16x16x32_bf16 v[124:127], v[172:175], v[32:35], v[124:127]
    s_waitcnt lgkmcnt(6)
    v_mfma_f32_16x16x32_bf16 v[108:111], v[176:179], v[28:31], v[108:111]
    ds_read_b128 v[156:159], v212 offset:20608
    v_mfma_f32_16x16x32_bf16 v[140:143], v[32:35], v[32:35], v[140:143]
    v_mfma_f32_16x16x32_bf16 v[128:131], v[176:179], v[32:35], v[128:131]
    v_mfma_f32_16x16x32_bf16 v[112:115], v[180:183], v[28:31], v[112:115]
    ds_read_b128 v[160:163], v212 offset:30848
    v_mfma_f32_16x16x32_bf16 v[144:147], v[216:219], v[32:35], v[144:147]
    v_mfma_f32_16x16x32_bf16 v[132:135], v[180:183], v[32:35], v[132:135]
    s_waitcnt lgkmcnt(7)
    v_mfma_f32_16x16x32_bf16 v[116:119], v[184:187], v[28:31], v[116:119]
    ds_read_b128 v[164:167], v212 offset:41088
    v_mfma_f32_16x16x32_bf16 v[136:139], v[184:187], v[32:35], v[136:139]
    s_waitcnt lgkmcnt(6)
    v_mfma_f32_16x16x32_bf16 v[100:103], v[148:151], v[36:39], v[100:103]
    ds_read_b128 v[168:171], v213 offset:128
    s_waitcnt lgkmcnt(4)
    v_mfma_f32_16x16x32_bf16 v[140:143], v[36:39], v[36:39], v[140:143]
    v_bfi_b32 v48, s68, v80, v79
    v_bfi_b32 v49, s68, v79, v78
    v_mfma_f32_16x16x32_bf16 v[120:123], v[148:151], v[40:43], v[120:123]
    v_bfi_b32 v50, s68, v78, v77
    v_bfi_b32 v51, s68, v77, v76
    v_mfma_f32_16x16x32_bf16 v[104:107], v[152:155], v[36:39], v[104:107]
    ds_read_b128 v[172:175], v213 offset:10368
    ds_read_b128 v[20:23], v52 offset:256
    v_mfma_f32_16x16x32_bf16 v[144:147], v[216:219], v[36:39], v[144:147]
    ds_read_b128 v[70:73], v59 offset:768
    ds_read_b32 v74, v64
    v_mfma_f32_16x16x32_bf16 v[124:127], v[152:155], v[40:43], v[124:127]
    s_waitcnt lgkmcnt(6)
    v_mfma_f32_16x16x32_bf16 v[108:111], v[156:159], v[36:39], v[108:111]
    ds_read_b128 v[176:179], v213 offset:20608
    v_mfma_f32_16x16x32_bf16 v[140:143], v[40:43], v[40:43], v[140:143]
    v_mfma_f32_16x16x32_bf16 v[128:131], v[156:159], v[40:43], v[128:131]
    v_mfma_f32_16x16x32_bf16 v[112:115], v[160:163], v[36:39], v[112:115]
    ds_read_b128 v[180:183], v213 offset:30848
    v_mfma_f32_16x16x32_bf16 v[144:147], v[216:219], v[40:43], v[144:147]
    v_mfma_f32_16x16x32_bf16 v[132:135], v[160:163], v[40:43], v[132:135]
    s_waitcnt lgkmcnt(7)
    v_mfma_f32_16x16x32_bf16 v[116:119], v[164:167], v[36:39], v[116:119]
    ds_read_b128 v[184:187], v213 offset:41088
    v_mfma_f32_16x16x32_bf16 v[136:139], v[164:167], v[40:43], v[136:139]
    s_waitcnt lgkmcnt(6)
    v_mfma_f32_16x16x32_bf16 v[100:103], v[168:171], v[44:47], v[100:103]
    ds_read_b128 v[148:151], v212 offset:256
    s_waitcnt lgkmcnt(4)
    v_mfma_f32_16x16x32_bf16 v[140:143], v[44:47], v[44:47], v[140:143]
    v_bfi_b32 v24, s68, v74, v73
    v_bfi_b32 v25, s68, v73, v72
    v_mfma_f32_16x16x32_bf16 v[120:123], v[168:171], v[48:51], v[120:123]
    v_bfi_b32 v26, s68, v72, v71
    v_bfi_b32 v27, s68, v71, v70
    v_mfma_f32_16x16x32_bf16 v[104:107], v[172:175], v[44:47], v[104:107]
    ds_read_b128 v[152:155], v212 offset:10496
    ds_read_b128 v[28:31], v53 offset:256
    v_mfma_f32_16x16x32_bf16 v[144:147], v[216:219], v[44:47], v[144:147]
    ds_read_b128 v[76:79], v58 offset:768
    ds_read_b32 v80, v65
    v_mfma_f32_16x16x32_bf16 v[124:127], v[172:175], v[48:51], v[124:127]
    s_waitcnt lgkmcnt(6)
    v_mfma_f32_16x16x32_bf16 v[108:111], v[176:179], v[44:47], v[108:111]
    ds_read_b128 v[156:159], v212 offset:20736
    v_mfma_f32_16x16x32_bf16 v[140:143], v[48:51], v[48:51], v[140:143]
    v_mfma_f32_16x16x32_bf16 v[128:131], v[176:179], v[48:51], v[128:131]
    v_mfma_f32_16x16x32_bf16 v[112:115], v[180:183], v[44:47], v[112:115]
    ds_read_b128 v[160:163], v212 offset:30976
    v_mfma_f32_16x16x32_bf16 v[144:147], v[216:219], v[48:51], v[144:147]
    v_mfma_f32_16x16x32_bf16 v[132:135], v[180:183], v[48:51], v[132:135]
    s_waitcnt lgkmcnt(7)
    v_mfma_f32_16x16x32_bf16 v[116:119], v[184:187], v[44:47], v[116:119]
    ds_read_b128 v[164:167], v212 offset:41216
    v_mfma_f32_16x16x32_bf16 v[136:139], v[184:187], v[48:51], v[136:139]
    s_waitcnt lgkmcnt(6)
    v_mfma_f32_16x16x32_bf16 v[100:103], v[148:151], v[20:23], v[100:103]
    ds_read_b128 v[168:171], v213 offset:256
    s_waitcnt lgkmcnt(4)
    v_mfma_f32_16x16x32_bf16 v[140:143], v[20:23], v[20:23], v[140:143]
    v_bfi_b32 v32, s68, v80, v79
    v_bfi_b32 v33, s68, v79, v78
    v_mfma_f32_16x16x32_bf16 v[120:123], v[148:151], v[24:27], v[120:123]
    v_bfi_b32 v34, s68, v78, v77
    v_bfi_b32 v35, s68, v77, v76
    v_mfma_f32_16x16x32_bf16 v[104:107], v[152:155], v[20:23], v[104:107]
    ds_read_b128 v[172:175], v213 offset:10496
    ds_read_b128 v[36:39], v54 offset:256
    v_mfma_f32_16x16x32_bf16 v[144:147], v[216:219], v[20:23], v[144:147]
    ds_read_b128 v[70:73], v57 offset:768
    ds_read_b32 v74, v66
    v_mfma_f32_16x16x32_bf16 v[124:127], v[152:155], v[24:27], v[124:127]
    s_waitcnt lgkmcnt(6)
    v_mfma_f32_16x16x32_bf16 v[108:111], v[156:159], v[20:23], v[108:111]
    ds_read_b128 v[176:179], v213 offset:20736
    v_mfma_f32_16x16x32_bf16 v[140:143], v[24:27], v[24:27], v[140:143]
    v_mfma_f32_16x16x32_bf16 v[128:131], v[156:159], v[24:27], v[128:131]
    v_mfma_f32_16x16x32_bf16 v[112:115], v[160:163], v[20:23], v[112:115]
    ds_read_b128 v[180:183], v213 offset:30976
    v_mfma_f32_16x16x32_bf16 v[144:147], v[216:219], v[24:27], v[144:147]
    v_mfma_f32_16x16x32_bf16 v[132:135], v[160:163], v[24:27], v[132:135]
    s_waitcnt lgkmcnt(7)
    v_mfma_f32_16x16x32_bf16 v[116:119], v[164:167], v[20:23], v[116:119]
    ds_read_b128 v[184:187], v213 offset:41216
    v_mfma_f32_16x16x32_bf16 v[136:139], v[164:167], v[24:27], v[136:139]
    s_waitcnt lgkmcnt(6)
    v_mfma_f32_16x16x32_bf16 v[100:103], v[168:171], v[28:31], v[100:103]
    ds_read_b128 v[148:151], v212 offset:384
    s_waitcnt lgkmcnt(4)
    v_mfma_f32_16x16x32_bf16 v[140:143], v[28:31], v[28:31], v[140:143]
    v_bfi_b32 v40, s68, v74, v73
    v_bfi_b32 v41, s68, v73, v72
    v_mfma_f32_16x16x32_bf16 v[120:123], v[168:171], v[32:35], v[120:123]
    v_bfi_b32 v42, s68, v72, v71
    v_bfi_b32 v43, s68, v71, v70
    v_mfma_f32_16x16x32_bf16 v[104:107], v[172:175], v[28:31], v[104:107]
    ds_read_b128 v[152:155], v212 offset:10624
    ds_read_b128 v[44:47], v55 offset:256
    v_mfma_f32_16x16x32_bf16 v[144:147], v[216:219], v[28:31], v[144:147]
    ds_read_b128 v[76:79], v56 offset:768
    ds_read_b32 v80, v67
    v_mfma_f32_16x16x32_bf16 v[124:127], v[172:175], v[32:35], v[124:127]
    s_waitcnt vmcnt(0) lgkmcnt(6)
    v_mfma_f32_16x16x32_bf16 v[108:111], v[176:179], v[28:31], v[108:111]
    ds_read_b128 v[156:159], v212 offset:20864
    ds_read_u16 v232, v248 offset:0
    v_mfma_f32_16x16x32_bf16 v[140:143], v[32:35], v[32:35], v[140:143]
    ds_read_u16 v233, v248 offset:768
    ds_read_u16 v234, v248 offset:1536
    v_mfma_f32_16x16x32_bf16 v[128:131], v[176:179], v[32:35], v[128:131]
    ds_read_u16 v235, v248 offset:2304
    ds_read_u16 v236, v248 offset:3072
    v_mfma_f32_16x16x32_bf16 v[112:115], v[180:183], v[28:31], v[112:115]
    ds_read_b128 v[160:163], v212 offset:31104
    ds_read_u16 v237, v248 offset:3840
    v_mfma_f32_16x16x32_bf16 v[144:147], v[216:219], v[32:35], v[144:147]
    ds_read_u16 v238, v248 offset:4608
    ds_read_u16 v239, v248 offset:5376
    v_mfma_f32_16x16x32_bf16 v[132:135], v[180:183], v[32:35], v[132:135]
    ds_read_u16 v240, v248 offset:8
    s_waitcnt lgkmcnt(14)
    v_mfma_f32_16x16x32_bf16 v[116:119], v[184:187], v[28:31], v[116:119]
    ds_read_b128 v[164:167], v212 offset:41344
    ds_read_u16 v241, v248 offset:776
    v_mfma_f32_16x16x32_bf16 v[136:139], v[184:187], v[32:35], v[136:139]
    ds_read_u16 v242, v248 offset:1544
    s_waitcnt lgkmcnt(14)
    v_mfma_f32_16x16x32_bf16 v[100:103], v[148:151], v[36:39], v[100:103]
    ds_read_b128 v[168:171], v213 offset:384
    ds_read_u16 v243, v248 offset:2312
    v_mfma_f32_16x16x32_bf16 v[140:143], v[36:39], v[36:39], v[140:143]
    ds_read_u16 v244, v248 offset:3080
    ds_read_u16 v245, v248 offset:3848
    v_mfma_f32_16x16x32_bf16 v[120:123], v[148:151], v[40:43], v[120:123]
    ds_read_u16 v246, v248 offset:4616
    ds_read_u16 v247, v248 offset:5384
    v_mfma_f32_16x16x32_bf16 v[104:107], v[152:155], v[36:39], v[104:107]
    ds_read_b128 v[172:175], v213 offset:10624
    s_waitcnt lgkmcnt(11)
    v_mfma_f32_16x16x32_bf16 v[144:147], v[216:219], v[36:39], v[144:147]
    v_lshl_or_b32 v252, v233, 16, v232
    v_lshl_or_b32 v253, v235, 16, v234
    v_mfma_f32_16x16x32_bf16 v[124:127], v[152:155], v[40:43], v[124:127]
    v_lshl_or_b32 v254, v237, 16, v236
    v_lshl_or_b32 v255, v239, 16, v238
    v_mfma_f32_16x16x32_bf16 v[108:111], v[156:159], v[36:39], v[108:111]
    ds_read_b128 v[176:179], v213 offset:20864
    buffer_store_dwordx4 v[252:255], v251, s[8:11], s61 offen offset:0 sc1
    v_mfma_f32_16x16x32_bf16 v[140:143], v[40:43], v[40:43], v[140:143]
    ds_read_u16 v232, v249 offset:8
    v_bfi_b32 v48, s68, v80, v79
    v_mfma_f32_16x16x32_bf16 v[128:131], v[156:159], v[40:43], v[128:131]
    v_bfi_b32 v49, s68, v79, v78
    v_bfi_b32 v50, s68, v78, v77
    v_mfma_f32_16x16x32_bf16 v[112:115], v[160:163], v[36:39], v[112:115]
    ds_read_b128 v[180:183], v213 offset:31104
    v_bfi_b32 v51, s68, v77, v76
    v_mfma_f32_16x16x32_bf16 v[144:147], v[216:219], v[40:43], v[144:147]
    ds_read_b128 v[20:23], v52 offset:512
    ds_read_b128 v[70:73], v59 offset:512
    v_mfma_f32_16x16x32_bf16 v[132:135], v[160:163], v[40:43], v[132:135]
    ds_read_b32 v74, v68
    s_waitcnt lgkmcnt(14)
    v_mfma_f32_16x16x32_bf16 v[116:119], v[164:167], v[36:39], v[116:119]
    ds_read_b128 v[184:187], v213 offset:41344
    ds_read_u16 v233, v249 offset:776
    v_mfma_f32_16x16x32_bf16 v[136:139], v[164:167], v[40:43], v[136:139]
    ds_read_u16 v234, v249 offset:1544
    s_waitcnt lgkmcnt(9)
    v_mfma_f32_16x16x32_bf16 v[100:103], v[168:171], v[44:47], v[100:103]
    ds_read_b128 v[148:151], v212 offset:512
    ds_read_u16 v235, v249 offset:2312
    v_mfma_f32_16x16x32_bf16 v[140:143], v[44:47], v[44:47], v[140:143]
    ds_read_u16 v236, v249 offset:3080
    ds_read_u16 v237, v249 offset:3848
    v_mfma_f32_16x16x32_bf16 v[120:123], v[168:171], v[48:51], v[120:123]
    ds_read_u16 v238, v249 offset:4616
    ds_read_u16 v239, v249 offset:5384
    v_mfma_f32_16x16x32_bf16 v[104:107], v[172:175], v[44:47], v[104:107]
    ds_read_b128 v[152:155], v212 offset:10752
    v_lshl_or_b32 v224, v241, 16, v240
    v_mfma_f32_16x16x32_bf16 v[144:147], v[216:219], v[44:47], v[144:147]
    v_lshl_or_b32 v225, v243, 16, v242
    v_lshl_or_b32 v226, v245, 16, v244
    v_mfma_f32_16x16x32_bf16 v[124:127], v[172:175], v[48:51], v[124:127]
    v_lshl_or_b32 v227, v247, 16, v246
    s_waitcnt lgkmcnt(13)
    v_mfma_f32_16x16x32_bf16 v[108:111], v[176:179], v[44:47], v[108:111]
    ds_read_b128 v[156:159], v212 offset:20992
    buffer_store_dwordx4 v[224:227], v251, s[8:11], s61 offen offset:1024 sc1
    v_mfma_f32_16x16x32_bf16 v[140:143], v[48:51], v[48:51], v[140:143]
    ds_read_u16 v240, v249 offset:0
    ds_read_u16 v241, v249 offset:768
    v_mfma_f32_16x16x32_bf16 v[128:131], v[176:179], v[48:51], v[128:131]
    ds_read_u16 v242, v249 offset:1536
    ds_read_u16 v243, v249 offset:2304
    v_mfma_f32_16x16x32_bf16 v[112:115], v[180:183], v[44:47], v[112:115]
    ds_read_b128 v[160:163], v212 offset:31232
    ds_read_u16 v244, v249 offset:3072
    v_mfma_f32_16x16x32_bf16 v[144:147], v[216:219], v[48:51], v[144:147]
    ds_read_u16 v245, v249 offset:3840
    ds_read_u16 v246, v249 offset:4608
    v_mfma_f32_16x16x32_bf16 v[132:135], v[180:183], v[48:51], v[132:135]
    ds_read_u16 v247, v249 offset:5376
    s_waitcnt lgkmcnt(14)
    v_mfma_f32_16x16x32_bf16 v[116:119], v[184:187], v[44:47], v[116:119]
    ds_read_b128 v[164:167], v212 offset:41472
    s_waitcnt lgkmcnt(12)
    v_mfma_f32_16x16x32_bf16 v[136:139], v[184:187], v[48:51], v[136:139]
    v_lshl_or_b32 v252, v233, 16, v232
    v_lshl_or_b32 v253, v235, 16, v234
    v_bfi_b32 v24, s68, v74, v73
    v_bfi_b32 v25, s68, v73, v72
    v_bfi_b32 v26, s68, v72, v71
    v_bfi_b32 v27, s68, v71, v70
    s_waitcnt lgkmcnt(11)
    v_mfma_f32_16x16x32_bf16 v[100:103], v[148:151], v[20:23], v[100:103]
    ds_read_b128 v[168:171], v213 offset:512
    ds_read_b128 v[28:31], v53 offset:512
    v_mfma_f32_16x16x32_bf16 v[140:143], v[20:23], v[20:23], v[140:143]
    ds_read_b128 v[76:79], v58 offset:512
    ds_read_b32 v80, v69
    v_mfma_f32_16x16x32_bf16 v[120:123], v[148:151], v[24:27], v[120:123]
    v_lshl_or_b32 v254, v237, 16, v236
    v_lshl_or_b32 v255, v239, 16, v238
    v_mfma_f32_16x16x32_bf16 v[104:107], v[152:155], v[20:23], v[104:107]
    ds_read_b128 v[172:175], v213 offset:10752
    buffer_store_dwordx4 v[252:255], v251, s[8:11], s61 offen offset:2048 sc1
    v_mfma_f32_16x16x32_bf16 v[144:147], v[216:219], v[20:23], v[144:147]
    ds_read_u16 v232, v250 offset:0
    ds_read_u16 v233, v250 offset:768
    v_mfma_f32_16x16x32_bf16 v[124:127], v[152:155], v[24:27], v[124:127]
    ds_read_u16 v234, v250 offset:1536
    s_waitcnt lgkmcnt(13)
    v_mfma_f32_16x16x32_bf16 v[108:111], v[156:159], v[20:23], v[108:111]
    ds_read_b128 v[176:179], v213 offset:20992
    ds_read_u16 v235, v250 offset:2304
    v_mfma_f32_16x16x32_bf16 v[140:143], v[24:27], v[24:27], v[140:143]
    ds_read_u16 v236, v250 offset:3072
    ds_read_u16 v237, v250 offset:3840
    v_mfma_f32_16x16x32_bf16 v[128:131], v[156:159], v[24:27], v[128:131]
    ds_read_u16 v238, v250 offset:4608
    ds_read_u16 v239, v250 offset:5376
    v_mfma_f32_16x16x32_bf16 v[112:115], v[160:163], v[20:23], v[112:115]
    ds_read_b128 v[180:183], v213 offset:31232
    s_waitcnt lgkmcnt(14)
    v_mfma_f32_16x16x32_bf16 v[144:147], v[216:219], v[24:27], v[144:147]
    v_lshl_or_b32 v224, v241, 16, v240
    v_lshl_or_b32 v225, v243, 16, v242
    v_mfma_f32_16x16x32_bf16 v[132:135], v[160:163], v[24:27], v[132:135]
    v_lshl_or_b32 v226, v245, 16, v244
    s_waitcnt lgkmcnt(14)
    v_mfma_f32_16x16x32_bf16 v[116:119], v[164:167], v[20:23], v[116:119]
    ds_read_b128 v[184:187], v213 offset:41472
    v_lshl_or_b32 v227, v247, 16, v246
    v_mfma_f32_16x16x32_bf16 v[136:139], v[164:167], v[24:27], v[136:139]
    buffer_store_dwordx4 v[224:227], v251, s[8:11], s61 offen offset:3072 sc1
    s_waitcnt lgkmcnt(2)
    v_lshl_or_b32 v252, v233, 16, v232
    v_lshl_or_b32 v253, v235, 16, v234
    v_lshl_or_b32 v254, v237, 16, v236
    v_lshl_or_b32 v255, v239, 16, v238
    s_add_u32 s61, s61, 4096
    buffer_store_dwordx4 v[252:255], v251, s[8:11], s61 offen offset:0 sc1
    v_bfi_b32 v32, s68, v80, v79
    v_bfi_b32 v33, s68, v79, v78
    v_bfi_b32 v34, s68, v78, v77
    v_bfi_b32 v35, s68, v77, v76
    v_mfma_f32_16x16x32_bf16 v[140:143], v[28:31], v[28:31], v[140:143]
    v_mov_b32 v148, 0
    v_mov_b32 v149, 0
    v_mfma_f32_16x16x32_bf16 v[140:143], v[32:35], v[32:35], v[140:143]
    v_mov_b32 v151, 0
    v_mov_b32 v152, 0
    v_mfma_f32_16x16x32_bf16 v[144:147], v[216:219], v[28:31], v[144:147]
    v_mov_b32 v153, 0
    v_mov_b32 v154, 0
    v_mfma_f32_16x16x32_bf16 v[144:147], v[216:219], v[32:35], v[144:147]
    v_mov_b32 v156, 0
    v_mov_b32 v157, 0
    v_mfma_f32_16x16x32_bf16 v[100:103], v[168:171], v[28:31], v[100:103]
    v_cmp_eq_u32 s[58:59], 0, v2
    v_mfma_f32_16x16x32_bf16 v[120:123], v[168:171], v[32:35], v[120:123]
    s_nop 2
    v_mul_f32 v18, -0.0015625, v144
    v_cvt_pk_bf16_f32 v18, v18, v18
    v_mfma_f32_16x16x32_bf16 v[104:107], v[172:175], v[28:31], v[104:107]
    v_cndmask_b32 v150, 0, v18, s[58:59]
    v_cndmask_b32 v155, 0, v18, s[58:59]
    v_mfma_f32_16x16x32_bf16 v[124:127], v[172:175], v[32:35], v[124:127]
    v_and_b32 v14, 3, v1
    s_waitcnt lgkmcnt(1)
    v_mfma_f32_16x16x32_bf16 v[108:111], v[176:179], v[28:31], v[108:111]
    v_lshrrev_b32 v15, 2, v1
    v_lshl_add_u32 v15, v15, 4, v1
    v_mfma_f32_16x16x32_bf16 v[128:131], v[176:179], v[32:35], v[128:131]
    v_lshlrev_b32 v15, 2, v15
    v_mov_b32 v16, v140
    v_mfma_f32_16x16x32_bf16 v[112:115], v[180:183], v[28:31], v[112:115]
    v_cmp_eq_u32 vcc, 1, v14
    s_nop 1
    v_cndmask_b32 v16, v16, v141, vcc
    v_mfma_f32_16x16x32_bf16 v[132:135], v[180:183], v[32:35], v[132:135]
    v_cmp_eq_u32 vcc, 2, v14
    s_waitcnt lgkmcnt(0)
    v_mfma_f32_16x16x32_bf16 v[116:119], v[184:187], v[28:31], v[116:119]
    v_cndmask_b32 v16, v16, v142, vcc
    v_cmp_eq_u32 vcc, 3, v14
    v_mfma_f32_16x16x32_bf16 v[136:139], v[184:187], v[32:35], v[136:139]
    s_nop 0
    v_cndmask_b32 v16, v16, v143, vcc
    ds_bpermute_b32 v16, v15, v16
    v_mfma_f32_16x16x32_bf16 v[100:103], a[0:3], v[150:153], v[100:103]
    s_waitcnt lgkmcnt(0)
    v_mul_f32 v144, 0.0015625, v144
    v_mfma_f32_16x16x32_bf16 v[104:107], a[0:3], v[154:157], v[104:107]
    v_mul_f32 v16, 0.0015625, v16
    v_fma_f32 v16, -v144, v144, v16
    v_mfma_f32_16x16x32_bf16 v[108:111], a[0:3], v[148:151], v[108:111]
    v_max_f32 v16, 0, v16
    v_cvt_pk_bf16_f32 v17, v144, v16
    v_lshlrev_b32 v144, 16, v17
    v_and_b32 v16, 0xffff0000, v17
    v_add_f32 v16, 0x3727c5ac, v16
    v_cvt_pk_bf16_f32 v17, v16, v16
    v_lshlrev_b32 v16, 16, v17
    v_sqrt_f32 v16, v16
    s_nop 0
    v_cvt_pk_bf16_f32 v17, v16, v16
    v_lshlrev_b32 v16, 16, v17
    v_rcp_f32 v16, v16
    s_waitcnt lgkmcnt(0)
L_interleave_layers__spectral_fnet__dense_activation_squared_relu__prompt_kernel_jobs_9:
    v_pk_add_f32 v[100:101], v[100:101], v[120:121]
    v_pk_add_f32 v[102:103], v[102:103], v[122:123]
    v_pk_add_f32 v[104:105], v[104:105], v[124:125]
    v_pk_add_f32 v[106:107], v[106:107], v[126:127]
    v_fmac_f32 v108, v128, v220
    v_fmac_f32 v109, v129, v220
    v_fmac_f32 v110, v130, v220
    v_fmac_f32 v111, v131, v220
    v_pk_add_f32 v[112:113], v[112:113], v[132:133] neg_lo:[0,1] neg_hi:[0,1]
    v_pk_add_f32 v[114:115], v[114:115], v[134:135] neg_lo:[0,1] neg_hi:[0,1]
    v_pk_add_f32 v[116:117], v[116:117], v[136:137] neg_lo:[0,1] neg_hi:[0,1]
    v_pk_add_f32 v[118:119], v[118:119], v[138:139] neg_lo:[0,1] neg_hi:[0,1]
    v_pk_mul_f32 v[100:101], v[100:101], v[16:17] op_sel_hi:[1,0]
    v_pk_mul_f32 v[102:103], v[102:103], v[16:17] op_sel_hi:[1,0]
    v_cvt_pk_bf16_f32 v100, v100, v101
    v_cvt_pk_bf16_f32 v101, v102, v103
    ds_write_b64 v98, v[100:101] offset:0
    v_pk_mul_f32 v[104:105], v[104:105], v[16:17] op_sel_hi:[1,0]
    v_pk_mul_f32 v[106:107], v[106:107], v[16:17] op_sel_hi:[1,0]
    v_cvt_pk_bf16_f32 v104, v104, v105
    v_cvt_pk_bf16_f32 v105, v106, v107
    ds_write_b64 v98, v[104:105] offset:32
    v_pk_mul_f32 v[108:109], v[108:109], v[16:17] op_sel_hi:[1,0]
    v_pk_mul_f32 v[110:111], v[110:111], v[16:17] op_sel_hi:[1,0]
    v_cvt_pk_bf16_f32 v108, v108, v109
    v_cvt_pk_bf16_f32 v109, v110, v111
    ds_write_b64 v98, v[108:109] offset:64
    v_pk_mul_f32 v[112:113], v[112:113], v[16:17] op_sel_hi:[1,0]
    v_pk_mul_f32 v[114:115], v[114:115], v[16:17] op_sel_hi:[1,0]
    v_cvt_pk_bf16_f32 v112, v112, v113
    v_cvt_pk_bf16_f32 v113, v114, v115
    ds_write_b64 v98, v[112:113] offset:96
    v_pk_mul_f32 v[116:117], v[116:117], v[16:17] op_sel_hi:[1,0]
    v_pk_mul_f32 v[118:119], v[118:119], v[16:17] op_sel_hi:[1,0]
    v_cvt_pk_bf16_f32 v116, v116, v117
    v_cvt_pk_bf16_f32 v117, v118, v119
    ds_write_b64 v98, v[116:117] offset:128
L_interleave_layers__spectral_fnet__dense_activation_squared_relu__prompt_kernel_dbg_10:
    v_cmp_ne_u32 vcc, 1, v230
    s_nop 4
    s_cbranch_vccz L_interleave_layers__spectral_fnet__dense_activation_squared_relu__prompt_kernel_dbgok_11
    s_cmp_eq_u32 s82, 0
    s_cbranch_scc1 L_interleave_layers__spectral_fnet__dense_activation_squared_relu__prompt_kernel_dbgok_11
    s_sub_u32 s82, s82, 1
    buffer_load_dword v230, v229, s[44:47], 0 offen sc1
    s_waitcnt vmcnt(0)
    s_branch L_interleave_layers__spectral_fnet__dense_activation_squared_relu__prompt_kernel_dbg_10
L_interleave_layers__spectral_fnet__dense_activation_squared_relu__prompt_kernel_dbgok_11:
    s_waitcnt lgkmcnt(0)
    s_barrier
    ds_read_b64_tr_b16 v[20:21], v99 offset:0
    ds_read_b64_tr_b16 v[22:23], v99 offset:2560
    ds_read_b64_tr_b16 v[28:29], v99 offset:80
    ds_read_b64_tr_b16 v[30:31], v99 offset:2640
    ds_read_b64_tr_b16 v[24:25], v99 offset:5120
    ds_read_b64_tr_b16 v[26:27], v99 offset:7680
    ds_read_b64_tr_b16 v[32:33], v99 offset:5200
    ds_read_b64_tr_b16 v[34:35], v99 offset:7760
    ds_read_b64_tr_b16 v[36:37], v99 offset:8
    ds_read_b64_tr_b16 v[38:39], v99 offset:2568
    ds_read_b64_tr_b16 v[44:45], v99 offset:88
    ds_read_b64_tr_b16 v[46:47], v99 offset:2648
    ds_read_b64_tr_b16 v[40:41], v99 offset:5128
    ds_read_b64_tr_b16 v[42:43], v99 offset:7688
    ds_read_b64_tr_b16 v[48:49], v99 offset:5208
    ds_read_b64_tr_b16 v[50:51], v99 offset:7768
    ds_read_b64_tr_b16 v[52:53], v221 offset:64
    ds_read_b64_tr_b16 v[54:55], v221 offset:2624
    ds_read_b64_tr_b16 v[60:61], v221 offset:144
    ds_read_b64_tr_b16 v[62:63], v221 offset:2704
    ds_read_b64_tr_b16 v[56:57], v221 offset:5184
    ds_read_b64_tr_b16 v[58:59], v221 offset:7744
    ds_read_b64_tr_b16 v[64:65], v221 offset:5264
    ds_read_b64_tr_b16 v[66:67], v221 offset:7824
    s_waitcnt lgkmcnt(14)
    v_mfma_f32_16x16x32_bf16 v[68:71], v[188:191], v[20:23], 0
    v_mfma_f32_16x16x32_bf16 v[72:75], v[188:191], v[28:31], 0
    v_mfma_f32_16x16x32_bf16 v[68:71], v[204:207], v[28:31], v[68:71]
    v_mfma_f32_16x16x32_bf16 v[72:75], v[196:199], v[20:23], v[72:75]
    s_waitcnt lgkmcnt(14)
    v_mfma_f32_16x16x32_bf16 v[68:71], v[192:195], v[24:27], v[68:71]
    v_mfma_f32_16x16x32_bf16 v[72:75], v[192:195], v[32:35], v[72:75]
    v_mfma_f32_16x16x32_bf16 v[68:71], v[208:211], v[32:35], v[68:71]
    v_mfma_f32_16x16x32_bf16 v[72:75], v[200:203], v[24:27], v[72:75]
    s_waitcnt lgkmcnt(12)
    v_mfma_f32_16x16x32_bf16 v[76:79], v[188:191], v[36:39], 0
    v_mfma_f32_16x16x32_bf16 v[80:83], v[188:191], v[44:47], 0
    v_mfma_f32_16x16x32_bf16 v[76:79], v[204:207], v[44:47], v[76:79]
    v_mfma_f32_16x16x32_bf16 v[80:83], v[196:199], v[36:39], v[80:83]
    s_nop 2
    v_cvt_pk_bf16_f32 v92, v68, v72
    s_waitcnt lgkmcnt(8)
    v_mfma_f32_16x16x32_bf16 v[76:79], v[192:195], v[40:43], v[76:79]
    v_cvt_pk_bf16_f32 v94, v69, v73
    v_cvt_pk_bf16_f32 v96, v70, v74
    v_mfma_f32_16x16x32_bf16 v[80:83], v[192:195], v[48:51], v[80:83]
    v_cvt_pk_bf16_f32 v98, v71, v75
    v_mfma_f32_16x16x32_bf16 v[76:79], v[208:211], v[48:51], v[76:79]
    v_mfma_f32_16x16x32_bf16 v[80:83], v[200:203], v[40:43], v[80:83]
    s_waitcnt lgkmcnt(4)
    v_mfma_f32_16x16x32_bf16 v[84:87], v[188:191], v[52:55], 0
    v_mfma_f32_16x16x32_bf16 v[88:91], v[188:191], v[60:63], 0
    v_mfma_f32_16x16x32_bf16 v[84:87], v[204:207], v[60:63], v[84:87]
    v_mfma_f32_16x16x32_bf16 v[88:91], v[196:199], v[52:55], v[88:91]
    s_nop 2
    v_cvt_pk_bf16_f32 v93, v76, v80
    s_waitcnt lgkmcnt(0)
    v_mfma_f32_16x16x32_bf16 v[84:87], v[192:195], v[56:59], v[84:87]
    buffer_store_dwordx2 v[92:93], v222, s[8:11], s69 offen offset:0 sc1
    v_cvt_pk_bf16_f32 v95, v77, v81
    v_mfma_f32_16x16x32_bf16 v[88:91], v[192:195], v[64:67], v[88:91]
    buffer_store_dwordx2 v[94:95], v222, s[8:11], s69 offen offset:128 sc1
    v_cvt_pk_bf16_f32 v97, v78, v82
    v_mfma_f32_16x16x32_bf16 v[84:87], v[208:211], v[64:67], v[84:87]
    buffer_store_dwordx2 v[96:97], v222, s[8:11], s69 offen offset:256 sc1
    v_cvt_pk_bf16_f32 v99, v79, v83
    v_mfma_f32_16x16x32_bf16 v[88:91], v[200:203], v[56:59], v[88:91]
    buffer_store_dwordx2 v[98:99], v222, s[8:11], s69 offen offset:384 sc1
    s_nop 6
    v_cvt_pk_bf16_f32 v84, v84, v88
    v_cvt_pk_bf16_f32 v85, v85, v89
    v_cvt_pk_bf16_f32 v86, v86, v90
    v_cvt_pk_bf16_f32 v87, v87, v91
    s_mov_b32 exec_lo, 0x00ff00ff
    s_mov_b32 exec_hi, 0x00ff00ff
    buffer_store_dwordx4 v[84:87], v223, s[8:11], s69 offen offset:512 sc1
    s_mov_b64 exec, -1
    s_add_u32 s74, s83, 32768
    v_mov_b32 v14, 1
    v_mov_b32 v15, 0
    s_waitcnt vmcnt(0)
    s_mov_b64 exec, 1
    buffer_store_dword v14, v15, s[8:11], s74 offen sc1
    s_mov_b64 exec, -1
    s_barrier
    s_cmp_eq_u32 s4, 0
    s_cbranch_scc0 L_interleave_layers__spectral_fnet__dense_activation_squared_relu__prompt_kernel_third_12
    s_getreg_b32 s3, hwreg(HW_REG_XCC_ID, 0, 4)
    s_or_b32 s3, s3, 0x80
    v_mov_b32 v14, s3
    v_mov_b32 v15, 0
    s_lshr_b32 s3, s2, 3
    s_lshl_b32 s3, s3, 5
    s_and_b32 s57, s2, 7
    s_add_u32 s3, s3, s57
    s_lshl_b32 s3, s3, 2
    s_mov_b64 exec, 1
    buffer_store_dword v14, v15, s[8:11], s3 offen sc1
    s_mov_b64 exec, -1
L_interleave_layers__spectral_fnet__dense_activation_squared_relu__prompt_kernel_third_12:
    v_lshrrev_b32 v14, 1, v0
    v_and_b32 v15, 1, v0
    v_lshlrev_b32 v15, 4, v15
    v_lshl_add_u32 v108, v14, 7, v15
    s_lshl_b32 s52, s80, 1
    v_lshlrev_b32 v16, 3, v0
    buffer_load_dwordx2 v[248:249], v16, s[32:35], s52 offen
    s_mul_i32 s52, s6, 80
    v_lshlrev_b32 v100, 4, v2
    v_mov_b32 v101, v100
    buffer_load_dwordx4 v[232:235], v101, s[36:39], s52 offen
    s_sub_u32 s53, 1266, s52
    v_sub_u32 v101, s53, v100
    v_add_u32 v102, 14, v101
    s_cmp_eq_u32 s6, 0
    s_cselect_b32 s54, 0xffff, 0
    s_mov_b32 s55, 0
    v_mov_b32 v103, 640
    v_cndmask_b32 v102, v102, v103, s[54:55]
    buffer_load_ushort v236, v102, s[36:39], 0 offen
    buffer_load_ushort v237, v101, s[36:39], 0 offen offset:12
    buffer_load_ushort v238, v101, s[36:39], 0 offen offset:10
    buffer_load_ushort v239, v101, s[36:39], 0 offen offset:8
    buffer_load_ushort v240, v101, s[36:39], 0 offen offset:6
    buffer_load_ushort v241, v101, s[36:39], 0 offen offset:4
    buffer_load_ushort v242, v101, s[36:39], 0 offen offset:2
    buffer_load_ushort v243, v101, s[36:39], 0 offen offset:0
    v_lshlrev_b32 v100, 3, v2
    s_add_u32 s53, s52, 64
    v_add_u32 v101, s53, v100
    s_sub_u32 s53, 1232, s52
    v_sub_u32 v102, s53, v100
    v_cmp_lt_u32 vcc, 1, v2
    s_nop 1
    v_cndmask_b32 v101, v101, v102, vcc
    v_cndmask_b32 v102, 2, -2, vcc
    buffer_load_ushort v244, v101, s[36:39], 0 offen
    v_add_u32 v101, v101, v102
    buffer_load_ushort v245, v101, s[36:39], 0 offen
    v_add_u32 v101, v101, v102
    buffer_load_ushort v246, v101, s[36:39], 0 offen
    v_add_u32 v101, v101, v102
    buffer_load_ushort v247, v101, s[36:39], 0 offen
    v_mov_b32 v16, 0
    s_lshl_b32 s52, s89, 5
    s_lshl_b32 s53, s5, 7
    s_lshl_b32 s54, s78, 5
    s_add_u32 s3, s52, 4096
    v_writelane_b32 v16, s3, 0
    s_add_u32 s3, s53, 12288
    v_writelane_b32 v16, s3, 1
    s_add_u32 s3, s54, 20480
    v_writelane_b32 v16, s3, 2
    s_add_u32 s3, s52, 8192
    v_writelane_b32 v16, s3, 3
    s_add_u32 s3, s53, 16384
    v_writelane_b32 v16, s3, 4
    s_add_u32 s3, s53, 24576
    v_writelane_b32 v16, s3, 5
    s_add_u32 s3, s53, 28672
    v_writelane_b32 v16, s3, 6
    s_mov_b64 exec, 127
    buffer_load_dword v231, v16, s[8:11], 0 offen sc1
    s_mov_b64 exec, -1
    s_and_b32 s52, s4, 1
    s_lshl_b32 s52, s52, 4
    v_add_u32 v14, s52, v1
    s_cmp_eq_u32 s87, 0
    s_cselect_b32 s53, 32, 31
    v_sub_u32 v15, s53, v14
    v_and_b32 v15, 31, v15
    v_cvt_f32_u32 v16, v2
    v_cvt_f32_u32 v17, v14
    v_mul_f32 v17, 0.03125, v17
    v_mul_f32 v18, v16, v17
    v_fmamk_f32 v224, v17, 0.0, v18
    v_fract_f32 v224, v224
    v_fmamk_f32 v225, v17, 4.0, v18
    v_fract_f32 v225, v225
    v_sin_f32 v226, v224
    v_sin_f32 v227, v225
    v_cos_f32 v224, v224
    v_cos_f32 v225, v225
    v_cvt_pk_bf16_f32 v20, v224, v226
    v_cvt_pk_bf16_f32 v21, v225, v227
    v_fmamk_f32 v224, v17, 8.0, v18
    v_fract_f32 v224, v224
    v_fmamk_f32 v225, v17, 12.0, v18
    v_fract_f32 v225, v225
    v_sin_f32 v226, v224
    v_sin_f32 v227, v225
    v_cos_f32 v224, v224
    v_cos_f32 v225, v225
    v_cvt_pk_bf16_f32 v22, v224, v226
    v_cvt_pk_bf16_f32 v23, v225, v227
    v_fmamk_f32 v224, v17, 16.0, v18
    v_fract_f32 v224, v224
    v_fmamk_f32 v225, v17, 20.0, v18
    v_fract_f32 v225, v225
    v_sin_f32 v226, v224
    v_sin_f32 v227, v225
    v_cos_f32 v224, v224
    v_cos_f32 v225, v225
    v_cvt_pk_bf16_f32 v24, v224, v226
    v_cvt_pk_bf16_f32 v25, v225, v227
    v_fmamk_f32 v224, v17, 24.0, v18
    v_fract_f32 v224, v224
    v_fmamk_f32 v225, v17, 28.0, v18
    v_fract_f32 v225, v225
    v_sin_f32 v226, v224
    v_sin_f32 v227, v225
    v_cos_f32 v224, v224
    v_cos_f32 v225, v225
    v_cvt_pk_bf16_f32 v26, v224, v226
    v_cvt_pk_bf16_f32 v27, v225, v227
    v_cvt_f32_u32 v17, v15
    v_mul_f32 v17, 0.03125, v17
    v_mul_f32 v18, v16, v17
    v_fmamk_f32 v224, v17, 0.0, v18
    v_fract_f32 v224, v224
    v_fmamk_f32 v225, v17, 4.0, v18
    v_fract_f32 v225, v225
    v_sin_f32 v226, v224
    v_sin_f32 v227, v225
    v_cos_f32 v224, v224
    v_cos_f32 v225, v225
    v_cvt_pk_bf16_f32 v28, v224, v226
    v_cvt_pk_bf16_f32 v29, v225, v227
    v_fmamk_f32 v224, v17, 8.0, v18
    v_fract_f32 v224, v224
    v_fmamk_f32 v225, v17, 12.0, v18
    v_fract_f32 v225, v225
    v_sin_f32 v226, v224
    v_sin_f32 v227, v225
    v_cos_f32 v224, v224
    v_cos_f32 v225, v225
    v_cvt_pk_bf16_f32 v30, v224, v226
    v_cvt_pk_bf16_f32 v31, v225, v227
    v_fmamk_f32 v224, v17, 16.0, v18
    v_fract_f32 v224, v224
    v_fmamk_f32 v225, v17, 20.0, v18
    v_fract_f32 v225, v225
    v_sin_f32 v226, v224
    v_sin_f32 v227, v225
    v_cos_f32 v224, v224
    v_cos_f32 v225, v225
    v_cvt_pk_bf16_f32 v32, v224, v226
    v_cvt_pk_bf16_f32 v33, v225, v227
    v_fmamk_f32 v224, v17, 24.0, v18
    v_fract_f32 v224, v224
    v_fmamk_f32 v225, v17, 28.0, v18
    v_fract_f32 v225, v225
    v_sin_f32 v226, v224
    v_sin_f32 v227, v225
    v_cos_f32 v224, v224
    v_cos_f32 v225, v225
    v_cvt_pk_bf16_f32 v34, v224, v226
    v_cvt_pk_bf16_f32 v35, v225, v227
    v_lshlrev_b32 v124, 16, v4
    v_and_b32 v125, 0xffff0000, v4
    v_lshlrev_b32 v126, 16, v5
    v_and_b32 v127, 0xffff0000, v5
    v_lshlrev_b32 v128, 16, v6
    v_and_b32 v129, 0xffff0000, v6
    v_lshlrev_b32 v130, 16, v7
    v_and_b32 v131, 0xffff0000, v7
    v_lshlrev_b32 v132, 16, v8
    v_and_b32 v133, 0xffff0000, v8
    v_lshlrev_b32 v134, 16, v9
    v_and_b32 v135, 0xffff0000, v9
    v_lshlrev_b32 v136, 16, v10
    v_and_b32 v137, 0xffff0000, v10
    v_lshlrev_b32 v138, 16, v11
    v_and_b32 v139, 0xffff0000, v11
    v_lshlrev_b32 v140, 16, v12
    v_and_b32 v141, 0xffff0000, v12
    v_lshlrev_b32 v142, 16, v13
    v_and_b32 v143, 0xffff0000, v13
    s_and_b32 s52, s5, 15
    s_sub_u32 s53, 16, s52
    s_and_b32 s53, s53, 15
    s_bitcmp1_b32 s5, 4
    s_cselect_b32 s52, s53, s52
    s_lshr_b32 s53, s87, 4
    s_lshl_b32 s53, s53, 1
    s_lshr_b32 s54, 0x9c, s53
    s_and_b32 s54, s54, 3
    s_lshr_b32 s53, s88, 4
    s_lshl_b32 s53, s53, 1
    s_lshr_b32 s55, 0x9c, s53
    s_and_b32 s55, s55, 3
    v_mul_u32_u24 v14, 640, v2
    v_add_u32 v14, 122880, v14
    v_lshl_add_u32 v15, v1, 3, v14
    s_lshl_b32 s53, s54, 7
    v_add_u32 v112, s53, v15
    s_lshl_b32 s53, s55, 7
    v_add_u32 v113, s53, v15
    v_and_b32 v15, 7, v1
    v_lshl_add_u32 v14, v15, 4, v14
    v_mov_b32 v15, s54
    v_mov_b32 v16, s55
    v_cmp_lt_u32 vcc, 7, v1
    s_nop 1
    v_cndmask_b32 v15, v15, v16, vcc
    v_lshl_add_u32 v114, v15, 2, v14
    v_mov_b32 v14, s4
    v_and_b32 v15, 7, v0
    v_lshl_add_u32 v14, v14, 5, v15
    v_lshlrev_b32 v115, 2, v14
    s_lshl_b32 s63, s6, 2
    s_lshr_b32 s53, s52, 2
    s_add_u32 s63, s63, s53
    s_lshl_b32 s63, s63, 9
    s_add_u32 s63, s63, 32768
    s_lshl_b32 s61, s6, 4
    s_add_u32 s61, s61, s52
    s_mul_i32 s61, s61, 20480
    s_mul_i32 s62, s4, 5120
    s_add_u32 s61, s61, s62
    s_add_u32 s61, s61, 4194304
    s_add_u32 m0, s62, 122880
L_interleave_layers__spectral_fnet__dense_activation_squared_relu__prompt_kernel_poll_13:
    buffer_load_dword v14, v115, s[8:11], s63 offen sc1
    s_waitcnt vmcnt(0)
    v_cmp_ne_u32 vcc, 1, v14
    s_nop 4
    s_cbranch_vccz L_interleave_layers__spectral_fnet__dense_activation_squared_relu__prompt_kernel_go_14
    s_cmp_eq_u32 s82, 0
    s_cbranch_scc1 L_interleave_layers__spectral_fnet__dense_activation_squared_relu__prompt_kernel_go_14
    s_sub_u32 s82, s82, 1
    s_branch L_interleave_layers__spectral_fnet__dense_activation_squared_relu__prompt_kernel_poll_13
L_interleave_layers__spectral_fnet__dense_activation_squared_relu__prompt_kernel_go_14:
    buffer_load_dwordx4 v3, s[8:11], s61 offen offset:0 sc1 lds
    buffer_load_dwordx4 v3, s[8:11], s61 offen offset:1024 sc1 lds
    buffer_load_dwordx4 v3, s[8:11], s61 offen offset:2048 sc1 lds
    buffer_load_dwordx4 v3, s[8:11], s61 offen offset:3072 sc1 lds
    s_add_u32 m0, m0, 4096
    s_add_u32 s61, s61, 4096
    buffer_load_dwordx4 v3, s[8:11], s61 offen sc1 lds
    buffer_load_dwordx4 v[104:107], v108, s[8:11], 0 offen sc1
    s_mul_i32 s72, s78, 20480
    s_mul_i32 s73, s6, 1280
    s_add_u32 s72, s72, s73
    s_add_u32 s72, s72, 10485760
    s_add_u32 s73, s72, 10240
    v_lshrrev_b32 v14, 1, v2
    v_mul_u32_u24 v14, 10240, v14
    v_lshl_add_u32 v14, v1, 4, v14
    v_and_b32 v15, 1, v2
    v_lshl_add_u32 v18, v15, 3, v14
    s_lshl_b32 s75, s78, 3
    s_add_u32 s75, s75, s6
    s_lshl_b32 s75, s75, 7
    s_add_u32 s75, s75, 131072
    s_mov_b32 s60, 0x3f803f80
    s_cmp_eq_u32 s6, 0
    s_cselect_b32 s56, 0xffff, 0
    s_mov_b32 s57, 0
    v_cmp_lt_u32 vcc, 1, v2
    s_waitcnt vmcnt(1)
    s_barrier
    ds_read_b64 v[144:145], v112 offset:0
    ds_read_b64 v[146:147], v112 offset:2560
    ds_read_b64 v[148:149], v112 offset:5120
    ds_read_b64 v[150:151], v112 offset:7680
    ds_read_b64 v[152:153], v112 offset:10240
    ds_read_b64 v[154:155], v112 offset:12800
    ds_read_b64 v[156:157], v112 offset:15360
    ds_read_b64 v[158:159], v112 offset:17920
    ds_read_b64 v[160:161], v113 offset:0
    ds_read_b64 v[162:163], v113 offset:2560
    ds_read_b64 v[164:165], v113 offset:5120
    ds_read_b64 v[166:167], v113 offset:7680
    ds_read_b64 v[168:169], v113 offset:10240
    ds_read_b64 v[170:171], v113 offset:12800
    ds_read_b64 v[172:173], v113 offset:15360
    ds_read_b64 v[174:175], v113 offset:17920
    ds_read_b32 v68, v114 offset:512
    ds_read_b32 v69, v114 offset:3072
    ds_read_b32 v70, v114 offset:5632
    ds_read_b32 v71, v114 offset:8192
    ds_read_b32 v72, v114 offset:10752
    ds_read_b32 v73, v114 offset:13312
    ds_read_b32 v74, v114 offset:15872
    ds_read_b32 v75, v114 offset:18432
    s_waitcnt lgkmcnt(14)
    v_pk_mov_b32 v[36:37], v[144:145], v[146:147] op_sel:[0,0]
    v_pk_mov_b32 v[38:39], v[148:149], v[150:151] op_sel:[0,0]
    v_pk_mov_b32 v[44:45], v[144:145], v[146:147] op_sel:[1,1]
    v_pk_mov_b32 v[46:47], v[148:149], v[150:151] op_sel:[1,1]
    v_mfma_f32_16x16x32_bf16 v[76:79], v[36:39], v[20:23], v[124:127]
    s_nop 0
    v_mfma_f32_16x16x32_bf16 v[80:83], v[44:47], v[20:23], v[128:131]
    s_waitcnt lgkmcnt(14)
    v_pk_mov_b32 v[40:41], v[152:153], v[154:155] op_sel:[0,0]
    v_pk_mov_b32 v[42:43], v[156:157], v[158:159] op_sel:[0,0]
    v_pk_mov_b32 v[48:49], v[152:153], v[154:155] op_sel:[1,1]
    v_pk_mov_b32 v[50:51], v[156:157], v[158:159] op_sel:[1,1]
    v_mfma_f32_16x16x32_bf16 v[76:79], v[40:43], v[24:27], v[76:79]
    s_nop 0
    v_mfma_f32_16x16x32_bf16 v[80:83], v[48:51], v[24:27], v[80:83]
    s_waitcnt lgkmcnt(12)
    v_pk_mov_b32 v[52:53], v[160:161], v[162:163] op_sel:[0,0]
    v_pk_mov_b32 v[54:55], v[164:165], v[166:167] op_sel:[0,0]
    v_pk_mov_b32 v[60:61], v[160:161], v[162:163] op_sel:[1,1]
    v_pk_mov_b32 v[62:63], v[164:165], v[166:167] op_sel:[1,1]
    v_mfma_f32_16x16x32_bf16 v[84:87], v[52:55], v[28:31], v[132:135]
    s_nop 0
    v_mfma_f32_16x16x32_bf16 v[88:91], v[60:63], v[28:31], v[136:139]
    s_waitcnt lgkmcnt(8)
    v_pk_mov_b32 v[56:57], v[168:169], v[170:171] op_sel:[0,0]
    v_pk_mov_b32 v[58:59], v[172:173], v[174:175] op_sel:[0,0]
    v_pk_mov_b32 v[64:65], v[168:169], v[170:171] op_sel:[1,1]
    v_pk_mov_b32 v[66:67], v[172:173], v[174:175] op_sel:[1,1]
    v_mfma_f32_16x16x32_bf16 v[84:87], v[56:59], v[32:35], v[84:87]
    s_nop 0
    v_mfma_f32_16x16x32_bf16 v[88:91], v[64:67], v[32:35], v[88:91]
    s_waitcnt lgkmcnt(0)
    v_mfma_f32_16x16x32_bf16 v[92:95], v[68:71], v[20:23], v[140:143]
    v_mfma_f32_16x16x32_bf16 v[96:99], v[68:71], v[28:31], v[140:143]
    v_mfma_f32_16x16x32_bf16 v[92:95], v[72:75], v[24:27], v[92:95]
    v_mfma_f32_16x16x32_bf16 v[96:99], v[72:75], v[32:35], v[96:99]
    v_cndmask_b32 v76, v76, v124, s[56:57]
    v_cvt_pk_bf16_f32 v4, v76, v77
    v_cvt_pk_bf16_f32 v5, v78, v79
    v_cvt_pk_bf16_f32 v6, v80, v81
    v_cvt_pk_bf16_f32 v7, v82, v83
    buffer_store_dwordx4 v[4:7], v3, s[8:11], s72 offen sc1
    v_cvt_pk_bf16_f32 v8, v84, v85
    v_cvt_pk_bf16_f32 v9, v86, v87
    v_cvt_pk_bf16_f32 v10, v88, v89
    v_cvt_pk_bf16_f32 v11, v90, v91
    buffer_store_dwordx4 v[8:11], v3, s[8:11], s73 offen sc1
    v_cndmask_b32 v92, v92, v96, vcc
    v_cndmask_b32 v93, v93, v97, vcc
    v_cndmask_b32 v94, v94, v98, vcc
    v_cndmask_b32 v95, v95, v99, vcc
    v_cvt_pk_bf16_f32 v12, v92, v93
    v_cvt_pk_bf16_f32 v13, v94, v95
    buffer_store_dwordx2 v[12:13], v18, s[8:11], s72 offen offset:1024 sc1
    v_dot2_f32_bf16 v16, v4, s60, 0
    v_dot2_f32_bf16 v17, v4, v4, 0
    v_dot2_f32_bf16 v16, v5, s60, v16
    v_dot2_f32_bf16 v17, v5, v5, v17
    v_dot2_f32_bf16 v16, v6, s60, v16
    v_dot2_f32_bf16 v17, v6, v6, v17
    v_dot2_f32_bf16 v16, v7, s60, v16
    v_dot2_f32_bf16 v17, v7, v7, v17
    v_dot2_f32_bf16 v16, v8, s60, v16
    v_dot2_f32_bf16 v17, v8, v8, v17
    v_dot2_f32_bf16 v16, v9, s60, v16
    v_dot2_f32_bf16 v17, v9, v9, v17
    v_dot2_f32_bf16 v16, v10, s60, v16
    v_dot2_f32_bf16 v17, v10, v10, v17
    v_dot2_f32_bf16 v16, v11, s60, v16
    v_dot2_f32_bf16 v17, v11, v11, v17
    v_dot2_f32_bf16 v16, v12, s60, v16
    v_dot2_f32_bf16 v17, v12, v12, v17
    v_dot2_f32_bf16 v16, v13, s60, v16
    v_dot2_f32_bf16 v17, v13, v13, v17
    s_nop 1
    v_mov_b32 v14, v16
    v_mov_b32 v15, v17
    s_nop 0
    v_permlane32_swap_b32 v16, v14
    v_permlane32_swap_b32 v17, v15
    v_pk_add_f32 v[16:17], v[16:17], v[14:15]
    v_mov_b32 v14, v16
    v_mov_b32 v15, v17
    s_nop 0
    v_permlane16_swap_b32 v16, v14
    v_permlane16_swap_b32 v17, v15
    v_pk_add_f32 v[16:17], v[16:17], v[14:15]
    v_lshlrev_b32 v14, 3, v0
    s_mov_b64 exec, 0xffff
    buffer_store_dwordx2 v[16:17], v14, s[8:11], s75 offen sc1
    s_mov_b64 exec, -1
    s_waitcnt vmcnt(4)
L_interleave_layers__spectral_fnet__dense_activation_squared_relu__prompt_kernel_f0_15:
    v_and_b32 v109, v104, v105
    v_and_b32 v110, v106, v107
    v_and_b32 v109, v109, v110
    v_and_b32 v109, 0x80, v109
    v_cmp_eq_u32 vcc, 0, v109
    s_nop 4
    s_cbranch_vccz L_interleave_layers__spectral_fnet__dense_activation_squared_relu__prompt_kernel_f0ok_16
    s_cmp_eq_u32 s82, 0
    s_cbranch_scc1 L_interleave_layers__spectral_fnet__dense_activation_squared_relu__prompt_kernel_f0ok_16
    s_sub_u32 s82, s82, 1
    buffer_load_dwordx4 v[104:107], v108, s[8:11], 0 offen sc1
    s_waitcnt vmcnt(0)
    s_branch L_interleave_layers__spectral_fnet__dense_activation_squared_relu__prompt_kernel_f0_15
L_interleave_layers__spectral_fnet__dense_activation_squared_relu__prompt_kernel_f0ok_16:
    s_bitcmp1_b32 s2, 0
    s_cselect_b64 vcc, -1, 0
    v_cndmask_b32 v104, v104, v105, vcc
    v_cndmask_b32 v106, v106, v107, vcc
    s_bitcmp1_b32 s2, 1
    s_cselect_b64 vcc, -1, 0
    v_cndmask_b32 v104, v104, v106, vcc
    s_getreg_b32 s54, hwreg(HW_REG_XCC_ID, 0, 4)
    s_or_b32 s54, s54, 0x80
    v_cmp_ne_u32 vcc, s54, v104
    s_bitcmp1_b32 s2, 7
    s_cselect_b32 s54, vcc_hi, vcc_lo
    s_mov_b32 s55, 0x55555555
    s_bitcmp1_b32 s2, 2
    s_cselect_b32 s55, 0xaaaaaaaa, s55
    s_and_b32 s54, s54, s55
    s_cselect_b32 s91, 0, 1
    v_add_u32 v224, 64512, v3
    v_add_u32 v225, 129024, v3
    v_lshlrev_b32 v226, 4, v1
    v_add_u32 v226, 153600, v226
    v_and_b32 v14, 1, v2
    v_mul_u32_u24 v14, 55296, v14
    v_lshl_add_u32 v14, v1, 4, v14
    v_lshrrev_b32 v15, 1, v2
    v_lshl_add_u32 v227, v15, 8, v14
    s_mul_i32 s61, s89, 55296
    s_lshl_b32 s53, s80, 5
    s_add_u32 s61, s61, s53
    s_add_u32 s61, s61, 20971520
    s_add_u32 s64, s61, s86
    s_mov_b32 s63, 4096
    s_mul_i32 s65, s89, 20480
    s_add_u32 s65, s65, 10485760
    s_add_u32 s66, s65, 4096
    s_add_u32 s67, s65, 8192
    s_add_u32 s68, s65, 12288
    s_add_u32 s69, s65, 16384
    s_add_u32 s70, s65, 20480
    s_add_u32 s71, s65, 24576
    s_add_u32 s72, s65, 28672
    s_add_u32 s73, s65, 32768
    s_add_u32 s60, s65, 36864
    s_lshl_b32 s62, s89, 10
    s_add_u32 s62, s62, 131072
    s_lshl_b32 s75, s78, 10
    s_add_u32 s75, s75, 131072
    s_lshl_b32 s52, s89, 3
    v_add_u32 v14, s52, v1
    s_lshl_b32 s52, s78, 3
    v_and_b32 v15, 7, v0
    v_add_u32 v15, s52, v15
    v_cmp_gt_u32 vcc, 16, v0
    s_nop 1
    v_cndmask_b32 v14, v15, v14, vcc
    v_lshlrev_b32 v228, 2, v14
    v_lshlrev_b32 v18, 8, v2
    v_lshl_add_u32 v18, v1, 3, v18
    s_add_u32 s74, s84, 4096
    v_mov_b32 v14, 1
    v_mov_b32 v15, 0
    s_waitcnt vmcnt(0)
    s_mov_b64 exec, 1
    s_cmp_eq_u32 s91, 1
    s_cbranch_scc0 L_interleave_layers__spectral_fnet__dense_activation_squared_relu__prompt_kernel_far_17
    buffer_store_dword v14, v15, s[8:11], s74 offen
    s_branch L_interleave_layers__spectral_fnet__dense_activation_squared_relu__prompt_kernel_set_18
L_interleave_layers__spectral_fnet__dense_activation_squared_relu__prompt_kernel_far_17:
    buffer_store_dword v14, v15, s[8:11], s74 offen sc1
L_interleave_layers__spectral_fnet__dense_activation_squared_relu__prompt_kernel_set_18:
    s_mov_b64 exec, -1
    s_mul_i32 s52, s4, 34560
    s_lshl_b32 s53, s80, 2
    s_add_u32 s52, s52, s53
    s_add_u32 s52, s52, 524288
    s_cmp_eq_u32 s86, 0
    s_cselect_b32 s53, 27, 23
    v_min_u32 v16, s53, v0
    v_lshlrev_b32 v16, 4, v16
    s_mov_b64 exec, 0xfffffff
    buffer_load_dwordx4 v[180:183], v16, s[8:11], s52 offen sc1
    s_add_u32 s52, s52, 6912
    buffer_load_dwordx4 v[184:187], v16, s[8:11], s52 offen sc1
    s_add_u32 s52, s52, 6912
    buffer_load_dwordx4 v[188:191], v16, s[8:11], s52 offen sc1
    s_add_u32 s52, s52, 6912
    buffer_load_dwordx4 v[192:195], v16, s[8:11], s52 offen sc1
    s_add_u32 s52, s52, 6912
    buffer_load_dwordx4 v[196:199], v16, s[8:11], s52 offen sc1
    s_add_u32 s52, s52, 6912
    s_mov_b64 exec, -1
    s_lshl_b32 s58, s4, 12
    s_mul_i32 s57, s7, 143360
    s_add_u32 s57, s57, 37748736
    s_add_u32 s59, s58, 0
    s_add_u32 m0, s59, 0
    s_add_u32 s59, s59, s57
    buffer_load_dwordx4 v3, s[8:11], s59 offen offset:0 sc1 lds
    buffer_load_dwordx4 v3, s[8:11], s59 offen offset:1024 sc1 lds
    buffer_load_dwordx4 v3, s[8:11], s59 offen offset:2048 sc1 lds
    buffer_load_dwordx4 v3, s[8:11], s59 offen offset:3072 sc1 lds
    s_add_u32 s59, s58, 16384
    s_add_u32 m0, s59, 0
    s_add_u32 s59, s59, s57
    buffer_load_dwordx4 v3, s[8:11], s59 offen offset:0 sc1 lds
    buffer_load_dwordx4 v3, s[8:11], s59 offen offset:1024 sc1 lds
    buffer_load_dwordx4 v3, s[8:11], s59 offen offset:2048 sc1 lds
    buffer_load_dwordx4 v3, s[8:11], s59 offen offset:3072 sc1 lds
    s_add_u32 s59, s58, 32768
    s_add_u32 m0, s59, 0
    s_add_u32 s59, s59, s57
    buffer_load_dwordx4 v3, s[8:11], s59 offen offset:0 sc1 lds
    buffer_load_dwordx4 v3, s[8:11], s59 offen offset:1024 sc1 lds
    buffer_load_dwordx4 v3, s[8:11], s59 offen offset:2048 sc1 lds
    buffer_load_dwordx4 v3, s[8:11], s59 offen offset:3072 sc1 lds
    s_add_u32 s59, s58, 49152
    s_add_u32 m0, s59, 0
    s_add_u32 s59, s59, s57
    buffer_load_dwordx4 v3, s[8:11], s59 offen offset:0 sc1 lds
    buffer_load_dwordx4 v3, s[8:11], s59 offen offset:1024 sc1 lds
    buffer_load_dwordx4 v3, s[8:11], s59 offen offset:2048 sc1 lds
    buffer_load_dwordx4 v3, s[8:11], s59 offen offset:3072 sc1 lds
    s_waitcnt vmcnt(16)
    v_add_f32 v180, v180, v184
    v_add_f32 v181, v181, v185
    v_add_f32 v182, v182, v186
    v_add_f32 v183, v183, v187
    v_add_f32 v180, v180, v188
    v_add_f32 v181, v181, v189
    v_add_f32 v182, v182, v190
    v_add_f32 v183, v183, v191
    v_add_f32 v180, v180, v192
    v_add_f32 v181, v181, v193
    v_add_f32 v182, v182, v194
    v_add_f32 v183, v183, v195
    v_add_f32 v180, v180, v196
    v_add_f32 v181, v181, v197
    v_add_f32 v182, v182, v198
    v_add_f32 v183, v183, v199
    s_lshl_b32 s52, s4, 10
    s_add_u32 s52, s52, 143360
    v_add_u32 v14, s52, v3
    ds_write_b128 v14, v[180:183]
    v_add_u32 v14, 143360, v3
    v_lshlrev_b32 v158, 6, v0
    v_add_u32 v158, 153600, v158
    v_lshlrev_b32 v160, 16, v232
    v_and_b32 v161, 0xffff0000, v232
    v_lshlrev_b32 v162, 16, v233
    v_and_b32 v163, 0xffff0000, v233
    v_lshlrev_b32 v164, 16, v234
    v_and_b32 v165, 0xffff0000, v234
    v_lshlrev_b32 v166, 16, v235
    v_and_b32 v167, 0xffff0000, v235
    v_lshlrev_b32 v168, 16, v236
    v_lshlrev_b32 v169, 16, v237
    v_lshlrev_b32 v170, 16, v238
    v_lshlrev_b32 v171, 16, v239
    v_lshlrev_b32 v172, 16, v240
    v_lshlrev_b32 v173, 16, v241
    v_lshlrev_b32 v174, 16, v242
    v_lshlrev_b32 v175, 16, v243
    v_lshlrev_b32 v176, 16, v244
    v_lshlrev_b32 v177, 16, v245
    v_lshlrev_b32 v178, 16, v246
    v_lshlrev_b32 v179, 16, v247
    v_lshlrev_b32 v157, 4, v1
    v_add_u32 v157, 155968, v157
    v_mul_u32_u24 v159, 80, v2
    v_add_u32 v159, 155648, v159
    s_waitcnt lgkmcnt(0)
    v_mov_b32 v156, v14
L_interleave_layers__spectral_fnet__dense_activation_squared_relu__prompt_kernel_poll_19:
    buffer_load_dword v14, v228, s[8:11], s63 offen sc1
    s_waitcnt vmcnt(0)
    v_cmp_ne_u32 vcc, 1, v14
    s_nop 4
    s_cbranch_vccz L_interleave_layers__spectral_fnet__dense_activation_squared_relu__prompt_kernel_go_20
    s_cmp_eq_u32 s82, 0
    s_cbranch_scc1 L_interleave_layers__spectral_fnet__dense_activation_squared_relu__prompt_kernel_go_20
    s_sub_u32 s82, s82, 1
    s_branch L_interleave_layers__spectral_fnet__dense_activation_squared_relu__prompt_kernel_poll_19
L_interleave_layers__spectral_fnet__dense_activation_squared_relu__prompt_kernel_go_20:
    buffer_load_dwordx4 v[108:111], v3, s[8:11], s65 offen offset:0 sc1
    buffer_load_dwordx4 v[112:115], v3, s[8:11], s70 offen offset:0 sc1
    buffer_load_dwordx4 v[116:119], v3, s[8:11], s65 offen offset:1024 sc1
    buffer_load_dwordx4 v[120:123], v3, s[8:11], s70 offen offset:1024 sc1
    buffer_load_dwordx4 v[124:127], v3, s[8:11], s65 offen offset:2048 sc1
    buffer_load_dwordx4 v[128:131], v3, s[8:11], s70 offen offset:2048 sc1
    buffer_load_dwordx4 v[132:135], v3, s[8:11], s65 offen offset:3072 sc1
    buffer_load_dwordx4 v[136:139], v3, s[8:11], s70 offen offset:3072 sc1
    buffer_load_dwordx2 v[212:213], v18, s[8:11], s62 offen offset:0 sc1
    buffer_load_dwordx2 v[214:215], v18, s[8:11], s62 offen offset:128 sc1
    buffer_load_dwordx2 v[216:217], v18, s[8:11], s62 offen offset:1024 sc1
    buffer_load_dwordx2 v[218:219], v18, s[8:11], s62 offen offset:1152 sc1
    s_barrier
    ds_read_b128 v[20:23], v156 offset:0
    ds_read_b128 v[24:27], v156 offset:1024
    ds_read_b128 v[28:31], v156 offset:2048
    ds_read_b128 v[32:35], v156 offset:3072
    ds_write_b128 v159, v[160:163] offset:0
    ds_write_b128 v159, v[164:167] offset:16
    ds_write_b128 v159, v[168:171] offset:32
    ds_write_b128 v159, v[172:175] offset:48
    ds_write_b128 v159, v[176:179] offset:64
    ds_write_b128 v157, a[0:3]
    s_mov_b32 s53, 0xffff0000
    s_waitcnt lgkmcnt(0)
    v_add_f32 v20, v20, v24
    v_add_f32 v28, v28, v32
    v_add_f32 v20, v20, v28
    v_add_f32 v21, v21, v25
    v_add_f32 v29, v29, v33
    v_add_f32 v21, v21, v29
    v_add_f32 v22, v22, v26
    v_add_f32 v30, v30, v34
    v_add_f32 v22, v22, v30
    v_add_f32 v23, v23, v27
    v_add_f32 v31, v31, v35
    v_add_f32 v23, v23, v31
    v_cvt_pk_bf16_f32 v14, v20, v21
    v_lshlrev_b32 v16, 16, v14
    v_and_b32 v17, 0xffff0000, v14
    v_pk_add_f32 v[16:17], v[20:21], v[16:17] neg_lo:[0,1] neg_hi:[0,1]
    v_cvt_pk_bf16_f32 v15, v16, v17
    v_and_b32 v25, 0xffff, v248
    v_lshrrev_b32 v29, 16, v248
    v_and_b32 v16, 0xffff, v14
    v_lshl_or_b32 v24, v15, 16, v16
    v_lshrrev_b32 v16, 16, v14
    v_and_or_b32 v28, v15, s53, v16
    v_mov_b32 v26, 0
    v_mov_b32 v27, 0
    v_mov_b32 v30, 0
    v_mov_b32 v31, 0
    v_cvt_pk_bf16_f32 v14, v22, v23
    v_lshlrev_b32 v16, 16, v14
    v_and_b32 v17, 0xffff0000, v14
    v_pk_add_f32 v[16:17], v[22:23], v[16:17] neg_lo:[0,1] neg_hi:[0,1]
    v_cvt_pk_bf16_f32 v15, v16, v17
    v_and_b32 v33, 0xffff, v249
    v_lshrrev_b32 v37, 16, v249
    v_and_b32 v16, 0xffff, v14
    v_lshl_or_b32 v32, v15, 16, v16
    v_lshrrev_b32 v16, 16, v14
    v_and_or_b32 v36, v15, s53, v16
    v_mov_b32 v34, 0
    v_mov_b32 v35, 0
    v_mov_b32 v38, 0
    v_mov_b32 v39, 0
    s_mov_b64 exec, 0xfffffff
    ds_write_b128 v158, v[24:27] offset:0
    ds_write_b128 v158, v[28:31] offset:16
    ds_write_b128 v158, v[32:35] offset:32
    ds_write_b128 v158, v[36:39] offset:48
    s_mov_b64 exec, -1
    ds_read_b128 v[76:79], v3 offset:0
    ds_read_b128 v[80:83], v3 offset:1024
    ds_read_b128 v[84:87], v3 offset:2048
    ds_read_b128 v[88:91], v3 offset:3072
    ds_read_b128 v[92:95], v3 offset:4096
    ds_read_b128 v[96:99], v3 offset:5120
    ds_read_b128 v[100:103], v3 offset:6144
    s_waitcnt vmcnt(10) lgkmcnt(5)
    v_mfma_f32_16x16x32_bf16 v[20:23], v[76:79], v[108:111], 0
    v_mfma_f32_16x16x32_bf16 v[48:51], v[76:79], v[112:115], 0
    ds_read_b128 v[104:107], v3 offset:7168
    v_mfma_f32_16x16x32_bf16 v[24:27], v[80:83], v[108:111], 0
    buffer_load_dwordx4 v[140:143], v3, s[8:11], s66 offen offset:0 sc1
    v_mfma_f32_16x16x32_bf16 v[52:55], v[80:83], v[112:115], 0
    ds_read_b128 v[76:79], v3 offset:8192
    s_waitcnt lgkmcnt(5)
    v_mfma_f32_16x16x32_bf16 v[28:31], v[84:87], v[108:111], 0
    buffer_load_dwordx4 v[144:147], v3, s[8:11], s71 offen offset:0 sc1
    v_mfma_f32_16x16x32_bf16 v[56:59], v[84:87], v[112:115], 0
    ds_read_b128 v[80:83], v3 offset:9216
    v_mfma_f32_16x16x32_bf16 v[32:35], v[88:91], v[108:111], 0
    buffer_load_dwordx4 v[148:151], v3, s[8:11], s66 offen offset:1024 sc1
    v_mfma_f32_16x16x32_bf16 v[60:63], v[88:91], v[112:115], 0
    ds_read_b128 v[84:87], v3 offset:10240
    s_waitcnt lgkmcnt(5)
    v_mfma_f32_16x16x32_bf16 v[36:39], v[92:95], v[108:111], 0
    v_mfma_f32_16x16x32_bf16 v[64:67], v[92:95], v[112:115], 0
    ds_read_b128 v[88:91], v3 offset:11264
    v_mfma_f32_16x16x32_bf16 v[40:43], v[96:99], v[108:111], 0
    buffer_load_dwordx4 v[152:155], v3, s[8:11], s71 offen offset:1024 sc1
    v_mfma_f32_16x16x32_bf16 v[68:71], v[96:99], v[112:115], 0
    ds_read_b128 v[92:95], v3 offset:12288
    s_waitcnt lgkmcnt(5)
    v_mfma_f32_16x16x32_bf16 v[44:47], v[100:103], v[108:111], 0
    buffer_load_dwordx4 v[156:159], v3, s[8:11], s66 offen offset:2048 sc1
    v_mfma_f32_16x16x32_bf16 v[72:75], v[100:103], v[112:115], 0
    ds_read_b128 v[96:99], v3 offset:13312
    s_waitcnt vmcnt(13)
    v_mfma_f32_16x16x32_bf16 v[20:23], v[104:107], v[116:119], v[20:23]
    buffer_load_dwordx4 v[160:163], v3, s[8:11], s71 offen offset:2048 sc1
    v_mfma_f32_16x16x32_bf16 v[48:51], v[104:107], v[120:123], v[48:51]
    ds_read_b128 v[100:103], v3 offset:14336
    s_waitcnt lgkmcnt(5)
    v_mfma_f32_16x16x32_bf16 v[24:27], v[76:79], v[116:119], v[24:27]
    v_mfma_f32_16x16x32_bf16 v[52:55], v[76:79], v[120:123], v[52:55]
    ds_read_b128 v[104:107], v3 offset:15360
    v_mfma_f32_16x16x32_bf16 v[28:31], v[80:83], v[116:119], v[28:31]
    s_add_u32 s59, s58, 65536
    s_add_u32 m0, s59, 0
    s_add_u32 s59, s59, s57
    buffer_load_dwordx4 v3, s[8:11], s59 offen offset:0 sc1 lds
    v_mfma_f32_16x16x32_bf16 v[56:59], v[80:83], v[120:123], v[56:59]
    ds_read_b128 v[76:79], v3 offset:16384
    s_waitcnt lgkmcnt(5)
    v_mfma_f32_16x16x32_bf16 v[32:35], v[84:87], v[116:119], v[32:35]
    buffer_load_dwordx4 v3, s[8:11], s59 offen offset:1024 sc1 lds
    v_mfma_f32_16x16x32_bf16 v[60:63], v[84:87], v[120:123], v[60:63]
    ds_read_b128 v[80:83], v3 offset:17408
    v_mfma_f32_16x16x32_bf16 v[36:39], v[88:91], v[116:119], v[36:39]
    buffer_load_dwordx4 v3, s[8:11], s59 offen offset:2048 sc1 lds
    v_mfma_f32_16x16x32_bf16 v[64:67], v[88:91], v[120:123], v[64:67]
    ds_read_b128 v[84:87], v3 offset:18432
    s_waitcnt lgkmcnt(5)
    v_mfma_f32_16x16x32_bf16 v[40:43], v[92:95], v[116:119], v[40:43]
    v_mfma_f32_16x16x32_bf16 v[68:71], v[92:95], v[120:123], v[68:71]
    ds_read_b128 v[88:91], v3 offset:19456
    v_mfma_f32_16x16x32_bf16 v[44:47], v[96:99], v[116:119], v[44:47]
    buffer_load_dwordx4 v3, s[8:11], s59 offen offset:3072 sc1 lds
    v_mfma_f32_16x16x32_bf16 v[72:75], v[96:99], v[120:123], v[72:75]
    ds_read_b128 v[92:95], v3 offset:20480
    s_waitcnt vmcnt(16) lgkmcnt(5)
    v_mfma_f32_16x16x32_bf16 v[20:23], v[100:103], v[124:127], v[20:23]
    s_add_u32 s59, s58, 81920
    s_add_u32 m0, s59, 0
    s_add_u32 s59, s59, s57
    buffer_load_dwordx4 v3, s[8:11], s59 offen offset:0 sc1 lds
    v_mfma_f32_16x16x32_bf16 v[48:51], v[100:103], v[128:131], v[48:51]
    ds_read_b128 v[96:99], v3 offset:21504
    v_mfma_f32_16x16x32_bf16 v[24:27], v[104:107], v[124:127], v[24:27]
    buffer_load_dwordx4 v3, s[8:11], s59 offen offset:1024 sc1 lds
    v_mfma_f32_16x16x32_bf16 v[52:55], v[104:107], v[128:131], v[52:55]
    ds_read_b128 v[100:103], v3 offset:22528
    s_waitcnt lgkmcnt(5)
    v_mfma_f32_16x16x32_bf16 v[28:31], v[76:79], v[124:127], v[28:31]
    v_mfma_f32_16x16x32_bf16 v[56:59], v[76:79], v[128:131], v[56:59]
    ds_read_b128 v[104:107], v3 offset:23552
    v_mfma_f32_16x16x32_bf16 v[32:35], v[80:83], v[124:127], v[32:35]
    buffer_load_dwordx4 v3, s[8:11], s59 offen offset:2048 sc1 lds
    v_mfma_f32_16x16x32_bf16 v[60:63], v[80:83], v[128:131], v[60:63]
    ds_read_b128 v[76:79], v3 offset:24576
    s_waitcnt lgkmcnt(5)
    v_mfma_f32_16x16x32_bf16 v[36:39], v[84:87], v[124:127], v[36:39]
    buffer_load_dwordx4 v3, s[8:11], s59 offen offset:3072 sc1 lds
    v_mfma_f32_16x16x32_bf16 v[64:67], v[84:87], v[128:131], v[64:67]
    ds_read_b128 v[80:83], v3 offset:25600
    v_mfma_f32_16x16x32_bf16 v[40:43], v[88:91], v[124:127], v[40:43]
    buffer_load_dwordx4 v[164:167], v3, s[8:11], s66 offen offset:3072 sc1
    v_mfma_f32_16x16x32_bf16 v[68:71], v[88:91], v[128:131], v[68:71]
    ds_read_b128 v[84:87], v3 offset:26624
    s_waitcnt lgkmcnt(5)
    v_mfma_f32_16x16x32_bf16 v[44:47], v[92:95], v[124:127], v[44:47]
    v_mfma_f32_16x16x32_bf16 v[72:75], v[92:95], v[128:131], v[72:75]
    ds_read_b128 v[88:91], v3 offset:27648
    s_waitcnt vmcnt(19)
    v_mfma_f32_16x16x32_bf16 v[20:23], v[96:99], v[132:135], v[20:23]
    buffer_load_dwordx4 v[168:171], v3, s[8:11], s71 offen offset:3072 sc1
    s_waitcnt vmcnt(16)
    v_mfma_f32_16x16x32_bf16 v[48:51], v[96:99], v[136:139], v[48:51]
    ds_read_b128 v[92:95], v3 offset:28672
    s_waitcnt lgkmcnt(5)
    v_mfma_f32_16x16x32_bf16 v[24:27], v[100:103], v[132:135], v[24:27]
    buffer_load_dwordx4 v[172:175], v3, s[8:11], s67 offen offset:0 sc1
    v_add_f32 v220, v212, v214
    v_mfma_f32_16x16x32_bf16 v[52:55], v[100:103], v[136:139], v[52:55]
    ds_read_b128 v[96:99], v3 offset:29696
    v_add_f32 v222, v216, v218
    v_mfma_f32_16x16x32_bf16 v[28:31], v[104:107], v[132:135], v[28:31]
    buffer_load_dwordx4 v[176:179], v3, s[8:11], s72 offen offset:0 sc1
    v_add_f32 v221, v213, v215
    v_mfma_f32_16x16x32_bf16 v[56:59], v[104:107], v[136:139], v[56:59]
    ds_read_b128 v[100:103], v3 offset:30720
    s_waitcnt lgkmcnt(5)
    v_mfma_f32_16x16x32_bf16 v[32:35], v[76:79], v[132:135], v[32:35]
    v_add_f32 v223, v217, v219
    v_mfma_f32_16x16x32_bf16 v[60:63], v[76:79], v[136:139], v[60:63]
    ds_read_b128 v[104:107], v3 offset:31744
    v_mfma_f32_16x16x32_bf16 v[36:39], v[80:83], v[132:135], v[36:39]
    s_add_u32 s59, s58, 98304
    s_add_u32 m0, s59, 0
    s_add_u32 s59, s59, s57
    buffer_load_dwordx4 v3, s[8:11], s59 offen offset:0 sc1 lds
    v_mfma_f32_16x16x32_bf16 v[64:67], v[80:83], v[136:139], v[64:67]
    ds_read_b128 v[76:79], v3 offset:32768
    s_waitcnt lgkmcnt(5)
    v_mfma_f32_16x16x32_bf16 v[40:43], v[84:87], v[132:135], v[40:43]
    buffer_load_dwordx4 v3, s[8:11], s59 offen offset:1024 sc1 lds
    v_mfma_f32_16x16x32_bf16 v[68:71], v[84:87], v[136:139], v[68:71]
    ds_read_b128 v[80:83], v3 offset:33792
    v_mfma_f32_16x16x32_bf16 v[44:47], v[88:91], v[132:135], v[44:47]
    buffer_load_dwordx4 v3, s[8:11], s59 offen offset:2048 sc1 lds
    v_mfma_f32_16x16x32_bf16 v[72:75], v[88:91], v[136:139], v[72:75]
    ds_read_b128 v[84:87], v3 offset:34816
    s_waitcnt vmcnt(19) lgkmcnt(5)
    v_mfma_f32_16x16x32_bf16 v[20:23], v[92:95], v[140:143], v[20:23]
    v_permlane32_swap_b32 v220, v222
    v_mfma_f32_16x16x32_bf16 v[48:51], v[92:95], v[144:147], v[48:51]
    ds_read_b128 v[88:91], v3 offset:35840
    v_mfma_f32_16x16x32_bf16 v[24:27], v[96:99], v[140:143], v[24:27]
    buffer_load_dwordx4 v3, s[8:11], s59 offen offset:3072 sc1 lds
    v_mfma_f32_16x16x32_bf16 v[52:55], v[96:99], v[144:147], v[52:55]
    ds_read_b128 v[92:95], v3 offset:36864
    s_waitcnt lgkmcnt(5)
    v_mfma_f32_16x16x32_bf16 v[28:31], v[100:103], v[140:143], v[28:31]
    s_add_u32 s59, s58, 114688
    s_add_u32 m0, s59, 0
    s_add_u32 s59, s59, s57
    buffer_load_dwordx4 v3, s[8:11], s59 offen offset:0 sc1 lds
    v_mfma_f32_16x16x32_bf16 v[56:59], v[100:103], v[144:147], v[56:59]
    ds_read_b128 v[96:99], v3 offset:37888
    v_mfma_f32_16x16x32_bf16 v[32:35], v[104:107], v[140:143], v[32:35]
    buffer_load_dwordx4 v3, s[8:11], s59 offen offset:1024 sc1 lds
    v_mfma_f32_16x16x32_bf16 v[60:63], v[104:107], v[144:147], v[60:63]
    ds_read_b128 v[100:103], v3 offset:38912
    s_waitcnt lgkmcnt(5)
    v_mfma_f32_16x16x32_bf16 v[36:39], v[76:79], v[140:143], v[36:39]
    v_permlane32_swap_b32 v221, v223
    v_mfma_f32_16x16x32_bf16 v[64:67], v[76:79], v[144:147], v[64:67]
    ds_read_b128 v[104:107], v3 offset:39936
    v_add_f32 v220, v220, v222
    v_mfma_f32_16x16x32_bf16 v[40:43], v[80:83], v[140:143], v[40:43]
    buffer_load_dwordx4 v3, s[8:11], s59 offen offset:2048 sc1 lds
    v_add_f32 v221, v221, v223
    v_mfma_f32_16x16x32_bf16 v[68:71], v[80:83], v[144:147], v[68:71]
    ds_read_b128 v[76:79], v3 offset:40960
    s_waitcnt lgkmcnt(5)
    v_mfma_f32_16x16x32_bf16 v[44:47], v[84:87], v[140:143], v[44:47]
    buffer_load_dwordx4 v3, s[8:11], s59 offen offset:3072 sc1 lds
    v_mov_b32 v222, v220
    v_mfma_f32_16x16x32_bf16 v[72:75], v[84:87], v[144:147], v[72:75]
    ds_read_b128 v[80:83], v3 offset:41984
    s_waitcnt vmcnt(22)
    v_mfma_f32_16x16x32_bf16 v[20:23], v[88:91], v[148:151], v[20:23]
    s_add_u32 s59, s58, 131072
    s_min_u32 s59, s59, 139264
    s_add_u32 m0, s59, 0
    s_add_u32 s59, s59, s57
    buffer_load_dwordx4 v3, s[8:11], s59 offen offset:0 sc1 lds
    v_mfma_f32_16x16x32_bf16 v[48:51], v[88:91], v[152:155], v[48:51]
    ds_read_b128 v[84:87], v3 offset:43008
    s_waitcnt lgkmcnt(5)
    v_mfma_f32_16x16x32_bf16 v[24:27], v[92:95], v[148:151], v[24:27]
    v_mov_b32 v223, v221
    v_mfma_f32_16x16x32_bf16 v[52:55], v[92:95], v[152:155], v[52:55]
    ds_read_b128 v[88:91], v3 offset:44032
    v_mfma_f32_16x16x32_bf16 v[28:31], v[96:99], v[148:151], v[28:31]
    buffer_load_dwordx4 v3, s[8:11], s59 offen offset:1024 sc1 lds
    v_mfma_f32_16x16x32_bf16 v[56:59], v[96:99], v[152:155], v[56:59]
    ds_read_b128 v[92:95], v3 offset:45056
    s_waitcnt lgkmcnt(5)
    v_mfma_f32_16x16x32_bf16 v[32:35], v[100:103], v[148:151], v[32:35]
    buffer_load_dwordx4 v3, s[8:11], s59 offen offset:2048 sc1 lds
    v_mfma_f32_16x16x32_bf16 v[60:63], v[100:103], v[152:155], v[60:63]
    ds_read_b128 v[96:99], v3 offset:46080
    v_mfma_f32_16x16x32_bf16 v[36:39], v[104:107], v[148:151], v[36:39]
    buffer_load_dwordx4 v3, s[8:11], s59 offen offset:3072 sc1 lds
    v_mfma_f32_16x16x32_bf16 v[64:67], v[104:107], v[152:155], v[64:67]
    ds_read_b128 v[100:103], v3 offset:47104
    s_waitcnt lgkmcnt(5)
    v_mfma_f32_16x16x32_bf16 v[40:43], v[76:79], v[148:151], v[40:43]
    v_permlane16_swap_b32 v220, v222
    v_mfma_f32_16x16x32_bf16 v[68:71], v[76:79], v[152:155], v[68:71]
    ds_read_b128 v[104:107], v3 offset:48128
    v_mfma_f32_16x16x32_bf16 v[44:47], v[80:83], v[148:151], v[44:47]
    buffer_load_dwordx4 v[180:183], v3, s[8:11], s67 offen offset:1024 sc1
    v_mfma_f32_16x16x32_bf16 v[72:75], v[80:83], v[152:155], v[72:75]
    ds_read_b128 v[76:79], v3 offset:49152
    s_waitcnt vmcnt(25) lgkmcnt(5)
    v_mfma_f32_16x16x32_bf16 v[20:23], v[84:87], v[156:159], v[20:23]
    buffer_load_dwordx4 v[184:187], v3, s[8:11], s72 offen offset:1024 sc1
    v_mfma_f32_16x16x32_bf16 v[48:51], v[84:87], v[160:163], v[48:51]
    ds_read_b128 v[80:83], v3 offset:50176
    v_mfma_f32_16x16x32_bf16 v[24:27], v[88:91], v[156:159], v[24:27]
    buffer_load_dwordx4 v[188:191], v3, s[8:11], s67 offen offset:2048 sc1
    v_mfma_f32_16x16x32_bf16 v[52:55], v[88:91], v[160:163], v[52:55]
    ds_read_b128 v[84:87], v3 offset:51200
    s_waitcnt lgkmcnt(5)
    v_mfma_f32_16x16x32_bf16 v[28:31], v[92:95], v[156:159], v[28:31]
    v_permlane16_swap_b32 v221, v223
    v_mfma_f32_16x16x32_bf16 v[56:59], v[92:95], v[160:163], v[56:59]
    ds_read_b128 v[88:91], v3 offset:52224
    v_add_f32 v220, v220, v222
    v_mfma_f32_16x16x32_bf16 v[32:35], v[96:99], v[156:159], v[32:35]
    buffer_load_dwordx4 v[192:195], v3, s[8:11], s72 offen offset:2048 sc1
    v_add_f32 v221, v221, v223
    v_mfma_f32_16x16x32_bf16 v[60:63], v[96:99], v[160:163], v[60:63]
    ds_read_b128 v[92:95], v3 offset:53248
    s_waitcnt lgkmcnt(5)
    v_mfma_f32_16x16x32_bf16 v[36:39], v[100:103], v[156:159], v[36:39]
    buffer_load_dwordx4 v[196:199], v3, s[8:11], s67 offen offset:3072 sc1
    v_mul_f32 v220, 0.0015625, v220
    v_mfma_f32_16x16x32_bf16 v[64:67], v[100:103], v[160:163], v[64:67]
    ds_read_b128 v[96:99], v3 offset:54272
    v_mul_f32 v221, 0.0015625, v221
    v_mfma_f32_16x16x32_bf16 v[40:43], v[104:107], v[156:159], v[40:43]
    buffer_load_dwordx4 v[200:203], v3, s[8:11], s72 offen offset:3072 sc1
    v_fma_f32 v221, -v220, v220, v221
    v_mfma_f32_16x16x32_bf16 v[68:71], v[104:107], v[160:163], v[68:71]
    ds_read_b128 v[100:103], v3 offset:55296
    s_waitcnt lgkmcnt(5)
    v_mfma_f32_16x16x32_bf16 v[44:47], v[76:79], v[156:159], v[44:47]
    v_max_f32 v221, 0, v221
    v_cvt_pk_bf16_f32 v14, v220, v221
    v_mfma_f32_16x16x32_bf16 v[72:75], v[76:79], v[160:163], v[72:75]
    ds_read_b128 v[104:107], v3 offset:56320
    s_waitcnt vmcnt(20)
    v_mfma_f32_16x16x32_bf16 v[20:23], v[80:83], v[164:167], v[20:23]
    buffer_load_dwordx4 v[108:111], v3, s[8:11], s68 offen offset:0 sc1
    v_lshlrev_b32 v220, 16, v14
    v_mfma_f32_16x16x32_bf16 v[48:51], v[80:83], v[168:171], v[48:51]
    ds_read_b128 v[76:79], v226 offset:0
    s_waitcnt lgkmcnt(5)
    v_mfma_f32_16x16x32_bf16 v[24:27], v[84:87], v[164:167], v[24:27]
    buffer_load_dwordx4 v[112:115], v3, s[8:11], s73 offen offset:0 sc1
    v_and_b32 v221, 0xffff0000, v14
    v_mfma_f32_16x16x32_bf16 v[52:55], v[84:87], v[168:171], v[52:55]
    ds_read_b128 v[80:83], v226 offset:256
    v_add_f32 v221, 0x3727c5ac, v221
    v_mfma_f32_16x16x32_bf16 v[28:31], v[88:91], v[164:167], v[28:31]
    buffer_load_dwordx4 v[116:119], v3, s[8:11], s68 offen offset:1024 sc1
    v_cvt_pk_bf16_f32 v14, v221, v221
    v_mfma_f32_16x16x32_bf16 v[56:59], v[88:91], v[168:171], v[56:59]
    ds_read_b128 v[84:87], v226 offset:512
    s_waitcnt lgkmcnt(5)
    v_mfma_f32_16x16x32_bf16 v[32:35], v[92:95], v[164:167], v[32:35]
    v_lshlrev_b32 v221, 16, v14
    v_mfma_f32_16x16x32_bf16 v[60:63], v[92:95], v[168:171], v[60:63]
    ds_read_b128 v[88:91], v226 offset:768
    v_mfma_f32_16x16x32_bf16 v[36:39], v[96:99], v[164:167], v[36:39]
    buffer_load_dwordx4 v[120:123], v3, s[8:11], s73 offen offset:1024 sc1
    v_mfma_f32_16x16x32_bf16 v[64:67], v[96:99], v[168:171], v[64:67]
    ds_read_b128 v[92:95], v226 offset:1024
    s_waitcnt lgkmcnt(5)
    v_mfma_f32_16x16x32_bf16 v[40:43], v[100:103], v[164:167], v[40:43]
    buffer_load_dwordx4 v[124:127], v3, s[8:11], s68 offen offset:2048 sc1
    v_mfma_f32_16x16x32_bf16 v[68:71], v[100:103], v[168:171], v[68:71]
    ds_read_b128 v[96:99], v226 offset:1280
    v_mfma_f32_16x16x32_bf16 v[44:47], v[104:107], v[164:167], v[44:47]
    buffer_load_dwordx4 v[128:131], v3, s[8:11], s73 offen offset:2048 sc1
    v_mfma_f32_16x16x32_bf16 v[72:75], v[104:107], v[168:171], v[72:75]
    ds_read_b128 v[100:103], v226 offset:1536
    v_sqrt_f32 v221, v221
    s_nop 0
    v_cvt_pk_bf16_f32 v14, v221, v221
    v_lshlrev_b32 v221, 16, v14
    v_mov_b32 v222, v220
    v_mov_b32 v223, v221
    s_nop 0
    v_permlane32_swap_b32 v220, v222
    v_permlane32_swap_b32 v221, v223
    v_cmp_eq_u32 vcc, 0, v2
    v_cvt_pk_bf16_f32 v14, -v220, -v220
    v_lshrrev_b32 v15, 16, v221
    v_cndmask_b32 v212, 0, v14, vcc
    v_cndmask_b32 v213, 0, v15, vcc
    v_mov_b32 v214, 0
    v_mov_b32 v215, 0
    v_cvt_pk_bf16_f32 v14, -v222, -v222
    v_lshrrev_b32 v15, 16, v223
    v_cndmask_b32 v216, 0, v14, vcc
    v_cndmask_b32 v217, 0, v15, vcc
    v_mov_b32 v218, 0
    v_mov_b32 v219, 0
    s_waitcnt lgkmcnt(5)
    v_mfma_f32_16x16x32_bf16 v[20:23], v[76:79], v[212:215], v[20:23]
    v_mfma_f32_16x16x32_bf16 v[48:51], v[76:79], v[216:219], v[48:51]
    ds_read_b128 v[104:107], v3 offset:57344
    v_mfma_f32_16x16x32_bf16 v[24:27], v[80:83], v[212:215], v[24:27]
    buffer_load_dwordx4 v[132:135], v3, s[8:11], s68 offen offset:3072 sc1
    v_mfma_f32_16x16x32_bf16 v[52:55], v[80:83], v[216:219], v[52:55]
    ds_read_b128 v[76:79], v3 offset:58368
    s_waitcnt lgkmcnt(5)
    v_mfma_f32_16x16x32_bf16 v[28:31], v[84:87], v[212:215], v[28:31]
    buffer_load_dwordx4 v[136:139], v3, s[8:11], s73 offen offset:3072 sc1
    v_mfma_f32_16x16x32_bf16 v[56:59], v[84:87], v[216:219], v[56:59]
    ds_read_b128 v[80:83], v3 offset:59392
    v_mfma_f32_16x16x32_bf16 v[32:35], v[88:91], v[212:215], v[32:35]
    buffer_load_dwordx4 v[140:143], v3, s[8:11], s69 offen offset:0 sc1
    v_mfma_f32_16x16x32_bf16 v[60:63], v[88:91], v[216:219], v[60:63]
    ds_read_b128 v[84:87], v3 offset:60416
    s_waitcnt lgkmcnt(5)
    v_mfma_f32_16x16x32_bf16 v[36:39], v[92:95], v[212:215], v[36:39]
    v_mfma_f32_16x16x32_bf16 v[64:67], v[92:95], v[216:219], v[64:67]
    ds_read_b128 v[88:91], v3 offset:61440
    v_mfma_f32_16x16x32_bf16 v[40:43], v[96:99], v[212:215], v[40:43]
    buffer_load_dwordx4 v[144:147], v3, s[8:11], s60 offen offset:0 sc1
    v_mfma_f32_16x16x32_bf16 v[68:71], v[96:99], v[216:219], v[68:71]
    ds_read_b128 v[92:95], v3 offset:62464
    s_waitcnt lgkmcnt(5)
    v_mfma_f32_16x16x32_bf16 v[44:47], v[100:103], v[212:215], v[44:47]
    buffer_load_dwordx4 v[148:151], v3, s[8:11], s69 offen offset:1024 sc1
    v_mfma_f32_16x16x32_bf16 v[72:75], v[100:103], v[216:219], v[72:75]
    ds_read_b128 v[96:99], v3 offset:63488
    s_waitcnt vmcnt(29)
    v_mfma_f32_16x16x32_bf16 v[20:23], v[104:107], v[172:175], v[20:23]
    buffer_load_dwordx4 v[152:155], v3, s[8:11], s60 offen offset:1024 sc1
    v_mfma_f32_16x16x32_bf16 v[48:51], v[104:107], v[176:179], v[48:51]
    ds_read_b128 v[100:103], v224 offset:0
    s_waitcnt lgkmcnt(5)
    v_mfma_f32_16x16x32_bf16 v[24:27], v[76:79], v[172:175], v[24:27]
    v_mfma_f32_16x16x32_bf16 v[52:55], v[76:79], v[176:179], v[52:55]
    s_barrier
    ds_read_b128 v[104:107], v224 offset:1024
    v_mfma_f32_16x16x32_bf16 v[28:31], v[80:83], v[172:175], v[28:31]
    buffer_load_dwordx4 v[156:159], v3, s[8:11], s69 offen offset:2048 sc1
    v_mfma_f32_16x16x32_bf16 v[56:59], v[80:83], v[176:179], v[56:59]
    ds_read_b128 v[76:79], v224 offset:2048
    s_waitcnt lgkmcnt(5)
    v_mfma_f32_16x16x32_bf16 v[32:35], v[84:87], v[172:175], v[32:35]
    buffer_load_dwordx4 v[160:163], v3, s[8:11], s60 offen offset:2048 sc1
    v_mfma_f32_16x16x32_bf16 v[60:63], v[84:87], v[176:179], v[60:63]
    ds_read_b128 v[80:83], v224 offset:3072
    v_mfma_f32_16x16x32_bf16 v[36:39], v[88:91], v[172:175], v[36:39]
    buffer_load_dwordx4 v[164:167], v3, s[8:11], s69 offen offset:3072 sc1
    v_mfma_f32_16x16x32_bf16 v[64:67], v[88:91], v[176:179], v[64:67]
    ds_read_b128 v[84:87], v224 offset:4096
    s_waitcnt lgkmcnt(5)
    v_mfma_f32_16x16x32_bf16 v[40:43], v[92:95], v[172:175], v[40:43]
    v_mfma_f32_16x16x32_bf16 v[68:71], v[92:95], v[176:179], v[68:71]
    ds_read_b128 v[88:91], v224 offset:5120
    v_mfma_f32_16x16x32_bf16 v[44:47], v[96:99], v[172:175], v[44:47]
    buffer_load_dwordx4 v[168:171], v3, s[8:11], s60 offen offset:3072 sc1
    v_mfma_f32_16x16x32_bf16 v[72:75], v[96:99], v[176:179], v[72:75]
    ds_read_b128 v[92:95], v224 offset:6144
    s_waitcnt vmcnt(20) lgkmcnt(5)
    v_mfma_f32_16x16x32_bf16 v[20:23], v[100:103], v[180:183], v[20:23]
    s_mul_i32 s77, s6, 54
    s_add_u32 s77, s77, s90
    s_mul_i32 s77, s77, 5120
    s_add_u32 s77, s77, 1048576
    s_add_u32 s76, s77, 0
    buffer_load_dwordx4 a[0:3], v3, s[8:11], s76 offen offset:0 sc1
    v_mfma_f32_16x16x32_bf16 v[48:51], v[100:103], v[184:187], v[48:51]
    ds_read_b128 v[96:99], v224 offset:7168
    v_mfma_f32_16x16x32_bf16 v[24:27], v[104:107], v[180:183], v[24:27]
    buffer_load_dwordx4 a[4:7], v3, s[8:11], s76 offen offset:1024 sc1
    v_mfma_f32_16x16x32_bf16 v[52:55], v[104:107], v[184:187], v[52:55]
    ds_read_b128 v[100:103], v224 offset:14336
    s_waitcnt lgkmcnt(5)
    v_mfma_f32_16x16x32_bf16 v[28:31], v[76:79], v[180:183], v[28:31]
    v_mfma_f32_16x16x32_bf16 v[56:59], v[76:79], v[184:187], v[56:59]
    ds_read_b128 v[104:107], v224 offset:21504
    v_mfma_f32_16x16x32_bf16 v[32:35], v[80:83], v[180:183], v[32:35]
    buffer_load_dwordx4 a[8:11], v3, s[8:11], s76 offen offset:2048 sc1
    v_mfma_f32_16x16x32_bf16 v[60:63], v[80:83], v[184:187], v[60:63]
    ds_read_b128 v[76:79], v224 offset:28672
    s_waitcnt lgkmcnt(5)
    v_mfma_f32_16x16x32_bf16 v[36:39], v[84:87], v[180:183], v[36:39]
    buffer_load_dwordx4 a[12:15], v3, s[8:11], s76 offen offset:3072 sc1
    v_mfma_f32_16x16x32_bf16 v[64:67], v[84:87], v[184:187], v[64:67]
    s_barrier
    ds_read_b128 v[80:83], v224 offset:35840
    v_mfma_f32_16x16x32_bf16 v[40:43], v[88:91], v[180:183], v[40:43]
    s_add_u32 s76, s76, 4096
    buffer_load_dwordx4 a[16:19], v3, s[8:11], s76 offen offset:0 sc1
    v_mfma_f32_16x16x32_bf16 v[68:71], v[88:91], v[184:187], v[68:71]
    ds_read_b128 v[84:87], v224 offset:43008
    s_waitcnt lgkmcnt(5)
    v_mfma_f32_16x16x32_bf16 v[44:47], v[92:95], v[180:183], v[44:47]
    v_mfma_f32_16x16x32_bf16 v[72:75], v[92:95], v[184:187], v[72:75]
    ds_read_b128 v[88:91], v224 offset:50176
    s_waitcnt vmcnt(23)
    v_mfma_f32_16x16x32_bf16 v[20:23], v[96:99], v[188:191], v[20:23]
    s_add_u32 s76, s77, 5120
    buffer_load_dwordx4 a[20:23], v3, s[8:11], s76 offen offset:0 sc1
    v_mfma_f32_16x16x32_bf16 v[48:51], v[96:99], v[192:195], v[48:51]
    ds_read_b128 v[92:95], v224 offset:57344
    s_waitcnt vmcnt(22) lgkmcnt(5)
    v_mfma_f32_16x16x32_bf16 v[20:23], v[100:103], v[196:199], v[20:23]
    buffer_load_dwordx4 a[24:27], v3, s[8:11], s76 offen offset:1024 sc1
    buffer_load_dwordx2 v[228:229], v18, s[8:11], s75 offen offset:0 sc1
    v_mfma_f32_16x16x32_bf16 v[48:51], v[100:103], v[200:203], v[48:51]
    ds_read_b128 v[96:99], v225 offset:0
    s_waitcnt vmcnt(22)
    v_mfma_f32_16x16x32_bf16 v[20:23], v[104:107], v[108:111], v[20:23]
    buffer_load_dwordx4 a[28:31], v3, s[8:11], s76 offen offset:2048 sc1
    buffer_load_dwordx2 v[230:231], v18, s[8:11], s75 offen offset:128 sc1
    v_mfma_f32_16x16x32_bf16 v[48:51], v[104:107], v[112:115], v[48:51]
    s_barrier
    ds_read_b128 v[100:103], v225 offset:7168
    s_waitcnt vmcnt(22) lgkmcnt(5)
    v_mfma_f32_16x16x32_bf16 v[20:23], v[76:79], v[116:119], v[20:23]
    v_mfma_f32_16x16x32_bf16 v[48:51], v[76:79], v[120:123], v[48:51]
    ds_read_b128 v[104:107], v224 offset:8192
    s_waitcnt vmcnt(20)
    v_mfma_f32_16x16x32_bf16 v[20:23], v[80:83], v[124:127], v[20:23]
    buffer_load_dwordx4 a[32:35], v3, s[8:11], s76 offen offset:3072 sc1
    v_mfma_f32_16x16x32_bf16 v[48:51], v[80:83], v[128:131], v[48:51]
    ds_read_b128 v[76:79], v224 offset:15360
    s_waitcnt vmcnt(19) lgkmcnt(5)
    v_mfma_f32_16x16x32_bf16 v[20:23], v[84:87], v[132:135], v[20:23]
    s_add_u32 s76, s76, 4096
    buffer_load_dwordx4 a[36:39], v3, s[8:11], s76 offen offset:0 sc1
    v_mfma_f32_16x16x32_bf16 v[48:51], v[84:87], v[136:139], v[48:51]
    ds_read_b128 v[80:83], v224 offset:22528
    s_waitcnt vmcnt(18)
    v_mfma_f32_16x16x32_bf16 v[20:23], v[88:91], v[140:143], v[20:23]
    s_add_u32 s76, s77, 20480
    buffer_load_dwordx4 a[80:83], v3, s[8:11], s76 offen offset:0 sc1
    v_mfma_f32_16x16x32_bf16 v[48:51], v[88:91], v[144:147], v[48:51]
    ds_read_b128 v[84:87], v224 offset:29696
    s_waitcnt vmcnt(17) lgkmcnt(5)
    v_mfma_f32_16x16x32_bf16 v[20:23], v[92:95], v[148:151], v[20:23]
    v_mfma_f32_16x16x32_bf16 v[48:51], v[92:95], v[152:155], v[48:51]
    ds_read_b128 v[88:91], v224 offset:36864
    s_waitcnt vmcnt(15)
    v_mfma_f32_16x16x32_bf16 v[20:23], v[96:99], v[156:159], v[20:23]
    buffer_load_dwordx4 a[84:87], v3, s[8:11], s76 offen offset:1024 sc1
    v_mfma_f32_16x16x32_bf16 v[48:51], v[96:99], v[160:163], v[48:51]
    ds_read_b128 v[92:95], v224 offset:44032
    s_waitcnt vmcnt(14) lgkmcnt(5)
    v_mfma_f32_16x16x32_bf16 v[20:23], v[100:103], v[164:167], v[20:23]
    buffer_load_dwordx4 a[88:91], v3, s[8:11], s76 offen offset:2048 sc1
    v_mfma_f32_16x16x32_bf16 v[48:51], v[100:103], v[168:171], v[48:51]
    ds_read_b128 v[96:99], v224 offset:51200
    v_mfma_f32_16x16x32_bf16 v[24:27], v[104:107], v[188:191], v[24:27]
    buffer_load_dwordx4 a[92:95], v3, s[8:11], s76 offen offset:3072 sc1
    v_mfma_f32_16x16x32_bf16 v[52:55], v[104:107], v[192:195], v[52:55]
    ds_read_b128 v[100:103], v224 offset:58368
    s_waitcnt lgkmcnt(5)
    v_mfma_f32_16x16x32_bf16 v[24:27], v[76:79], v[196:199], v[24:27]
    v_mfma_f32_16x16x32_bf16 v[52:55], v[76:79], v[200:203], v[52:55]
    ds_read_b128 v[104:107], v225 offset:1024
    v_max_f32 v14, 0, v20
    v_mfma_f32_16x16x32_bf16 v[24:27], v[80:83], v[108:111], v[24:27]
    s_add_u32 s76, s76, 4096
    buffer_load_dwordx4 a[96:99], v3, s[8:11], s76 offen offset:0 sc1
    v_mfma_f32_16x16x32_bf16 v[52:55], v[80:83], v[112:115], v[52:55]
    ds_read_b128 v[76:79], v225 offset:8192
    s_waitcnt lgkmcnt(5)
    v_mfma_f32_16x16x32_bf16 v[24:27], v[84:87], v[116:119], v[24:27]
    s_add_u32 s76, s77, 35840
    buffer_load_dwordx4 a[140:143], v3, s[8:11], s76 offen offset:0 sc1
    v_mfma_f32_16x16x32_bf16 v[52:55], v[84:87], v[120:123], v[52:55]
    ds_read_b128 v[80:83], v224 offset:9216
    v_max_f32 v15, 0, v21
    v_mfma_f32_16x16x32_bf16 v[24:27], v[88:91], v[124:127], v[24:27]
    buffer_load_dwordx4 a[144:147], v3, s[8:11], s76 offen offset:1024 sc1
    v_max_f32 v16, 0, v22
    v_mfma_f32_16x16x32_bf16 v[52:55], v[88:91], v[128:131], v[52:55]
    ds_read_b128 v[84:87], v224 offset:16384
    s_waitcnt lgkmcnt(5)
    v_mfma_f32_16x16x32_bf16 v[24:27], v[92:95], v[132:135], v[24:27]
    v_max_f32 v17, 0, v23
    v_mul_f32 v20, v14, v20
    v_mfma_f32_16x16x32_bf16 v[52:55], v[92:95], v[136:139], v[52:55]
    ds_read_b128 v[88:91], v224 offset:23552
    v_mul_f32 v21, v15, v21
    v_mfma_f32_16x16x32_bf16 v[24:27], v[96:99], v[140:143], v[24:27]
    buffer_load_dwordx4 a[148:151], v3, s[8:11], s76 offen offset:2048 sc1
    v_mul_f32 v22, v16, v22
    v_mfma_f32_16x16x32_bf16 v[52:55], v[96:99], v[144:147], v[52:55]
    ds_read_b128 v[92:95], v224 offset:30720
    s_waitcnt lgkmcnt(5)
    v_mfma_f32_16x16x32_bf16 v[24:27], v[100:103], v[148:151], v[24:27]
    buffer_load_dwordx4 a[152:155], v3, s[8:11], s76 offen offset:3072 sc1
    v_mul_f32 v23, v17, v23
    v_mfma_f32_16x16x32_bf16 v[52:55], v[100:103], v[152:155], v[52:55]
    ds_read_b128 v[96:99], v224 offset:37888
    v_cvt_pk_bf16_f32 v204, v20, v21
    v_mfma_f32_16x16x32_bf16 v[24:27], v[104:107], v[156:159], v[24:27]
    s_add_u32 s76, s76, 4096
    buffer_load_dwordx4 a[156:159], v3, s[8:11], s76 offen offset:0 sc1
    v_mfma_f32_16x16x32_bf16 v[52:55], v[104:107], v[160:163], v[52:55]
    ds_read_b128 v[100:103], v224 offset:45056
    s_waitcnt lgkmcnt(5)
    v_mfma_f32_16x16x32_bf16 v[24:27], v[76:79], v[164:167], v[24:27]
    v_cvt_pk_bf16_f32 v205, v22, v23
    v_max_f32 v14, 0, v48
    v_mfma_f32_16x16x32_bf16 v[52:55], v[76:79], v[168:171], v[52:55]
    ds_read_b128 v[104:107], v224 offset:52224
    v_max_f32 v15, 0, v49
    v_mfma_f32_16x16x32_bf16 v[28:31], v[80:83], v[188:191], v[28:31]
    s_add_u32 s76, s77, 40960
    buffer_load_dwordx4 a[160:163], v3, s[8:11], s76 offen offset:0 sc1
    v_mfma_f32_16x16x32_bf16 v[56:59], v[80:83], v[192:195], v[56:59]
    ds_read_b128 v[76:79], v224 offset:59392
    s_waitcnt lgkmcnt(5)
    v_mfma_f32_16x16x32_bf16 v[28:31], v[84:87], v[196:199], v[28:31]
    buffer_load_dwordx4 a[164:167], v3, s[8:11], s76 offen offset:1024 sc1
    v_max_f32 v16, 0, v50
    v_mfma_f32_16x16x32_bf16 v[56:59], v[84:87], v[200:203], v[56:59]
    ds_read_b128 v[80:83], v225 offset:2048
    v_max_f32 v17, 0, v51
    v_mfma_f32_16x16x32_bf16 v[28:31], v[88:91], v[108:111], v[28:31]
    buffer_load_dwordx4 a[168:171], v3, s[8:11], s76 offen offset:2048 sc1
    v_mul_f32 v48, v14, v48
    v_mfma_f32_16x16x32_bf16 v[56:59], v[88:91], v[112:115], v[56:59]
    ds_read_b128 v[84:87], v225 offset:9216
    s_waitcnt lgkmcnt(5)
    v_mfma_f32_16x16x32_bf16 v[28:31], v[92:95], v[116:119], v[28:31]
    v_mul_f32 v49, v15, v49
    v_mul_f32 v50, v16, v50
    v_mfma_f32_16x16x32_bf16 v[56:59], v[92:95], v[120:123], v[56:59]
    ds_read_b128 v[88:91], v224 offset:10240
    v_mul_f32 v51, v17, v51
    v_mfma_f32_16x16x32_bf16 v[28:31], v[96:99], v[124:127], v[28:31]
    buffer_load_dwordx4 a[172:175], v3, s[8:11], s76 offen offset:3072 sc1
    v_cvt_pk_bf16_f32 v206, v48, v49
    v_mfma_f32_16x16x32_bf16 v[56:59], v[96:99], v[128:131], v[56:59]
    ds_read_b128 v[92:95], v224 offset:17408
    s_waitcnt lgkmcnt(5)
    v_mfma_f32_16x16x32_bf16 v[28:31], v[100:103], v[132:135], v[28:31]
    s_add_u32 s76, s76, 4096
    buffer_load_dwordx4 a[176:179], v3, s[8:11], s76 offen offset:0 sc1
    v_mfma_f32_16x16x32_bf16 v[56:59], v[100:103], v[136:139], v[56:59]
    ds_read_b128 v[96:99], v224 offset:24576
    v_cvt_pk_bf16_f32 v207, v50, v51
    v_mfma_f32_16x16x32_bf16 v[28:31], v[104:107], v[140:143], v[28:31]
    s_add_u32 s76, s77, 56320
    buffer_load_dwordx4 a[220:223], v3, s[8:11], s76 offen offset:0 sc1
    v_mfma_f32_16x16x32_bf16 v[56:59], v[104:107], v[144:147], v[56:59]
    ds_read_b128 v[100:103], v224 offset:31744
    s_waitcnt lgkmcnt(5)
    v_mfma_f32_16x16x32_bf16 v[28:31], v[76:79], v[148:151], v[28:31]
    v_permlane16_swap_b32 v204, v206
    v_mfma_f32_16x16x32_bf16 v[56:59], v[76:79], v[152:155], v[56:59]
    ds_read_b128 v[104:107], v224 offset:38912
    v_mfma_f32_16x16x32_bf16 v[28:31], v[80:83], v[156:159], v[28:31]
    buffer_load_dwordx4 a[224:227], v3, s[8:11], s76 offen offset:1024 sc1
    v_mfma_f32_16x16x32_bf16 v[56:59], v[80:83], v[160:163], v[56:59]
    ds_read_b128 v[76:79], v224 offset:46080
    s_waitcnt lgkmcnt(5)
    v_mfma_f32_16x16x32_bf16 v[28:31], v[84:87], v[164:167], v[28:31]
    buffer_load_dwordx4 a[228:231], v3, s[8:11], s76 offen offset:2048 sc1
    v_mfma_f32_16x16x32_bf16 v[56:59], v[84:87], v[168:171], v[56:59]
    ds_read_b128 v[80:83], v224 offset:53248
    v_mfma_f32_16x16x32_bf16 v[32:35], v[88:91], v[188:191], v[32:35]
    buffer_load_dwordx4 a[232:235], v3, s[8:11], s76 offen offset:3072 sc1
    v_mfma_f32_16x16x32_bf16 v[60:63], v[88:91], v[192:195], v[60:63]
    ds_read_b128 v[84:87], v224 offset:60416
    s_waitcnt lgkmcnt(5)
    v_mfma_f32_16x16x32_bf16 v[32:35], v[92:95], v[196:199], v[32:35]
    v_permlane16_swap_b32 v205, v207
    v_mfma_f32_16x16x32_bf16 v[60:63], v[92:95], v[200:203], v[60:63]
    ds_read_b128 v[88:91], v225 offset:3072
    buffer_store_dwordx4 v[204:207], v227, s[8:11], s61 offen offset:0 sc1
    v_mfma_f32_16x16x32_bf16 v[32:35], v[96:99], v[108:111], v[32:35]
    s_add_u32 s76, s76, 4096
    buffer_load_dwordx4 a[236:239], v3, s[8:11], s76 offen offset:0 sc1
    v_mfma_f32_16x16x32_bf16 v[60:63], v[96:99], v[112:115], v[60:63]
    ds_read_b128 v[92:95], v225 offset:10240
    s_waitcnt lgkmcnt(5)
    v_mfma_f32_16x16x32_bf16 v[32:35], v[100:103], v[116:119], v[32:35]
    s_add_u32 s76, s77, 10240
    buffer_load_dwordx4 a[40:43], v3, s[8:11], s76 offen offset:0 sc1
    v_mfma_f32_16x16x32_bf16 v[60:63], v[100:103], v[120:123], v[60:63]
    ds_read_b128 v[96:99], v224 offset:11264
    v_max_f32 v14, 0, v24
    v_mfma_f32_16x16x32_bf16 v[32:35], v[104:107], v[124:127], v[32:35]
    buffer_load_dwordx4 a[44:47], v3, s[8:11], s76 offen offset:1024 sc1
    v_max_f32 v15, 0, v25
    v_mfma_f32_16x16x32_bf16 v[60:63], v[104:107], v[128:131], v[60:63]
    ds_read_b128 v[100:103], v224 offset:18432
    s_waitcnt lgkmcnt(5)
    v_mfma_f32_16x16x32_bf16 v[32:35], v[76:79], v[132:135], v[32:35]
    v_max_f32 v16, 0, v26
    v_max_f32 v17, 0, v27
    v_mfma_f32_16x16x32_bf16 v[60:63], v[76:79], v[136:139], v[60:63]
    ds_read_b128 v[104:107], v224 offset:25600
    v_mul_f32 v24, v14, v24
    v_mfma_f32_16x16x32_bf16 v[32:35], v[80:83], v[140:143], v[32:35]
    buffer_load_dwordx4 a[48:51], v3, s[8:11], s76 offen offset:2048 sc1
    v_mul_f32 v25, v15, v25
    v_mfma_f32_16x16x32_bf16 v[60:63], v[80:83], v[144:147], v[60:63]
    ds_read_b128 v[76:79], v224 offset:32768
    s_waitcnt lgkmcnt(5)
    v_mfma_f32_16x16x32_bf16 v[32:35], v[84:87], v[148:151], v[32:35]
    buffer_load_dwordx4 a[52:55], v3, s[8:11], s76 offen offset:3072 sc1
    v_mul_f32 v26, v16, v26
    v_mfma_f32_16x16x32_bf16 v[60:63], v[84:87], v[152:155], v[60:63]
    ds_read_b128 v[80:83], v224 offset:39936
    v_mul_f32 v27, v17, v27
    v_mfma_f32_16x16x32_bf16 v[32:35], v[88:91], v[156:159], v[32:35]
    s_add_u32 s76, s76, 4096
    buffer_load_dwordx4 a[56:59], v3, s[8:11], s76 offen offset:0 sc1
    v_mfma_f32_16x16x32_bf16 v[60:63], v[88:91], v[160:163], v[60:63]
    ds_read_b128 v[84:87], v224 offset:47104
    s_waitcnt lgkmcnt(5)
    v_mfma_f32_16x16x32_bf16 v[32:35], v[92:95], v[164:167], v[32:35]
    v_cvt_pk_bf16_f32 v208, v24, v25
    v_cvt_pk_bf16_f32 v209, v26, v27
    v_mfma_f32_16x16x32_bf16 v[60:63], v[92:95], v[168:171], v[60:63]
    ds_read_b128 v[88:91], v224 offset:54272
    v_max_f32 v14, 0, v52
    v_mfma_f32_16x16x32_bf16 v[36:39], v[96:99], v[188:191], v[36:39]
    s_add_u32 s76, s77, 15360
    buffer_load_dwordx4 a[60:63], v3, s[8:11], s76 offen offset:0 sc1
    v_mfma_f32_16x16x32_bf16 v[64:67], v[96:99], v[192:195], v[64:67]
    ds_read_b128 v[92:95], v224 offset:61440
    s_waitcnt lgkmcnt(5)
    v_mfma_f32_16x16x32_bf16 v[36:39], v[100:103], v[196:199], v[36:39]
    buffer_load_dwordx4 a[64:67], v3, s[8:11], s76 offen offset:1024 sc1
    v_max_f32 v15, 0, v53
    v_mfma_f32_16x16x32_bf16 v[64:67], v[100:103], v[200:203], v[64:67]
    ds_read_b128 v[96:99], v225 offset:4096
    v_max_f32 v16, 0, v54
    v_mfma_f32_16x16x32_bf16 v[36:39], v[104:107], v[108:111], v[36:39]
    buffer_load_dwordx4 a[68:71], v3, s[8:11], s76 offen offset:2048 sc1
    v_max_f32 v17, 0, v55
    v_mfma_f32_16x16x32_bf16 v[64:67], v[104:107], v[112:115], v[64:67]
    ds_read_b128 v[100:103], v225 offset:11264
    s_waitcnt lgkmcnt(5)
    v_mfma_f32_16x16x32_bf16 v[36:39], v[76:79], v[116:119], v[36:39]
    v_mul_f32 v52, v14, v52
    v_mul_f32 v53, v15, v53
    v_mfma_f32_16x16x32_bf16 v[64:67], v[76:79], v[120:123], v[64:67]
    ds_read_b128 v[104:107], v224 offset:12288
    v_mul_f32 v54, v16, v54
    v_mfma_f32_16x16x32_bf16 v[36:39], v[80:83], v[124:127], v[36:39]
    buffer_load_dwordx4 a[72:75], v3, s[8:11], s76 offen offset:3072 sc1
    v_mul_f32 v55, v17, v55
    v_mfma_f32_16x16x32_bf16 v[64:67], v[80:83], v[128:131], v[64:67]
    ds_read_b128 v[76:79], v224 offset:19456
    s_waitcnt lgkmcnt(5)
    v_mfma_f32_16x16x32_bf16 v[36:39], v[84:87], v[132:135], v[36:39]
    s_add_u32 s76, s76, 4096
    buffer_load_dwordx4 a[76:79], v3, s[8:11], s76 offen offset:0 sc1
    v_mfma_f32_16x16x32_bf16 v[64:67], v[84:87], v[136:139], v[64:67]
    ds_read_b128 v[80:83], v224 offset:26624
    v_cvt_pk_bf16_f32 v210, v52, v53
    v_mfma_f32_16x16x32_bf16 v[36:39], v[88:91], v[140:143], v[36:39]
    v_cvt_pk_bf16_f32 v211, v54, v55
    v_mfma_f32_16x16x32_bf16 v[64:67], v[88:91], v[144:147], v[64:67]
    ds_read_b128 v[84:87], v224 offset:33792
    s_waitcnt lgkmcnt(5)
    v_mfma_f32_16x16x32_bf16 v[36:39], v[92:95], v[148:151], v[36:39]
    v_permlane16_swap_b32 v208, v210
    v_mfma_f32_16x16x32_bf16 v[64:67], v[92:95], v[152:155], v[64:67]
    ds_read_b128 v[88:91], v224 offset:40960
    v_mfma_f32_16x16x32_bf16 v[36:39], v[96:99], v[156:159], v[36:39]
    v_permlane16_swap_b32 v209, v211
    v_mfma_f32_16x16x32_bf16 v[64:67], v[96:99], v[160:163], v[64:67]
    ds_read_b128 v[92:95], v224 offset:48128
    s_waitcnt lgkmcnt(5)
    v_mfma_f32_16x16x32_bf16 v[36:39], v[100:103], v[164:167], v[36:39]
    buffer_store_dwordx4 v[208:211], v227, s[8:11], s61 offen offset:512 sc1
    v_max_f32 v14, 0, v28
    v_mfma_f32_16x16x32_bf16 v[64:67], v[100:103], v[168:171], v[64:67]
    ds_read_b128 v[96:99], v224 offset:55296
    v_max_f32 v15, 0, v29
    v_mfma_f32_16x16x32_bf16 v[40:43], v[104:107], v[188:191], v[40:43]
    v_max_f32 v16, 0, v30
    v_max_f32 v17, 0, v31
    v_mfma_f32_16x16x32_bf16 v[68:71], v[104:107], v[192:195], v[68:71]
    ds_read_b128 v[100:103], v224 offset:62464
    s_waitcnt lgkmcnt(5)
    v_mfma_f32_16x16x32_bf16 v[40:43], v[76:79], v[196:199], v[40:43]
    v_mul_f32 v28, v14, v28
    v_mul_f32 v29, v15, v29
    v_mfma_f32_16x16x32_bf16 v[68:71], v[76:79], v[200:203], v[68:71]
    ds_read_b128 v[104:107], v225 offset:5120
    v_mul_f32 v30, v16, v30
    v_mfma_f32_16x16x32_bf16 v[40:43], v[80:83], v[108:111], v[40:43]
    v_mul_f32 v31, v17, v31
    v_cvt_pk_bf16_f32 v204, v28, v29
    v_mfma_f32_16x16x32_bf16 v[68:71], v[80:83], v[112:115], v[68:71]
    ds_read_b128 v[76:79], v225 offset:12288
    s_waitcnt lgkmcnt(5)
    v_mfma_f32_16x16x32_bf16 v[40:43], v[84:87], v[116:119], v[40:43]
    v_cvt_pk_bf16_f32 v205, v30, v31
    v_max_f32 v14, 0, v56
    v_mfma_f32_16x16x32_bf16 v[68:71], v[84:87], v[120:123], v[68:71]
    ds_read_b128 v[80:83], v224 offset:13312
    v_max_f32 v15, 0, v57
    v_mfma_f32_16x16x32_bf16 v[40:43], v[88:91], v[124:127], v[40:43]
    v_max_f32 v16, 0, v58
    v_max_f32 v17, 0, v59
    v_mfma_f32_16x16x32_bf16 v[68:71], v[88:91], v[128:131], v[68:71]
    ds_read_b128 v[84:87], v224 offset:20480
    s_waitcnt lgkmcnt(5)
    v_mfma_f32_16x16x32_bf16 v[40:43], v[92:95], v[132:135], v[40:43]
    v_mul_f32 v56, v14, v56
    v_mul_f32 v57, v15, v57
    v_mfma_f32_16x16x32_bf16 v[68:71], v[92:95], v[136:139], v[68:71]
    ds_read_b128 v[88:91], v224 offset:27648
    v_mul_f32 v58, v16, v58
    v_mfma_f32_16x16x32_bf16 v[40:43], v[96:99], v[140:143], v[40:43]
    v_mul_f32 v59, v17, v59
    v_cvt_pk_bf16_f32 v206, v56, v57
    v_mfma_f32_16x16x32_bf16 v[68:71], v[96:99], v[144:147], v[68:71]
    ds_read_b128 v[92:95], v224 offset:34816
    s_waitcnt lgkmcnt(5)
    v_mfma_f32_16x16x32_bf16 v[40:43], v[100:103], v[148:151], v[40:43]
    v_cvt_pk_bf16_f32 v207, v58, v59
    v_mfma_f32_16x16x32_bf16 v[68:71], v[100:103], v[152:155], v[68:71]
    ds_read_b128 v[96:99], v224 offset:41984
    v_mfma_f32_16x16x32_bf16 v[40:43], v[104:107], v[156:159], v[40:43]
    v_permlane16_swap_b32 v204, v206
    v_mfma_f32_16x16x32_bf16 v[68:71], v[104:107], v[160:163], v[68:71]
    ds_read_b128 v[100:103], v224 offset:49152
    s_waitcnt lgkmcnt(5)
    v_mfma_f32_16x16x32_bf16 v[40:43], v[76:79], v[164:167], v[40:43]
    v_permlane16_swap_b32 v205, v207
    v_mfma_f32_16x16x32_bf16 v[68:71], v[76:79], v[168:171], v[68:71]
    ds_read_b128 v[104:107], v224 offset:56320
    buffer_store_dwordx4 v[204:207], v227, s[8:11], s61 offen offset:1024 sc1
    v_mfma_f32_16x16x32_bf16 v[44:47], v[80:83], v[188:191], v[44:47]
    v_max_f32 v14, 0, v32
    v_max_f32 v15, 0, v33
    v_mfma_f32_16x16x32_bf16 v[72:75], v[80:83], v[192:195], v[72:75]
    ds_read_b128 v[76:79], v224 offset:63488
    s_waitcnt lgkmcnt(5)
    v_mfma_f32_16x16x32_bf16 v[44:47], v[84:87], v[196:199], v[44:47]
    v_max_f32 v16, 0, v34
    v_max_f32 v17, 0, v35
    v_mfma_f32_16x16x32_bf16 v[72:75], v[84:87], v[200:203], v[72:75]
    ds_read_b128 v[80:83], v225 offset:6144
    v_mul_f32 v32, v14, v32
    v_mfma_f32_16x16x32_bf16 v[44:47], v[88:91], v[108:111], v[44:47]
    v_mul_f32 v33, v15, v33
    v_mul_f32 v34, v16, v34
    v_mfma_f32_16x16x32_bf16 v[72:75], v[88:91], v[112:115], v[72:75]
    ds_read_b128 v[84:87], v225 offset:13312
    s_waitcnt lgkmcnt(5)
    v_mfma_f32_16x16x32_bf16 v[44:47], v[92:95], v[116:119], v[44:47]
    v_mul_f32 v35, v17, v35
    v_cvt_pk_bf16_f32 v208, v32, v33
    v_mfma_f32_16x16x32_bf16 v[72:75], v[92:95], v[120:123], v[72:75]
    v_cvt_pk_bf16_f32 v209, v34, v35
    v_max_f32 v14, 0, v60
    v_mfma_f32_16x16x32_bf16 v[44:47], v[96:99], v[124:127], v[44:47]
    v_max_f32 v15, 0, v61
    v_max_f32 v16, 0, v62
    v_mfma_f32_16x16x32_bf16 v[72:75], v[96:99], v[128:131], v[72:75]
    v_max_f32 v17, 0, v63
    s_waitcnt lgkmcnt(3)
    v_mfma_f32_16x16x32_bf16 v[44:47], v[100:103], v[132:135], v[44:47]
    v_mul_f32 v60, v14, v60
    v_mul_f32 v61, v15, v61
    v_mfma_f32_16x16x32_bf16 v[72:75], v[100:103], v[136:139], v[72:75]
    v_mul_f32 v62, v16, v62
    v_mul_f32 v63, v17, v63
    v_mfma_f32_16x16x32_bf16 v[44:47], v[104:107], v[140:143], v[44:47]
    v_cvt_pk_bf16_f32 v210, v60, v61
    v_cvt_pk_bf16_f32 v211, v62, v63
    v_mfma_f32_16x16x32_bf16 v[72:75], v[104:107], v[144:147], v[72:75]
    s_waitcnt lgkmcnt(1)
    v_mfma_f32_16x16x32_bf16 v[44:47], v[76:79], v[148:151], v[44:47]
    v_permlane16_swap_b32 v208, v210
    v_mfma_f32_16x16x32_bf16 v[72:75], v[76:79], v[152:155], v[72:75]
    v_permlane16_swap_b32 v209, v211
    v_mfma_f32_16x16x32_bf16 v[44:47], v[80:83], v[156:159], v[44:47]
    buffer_store_dwordx4 v[208:211], v227, s[8:11], s61 offen offset:1536 sc1
    v_max_f32 v14, 0, v36
    v_mfma_f32_16x16x32_bf16 v[72:75], v[80:83], v[160:163], v[72:75]
    v_max_f32 v15, 0, v37
    s_waitcnt lgkmcnt(0)
    v_mfma_f32_16x16x32_bf16 v[44:47], v[84:87], v[164:167], v[44:47]
    v_max_f32 v16, 0, v38
    v_max_f32 v17, 0, v39
    v_mfma_f32_16x16x32_bf16 v[72:75], v[84:87], v[168:171], v[72:75]
    v_mul_f32 v36, v14, v36
    v_mul_f32 v37, v15, v37
    v_mul_f32 v38, v16, v38
    v_mul_f32 v39, v17, v39
    v_cvt_pk_bf16_f32 v204, v36, v37
    v_cvt_pk_bf16_f32 v205, v38, v39
    v_max_f32 v14, 0, v64
    v_max_f32 v15, 0, v65
    v_max_f32 v16, 0, v66
    v_max_f32 v17, 0, v67
    v_mul_f32 v64, v14, v64
    v_mul_f32 v65, v15, v65
    v_mul_f32 v66, v16, v66
    v_mul_f32 v67, v17, v67
    v_cvt_pk_bf16_f32 v206, v64, v65
    v_cvt_pk_bf16_f32 v207, v66, v67
    s_nop 0
    v_permlane16_swap_b32 v204, v206
    v_permlane16_swap_b32 v205, v207
    buffer_store_dwordx4 v[204:207], v227, s[8:11], s61 offen offset:2048 sc1
    v_max_f32 v14, 0, v40
    v_max_f32 v15, 0, v41
    v_max_f32 v16, 0, v42
    v_max_f32 v17, 0, v43
    v_mul_f32 v40, v14, v40
    v_mul_f32 v41, v15, v41
    v_mul_f32 v42, v16, v42
    v_mul_f32 v43, v17, v43
    v_cvt_pk_bf16_f32 v208, v40, v41
    v_cvt_pk_bf16_f32 v209, v42, v43
    v_max_f32 v14, 0, v68
    v_max_f32 v15, 0, v69
    v_max_f32 v16, 0, v70
    v_max_f32 v17, 0, v71
    v_mul_f32 v68, v14, v68
    v_mul_f32 v69, v15, v69
    v_mul_f32 v70, v16, v70
    v_mul_f32 v71, v17, v71
    v_cvt_pk_bf16_f32 v210, v68, v69
    v_cvt_pk_bf16_f32 v211, v70, v71
    s_nop 0
    v_permlane16_swap_b32 v208, v210
    v_permlane16_swap_b32 v209, v211
    buffer_store_dwordx4 v[208:211], v227, s[8:11], s61 offen offset:2560 sc1
    v_max_f32 v14, 0, v44
    v_max_f32 v15, 0, v45
    v_max_f32 v16, 0, v46
    v_max_f32 v17, 0, v47
    v_mul_f32 v44, v14, v44
    v_mul_f32 v45, v15, v45
    v_mul_f32 v46, v16, v46
    v_mul_f32 v47, v17, v47
    v_cvt_pk_bf16_f32 v204, v44, v45
    v_cvt_pk_bf16_f32 v205, v46, v47
    v_max_f32 v14, 0, v72
    v_max_f32 v15, 0, v73
    v_max_f32 v16, 0, v74
    v_max_f32 v17, 0, v75
    v_mul_f32 v72, v14, v72
    v_mul_f32 v73, v15, v73
    v_mul_f32 v74, v16, v74
    v_mul_f32 v75, v17, v75
    v_cvt_pk_bf16_f32 v206, v72, v73
    v_cvt_pk_bf16_f32 v207, v74, v75
    s_nop 0
    v_permlane16_swap_b32 v204, v206
    v_permlane16_swap_b32 v205, v207
    s_add_u32 s74, s85, 24576
    v_mov_b32 v14, 1
    v_mov_b32 v15, 0
    s_waitcnt vmcnt(2)
    s_mov_b64 exec, 1
    s_cmp_eq_u32 s91, 1
    s_cbranch_scc0 L_interleave_layers__spectral_fnet__dense_activation_squared_relu__prompt_kernel_far_21
    buffer_store_dword v14, v15, s[8:11], s74 offen
    s_branch L_interleave_layers__spectral_fnet__dense_activation_squared_relu__prompt_kernel_set_22
L_interleave_layers__spectral_fnet__dense_activation_squared_relu__prompt_kernel_far_21:
    buffer_store_dword v14, v15, s[8:11], s74 offen sc1
L_interleave_layers__spectral_fnet__dense_activation_squared_relu__prompt_kernel_set_22:
    s_mov_b64 exec, -1
    buffer_store_dwordx4 v[204:207], v227, s[8:11], s64 offen offset:3072 sc1
    s_waitcnt lgkmcnt(0)
    v_mul_u32_u24 v14, 80, v2
    v_add_u32 v14, 155648, v14
    ds_read_b128 v[100:103], v14 offset:0
    ds_read_b128 v[104:107], v14 offset:16
    ds_read_b128 v[108:111], v14 offset:32
    ds_read_b128 v[112:115], v14 offset:48
    ds_read_b128 v[116:119], v14 offset:64
    v_add_u32 v122, 4096, v3
    v_add_u32 v123, 8192, v3
    v_add_u32 v124, 12288, v3
    s_cmp_ge_u32 s4, 2
    s_mov_b32 s52, 13312
    s_cselect_b32 s52, 117440512, s52
    v_add_u32 v125, s52, v3
    s_add_u32 s52, s4, 1
    s_and_b32 s52, s52, 3
    s_mul_i32 s68, s52, 10240
    s_add_u32 s68, s68, 81920
    s_lshl_b32 s53, s5, 2
    s_add_u32 s52, s52, s53
    s_mul_i32 s52, s52, 54
    s_add_u32 s52, s52, s90
    s_lshl_b32 s52, s52, 10
    s_add_u32 s64, s52, 20971520
    s_add_u32 s52, s4, 2
    s_and_b32 s52, s52, 3
    s_mul_i32 s69, s52, 10240
    s_add_u32 s69, s69, 87040
    s_lshl_b32 s53, s5, 2
    s_add_u32 s52, s52, s53
    s_mul_i32 s52, s52, 54
    s_add_u32 s52, s52, s90
    s_lshl_b32 s52, s52, 10
    s_add_u32 s65, s52, 20971520
    s_add_u32 s52, s4, 3
    s_and_b32 s52, s52, 3
    s_mul_i32 s70, s52, 5120
    s_add_u32 s70, s70, 133120
    s_lshl_b32 s53, s5, 2
    s_add_u32 s52, s52, s53
    s_mul_i32 s52, s52, 54
    s_add_u32 s52, s52, s90
    s_lshl_b32 s52, s52, 10
    s_add_u32 s66, s52, 20971520
    s_add_u32 s52, s4, 4
    s_and_b32 s52, s52, 3
    s_mul_i32 s61, s52, 5120
    s_add_u32 s61, s61, 133120
    s_mul_i32 s71, s52, 10240
    s_add_u32 s71, s71, 81920
    s_lshl_b32 s53, s5, 2
    s_add_u32 s52, s52, s53
    s_mul_i32 s52, s52, 54
    s_add_u32 s52, s52, s90
    s_lshl_b32 s52, s52, 10
    s_add_u32 s67, s52, 20971520
    v_add_f32 v16, v228, v230
    v_add_f32 v17, v229, v231
    v_mov_b32 v14, v16
    s_nop 1
    v_permlane32_swap_b32 v16, v14
    v_add_f32 v16, v16, v14
    v_mov_b32 v14, v16
    s_nop 1
    v_permlane16_swap_b32 v16, v14
    v_add_f32 v16, v16, v14
    v_mov_b32 v14, v17
    s_nop 1
    v_permlane32_swap_b32 v17, v14
    v_add_f32 v17, v17, v14
    v_mov_b32 v14, v17
    s_nop 1
    v_permlane16_swap_b32 v17, v14
    v_add_f32 v17, v17, v14
    v_mul_f32 v16, 0.0015625, v16
    v_mul_f32 v17, 0.0015625, v17
    v_fma_f32 v17, -v16, v16, v17
    v_max_f32 v17, 0, v17
    v_cvt_pk_bf16_f32 v14, v16, v17
    v_lshlrev_b32 v16, 16, v14
    v_and_b32 v17, 0xffff0000, v14
    v_add_f32 v17, 0x3727c5ac, v17
    v_cvt_pk_bf16_f32 v14, v17, v17
    v_lshlrev_b32 v17, 16, v14
    v_sqrt_f32 v17, v17
    s_nop 0
    v_cvt_pk_bf16_f32 v14, v17, v17
    v_lshlrev_b32 v17, 16, v14
    v_rcp_f32 v17, v17
    s_nop 0
    v_mul_f32 v120, v17, v17
    v_mov_b32 v121, v120
    s_mul_i32 s72, s78, 20480
    s_mul_i32 s73, s6, 1280
    s_add_u32 s72, s72, s73
    s_add_u32 s72, s72, 16777216
    s_add_u32 s73, s72, 10240
    v_lshrrev_b32 v14, 1, v2
    v_mul_u32_u24 v14, 10240, v14
    v_lshl_add_u32 v14, v1, 4, v14
    v_and_b32 v15, 1, v2
    v_lshl_add_u32 v18, v15, 3, v14
    s_lshl_b32 s75, s78, 3
    s_add_u32 s75, s75, s6
    s_lshl_b32 s75, s75, 7
    s_add_u32 s75, s75, 393216
    s_mov_b32 s60, 0x3f803f80
    v_lshlrev_b32 v127, 2, v0
    v_and_b32 v15, 7, v0
    v_min_u32 v15, 4, v15
    s_lshl_b32 s63, s4, 2
    v_add_u32 v15, s63, v15
    v_max_u32 v15, 1, v15
    v_subrev_u32 v15, 1, v15
    v_bfe_u32 v14, v0, 3, 1
    v_lshl_add_u32 v15, v14, 4, v15
    v_lshlrev_b32 v126, 2, v15
    s_lshl_b32 s63, s5, 7
    s_add_u32 s62, s63, 24576
    s_add_u32 s63, s63, 12288
    s_add_u32 s74, s85, 12288
    v_mov_b32 v14, 1
    v_mov_b32 v15, 0
    buffer_load_dword v129, v126, s[8:11], s62 offen sc1
    s_waitcnt vmcnt(1)
    s_mov_b64 exec, 1
    s_cmp_eq_u32 s91, 1
    s_cbranch_scc0 L_interleave_layers__spectral_fnet__dense_activation_squared_relu__prompt_kernel_far_23
    buffer_store_dword v14, v15, s[8:11], s74 offen
    s_branch L_interleave_layers__spectral_fnet__dense_activation_squared_relu__prompt_kernel_set_24
L_interleave_layers__spectral_fnet__dense_activation_squared_relu__prompt_kernel_far_23:
    buffer_store_dword v14, v15, s[8:11], s74 offen sc1
L_interleave_layers__spectral_fnet__dense_activation_squared_relu__prompt_kernel_set_24:
    s_mov_b64 exec, -1
    s_getpc_b64 s[54:55]
L_pc2:
    s_lshr_b32 s3, s2, 3
    s_lshl_b32 s3, s3, 2
    s_add_u32 s3, s3, s4
    s_mul_i32 s3, s3, 2
    v_add_lshl_u32 v14, v0, s3, 7
    v_min_u32 v14, L_tab_end-4-L_pc2, v14
    v_mov_b32 v15, s55
    v_add_co_u32 v14, vcc, s54, v14
    s_nop 1
    v_addc_co_u32 v15, vcc, 0, v15, vcc
    s_mov_b64 exec, 3
    global_load_dword v231, v[14:15], off
    s_mov_b64 exec, -1
    s_add_u32 s76, s77, 25600
    buffer_load_dwordx4 a[100:103], v3, s[8:11], s76 offen offset:0 sc1
    buffer_load_dwordx4 a[104:107], v3, s[8:11], s76 offen offset:1024 sc1
    buffer_load_dwordx4 a[108:111], v3, s[8:11], s76 offen offset:2048 sc1
    buffer_load_dwordx4 a[112:115], v3, s[8:11], s76 offen offset:3072 sc1
    s_waitcnt vmcnt(6)
    v_cmp_ne_u32 vcc, 1, v129
    s_nop 4
    s_cbranch_vccz L_interleave_layers__spectral_fnet__dense_activation_squared_relu__prompt_kernel_early_25
L_interleave_layers__spectral_fnet__dense_activation_squared_relu__prompt_kernel_poll_26:
    buffer_load_dword v14, v126, s[8:11], s62 offen sc1
    s_waitcnt vmcnt(0)
    v_cmp_ne_u32 vcc, 1, v14
    s_nop 4
    s_cbranch_vccz L_interleave_layers__spectral_fnet__dense_activation_squared_relu__prompt_kernel_go_27
    s_cmp_eq_u32 s82, 0
    s_cbranch_scc1 L_interleave_layers__spectral_fnet__dense_activation_squared_relu__prompt_kernel_go_27
    s_sub_u32 s82, s82, 1
    s_branch L_interleave_layers__spectral_fnet__dense_activation_squared_relu__prompt_kernel_poll_26
L_interleave_layers__spectral_fnet__dense_activation_squared_relu__prompt_kernel_go_27:
L_interleave_layers__spectral_fnet__dense_activation_squared_relu__prompt_kernel_early_25:
    buffer_load_dwordx4 v[136:139], v3, s[8:11], s64 offen offset:0 sc1
    buffer_load_dwordx4 v[140:143], v3, s[8:11], s64 offen offset:1024 sc1
    buffer_load_dwordx4 v[144:147], v122, s[8:11], s64 offen offset:0 sc1
    buffer_load_dwordx4 v[148:151], v122, s[8:11], s64 offen offset:3072 sc1
    buffer_load_dwordx4 v[152:155], v123, s[8:11], s64 offen offset:0 sc1
    buffer_load_dwordx4 v[156:159], v123, s[8:11], s64 offen offset:3072 sc1
    buffer_load_dwordx4 v[160:163], v3, s[8:11], s65 offen offset:0 sc1
    buffer_load_dwordx4 v[164:167], v3, s[8:11], s65 offen offset:1024 sc1
    buffer_load_dwordx4 v[168:171], v122, s[8:11], s65 offen offset:0 sc1
    buffer_load_dwordx4 v[172:175], v122, s[8:11], s65 offen offset:3072 sc1
    s_waitcnt lgkmcnt(0)
    s_barrier
    v_lshlrev_b32 v14, 16, v4
    v_and_b32 v15, 0xffff0000, v4
    v_pk_add_f32 v[100:101], v[100:101], v[14:15]
    v_lshlrev_b32 v14, 16, v5
    v_and_b32 v15, 0xffff0000, v5
    v_pk_add_f32 v[102:103], v[102:103], v[14:15]
    v_lshlrev_b32 v14, 16, v6
    v_and_b32 v15, 0xffff0000, v6
    v_pk_add_f32 v[104:105], v[104:105], v[14:15]
    v_lshlrev_b32 v14, 16, v7
    v_and_b32 v15, 0xffff0000, v7
    v_pk_add_f32 v[106:107], v[106:107], v[14:15]
    v_lshlrev_b32 v14, 16, v8
    v_and_b32 v15, 0xffff0000, v8
    v_pk_add_f32 v[108:109], v[108:109], v[14:15]
    v_lshlrev_b32 v14, 16, v9
    v_and_b32 v15, 0xffff0000, v9
    v_pk_add_f32 v[110:111], v[110:111], v[14:15]
    v_lshlrev_b32 v14, 16, v10
    v_and_b32 v15, 0xffff0000, v10
    v_pk_add_f32 v[112:113], v[112:113], v[14:15]
    v_lshlrev_b32 v14, 16, v11
    v_and_b32 v15, 0xffff0000, v11
    v_pk_add_f32 v[114:115], v[114:115], v[14:15]
    v_lshlrev_b32 v14, 16, v12
    v_and_b32 v15, 0xffff0000, v12
    v_pk_add_f32 v[116:117], v[116:117], v[14:15]
    v_lshlrev_b32 v14, 16, v13
    v_and_b32 v15, 0xffff0000, v13
    v_pk_add_f32 v[118:119], v[118:119], v[14:15]
    s_waitcnt vmcnt(9)
    v_mfma_f32_16x16x32_bf16 v[20:23], a[0:3], v[136:139], 0
    buffer_load_dwordx4 v[176:179], v123, s[8:11], s65 offen offset:0 sc1
    v_mfma_f32_16x16x32_bf16 v[24:27], a[4:7], v[136:139], 0
    v_mfma_f32_16x16x32_bf16 v[28:31], a[8:11], v[136:139], 0
    s_add_u32 s76, s76, 4096
    buffer_load_dwordx4 a[116:119], v3, s[8:11], s76 offen offset:0 sc1
    v_mfma_f32_16x16x32_bf16 v[32:35], a[12:15], v[136:139], 0
    v_mfma_f32_16x16x32_bf16 v[36:39], a[16:19], v[136:139], 0
    s_add_u32 s76, s77, 30720
    buffer_load_dwordx4 a[120:123], v3, s[8:11], s76 offen offset:0 sc1
    s_waitcnt vmcnt(11)
    v_mfma_f32_16x16x32_bf16 v[20:23], a[20:23], v[140:143], v[20:23]
    buffer_load_dwordx4 v[180:183], v123, s[8:11], s65 offen offset:3072 sc1
    v_mfma_f32_16x16x32_bf16 v[24:27], a[24:27], v[140:143], v[24:27]
    v_mfma_f32_16x16x32_bf16 v[28:31], a[28:31], v[140:143], v[28:31]
    buffer_load_dwordx4 a[124:127], v3, s[8:11], s76 offen offset:1024 sc1
    v_mfma_f32_16x16x32_bf16 v[32:35], a[32:35], v[140:143], v[32:35]
    v_mfma_f32_16x16x32_bf16 v[36:39], a[36:39], v[140:143], v[36:39]
    buffer_load_dwordx4 a[128:131], v3, s[8:11], s76 offen offset:2048 sc1
    s_waitcnt vmcnt(13)
    v_mfma_f32_16x16x32_bf16 v[20:23], a[80:83], v[144:147], v[20:23]
    buffer_load_dwordx4 v[184:187], v3, s[8:11], s66 offen offset:0 sc1
    v_mfma_f32_16x16x32_bf16 v[24:27], a[84:87], v[144:147], v[24:27]
    v_mfma_f32_16x16x32_bf16 v[28:31], a[88:91], v[144:147], v[28:31]
    buffer_load_dwordx4 a[132:135], v3, s[8:11], s76 offen offset:3072 sc1
    v_mfma_f32_16x16x32_bf16 v[32:35], a[92:95], v[144:147], v[32:35]
    v_mfma_f32_16x16x32_bf16 v[36:39], a[96:99], v[144:147], v[36:39]
    s_add_u32 s76, s76, 4096
    buffer_load_dwordx4 a[136:139], v3, s[8:11], s76 offen offset:0 sc1
    s_waitcnt vmcnt(15)
    v_mfma_f32_16x16x32_bf16 v[20:23], a[140:143], v[148:151], v[20:23]
    buffer_load_dwordx4 v[188:191], v3, s[8:11], s66 offen offset:1024 sc1
    v_mfma_f32_16x16x32_bf16 v[24:27], a[144:147], v[148:151], v[24:27]
    v_mfma_f32_16x16x32_bf16 v[28:31], a[148:151], v[148:151], v[28:31]
    s_add_u32 s76, s77, 46080
    buffer_load_dwordx4 a[180:183], v3, s[8:11], s76 offen offset:0 sc1
    v_mfma_f32_16x16x32_bf16 v[32:35], a[152:155], v[148:151], v[32:35]
    v_mfma_f32_16x16x32_bf16 v[36:39], a[156:159], v[148:151], v[36:39]
    buffer_load_dwordx4 a[184:187], v3, s[8:11], s76 offen offset:1024 sc1
    s_waitcnt vmcnt(17)
    v_mfma_f32_16x16x32_bf16 v[20:23], a[160:163], v[152:155], v[20:23]
    buffer_load_dwordx4 v[192:195], v122, s[8:11], s66 offen offset:0 sc1
    v_mfma_f32_16x16x32_bf16 v[24:27], a[164:167], v[152:155], v[24:27]
    v_mfma_f32_16x16x32_bf16 v[28:31], a[168:171], v[152:155], v[28:31]
    buffer_load_dword v129, v126, s[8:11], s63 offen sc1
    buffer_load_dwordx4 a[188:191], v3, s[8:11], s76 offen offset:2048 sc1
    v_mfma_f32_16x16x32_bf16 v[32:35], a[172:175], v[152:155], v[32:35]
    v_mfma_f32_16x16x32_bf16 v[36:39], a[176:179], v[152:155], v[36:39]
    buffer_load_dwordx4 a[192:195], v3, s[8:11], s76 offen offset:3072 sc1
    s_waitcnt vmcnt(20)
    v_mfma_f32_16x16x32_bf16 v[20:23], a[220:223], v[156:159], v[20:23]
    buffer_load_dwordx4 v[196:199], v122, s[8:11], s66 offen offset:3072 sc1
    v_mfma_f32_16x16x32_bf16 v[24:27], a[224:227], v[156:159], v[24:27]
    v_mfma_f32_16x16x32_bf16 v[28:31], a[228:231], v[156:159], v[28:31]
    s_add_u32 s76, s76, 4096
    buffer_load_dwordx4 a[196:199], v3, s[8:11], s76 offen offset:0 sc1
    v_mfma_f32_16x16x32_bf16 v[32:35], a[232:235], v[156:159], v[32:35]
    v_mfma_f32_16x16x32_bf16 v[36:39], a[236:239], v[156:159], v[36:39]
    s_add_u32 s76, s77, 51200
    buffer_load_dwordx4 a[200:203], v3, s[8:11], s76 offen offset:0 sc1
    s_waitcnt vmcnt(22)
    v_mfma_f32_16x16x32_bf16 v[40:43], a[0:3], v[160:163], 0
    buffer_load_dwordx4 v[200:203], v123, s[8:11], s66 offen offset:0 sc1
    v_mfma_f32_16x16x32_bf16 v[44:47], a[4:7], v[160:163], 0
    v_mfma_f32_16x16x32_bf16 v[48:51], a[8:11], v[160:163], 0
    buffer_load_dwordx4 a[204:207], v3, s[8:11], s76 offen offset:1024 sc1
    v_mfma_f32_16x16x32_bf16 v[52:55], a[12:15], v[160:163], 0
    v_mfma_f32_16x16x32_bf16 v[56:59], a[16:19], v[160:163], 0
    buffer_load_dwordx4 a[208:211], v3, s[8:11], s76 offen offset:2048 sc1
    s_waitcnt vmcnt(24)
    v_mfma_f32_16x16x32_bf16 v[40:43], a[20:23], v[164:167], v[40:43]
    buffer_load_dwordx4 v[204:207], v123, s[8:11], s66 offen offset:3072 sc1
    v_mfma_f32_16x16x32_bf16 v[44:47], a[24:27], v[164:167], v[44:47]
    v_mfma_f32_16x16x32_bf16 v[48:51], a[28:31], v[164:167], v[48:51]
    buffer_load_dwordx4 a[212:215], v3, s[8:11], s76 offen offset:3072 sc1
    v_mfma_f32_16x16x32_bf16 v[52:55], a[32:35], v[164:167], v[52:55]
    v_mfma_f32_16x16x32_bf16 v[56:59], a[36:39], v[164:167], v[56:59]
    s_add_u32 s76, s76, 4096
    buffer_load_dwordx4 a[216:219], v3, s[8:11], s76 offen offset:0 sc1
    s_waitcnt vmcnt(26)
    v_mfma_f32_16x16x32_bf16 v[40:43], a[80:83], v[168:171], v[40:43]
    buffer_load_dwordx4 v[208:211], v3, s[8:11], s67 offen offset:0 sc1
    v_mfma_f32_16x16x32_bf16 v[44:47], a[84:87], v[168:171], v[44:47]
    v_mfma_f32_16x16x32_bf16 v[48:51], a[88:91], v[168:171], v[48:51]
    s_add_u32 s76, s77, 61440
    buffer_load_dwordx4 a[240:243], v3, s[8:11], s76 offen offset:0 sc1
    v_mfma_f32_16x16x32_bf16 v[52:55], a[92:95], v[168:171], v[52:55]
    v_mfma_f32_16x16x32_bf16 v[56:59], a[96:99], v[168:171], v[56:59]
    buffer_load_dwordx4 a[244:247], v3, s[8:11], s76 offen offset:1024 sc1
    s_waitcnt vmcnt(28)
    v_mfma_f32_16x16x32_bf16 v[40:43], a[140:143], v[172:175], v[40:43]
    buffer_load_dwordx4 v[212:215], v3, s[8:11], s67 offen offset:1024 sc1
    v_mfma_f32_16x16x32_bf16 v[44:47], a[144:147], v[172:175], v[44:47]
    v_mfma_f32_16x16x32_bf16 v[48:51], a[148:151], v[172:175], v[48:51]
    buffer_load_dwordx4 a[248:251], v3, s[8:11], s76 offen offset:2048 sc1
    v_mfma_f32_16x16x32_bf16 v[52:55], a[152:155], v[172:175], v[52:55]
    v_mfma_f32_16x16x32_bf16 v[56:59], a[156:159], v[172:175], v[56:59]
    buffer_load_dwordx4 a[252:255], v3, s[8:11], s76 offen offset:3072 sc1
    s_waitcnt vmcnt(30)
    v_mfma_f32_16x16x32_bf16 v[40:43], a[160:163], v[176:179], v[40:43]
    buffer_load_dwordx4 v[216:219], v122, s[8:11], s67 offen offset:0 sc1
    v_mfma_f32_16x16x32_bf16 v[44:47], a[164:167], v[176:179], v[44:47]
    v_mfma_f32_16x16x32_bf16 v[48:51], a[168:171], v[176:179], v[48:51]
    s_add_u32 s76, s76, 4096
    buffer_load_dwordx4 v[232:235], v3, s[8:11], s76 offen offset:0 sc1
    v_mfma_f32_16x16x32_bf16 v[52:55], a[172:175], v[176:179], v[52:55]
    v_mfma_f32_16x16x32_bf16 v[56:59], a[176:179], v[176:179], v[56:59]
    s_add_u32 s76, s77, 66560
    s_cmp_ge_u32 s4, 2
    s_cselect_b32 s76, 117440512, s76
    buffer_load_dwordx4 v[236:239], v3, s[8:11], s76 offen offset:0 sc1
    s_waitcnt vmcnt(30)
    v_mfma_f32_16x16x32_bf16 v[40:43], a[220:223], v[180:183], v[40:43]
    buffer_load_dwordx4 v[220:223], v122, s[8:11], s67 offen offset:3072 sc1
    v_mfma_f32_16x16x32_bf16 v[44:47], a[224:227], v[180:183], v[44:47]
    v_mfma_f32_16x16x32_bf16 v[48:51], a[228:231], v[180:183], v[48:51]
    buffer_load_dwordx4 v[240:243], v3, s[8:11], s76 offen offset:1024 sc1
    v_mfma_f32_16x16x32_bf16 v[52:55], a[232:235], v[180:183], v[52:55]
    v_mfma_f32_16x16x32_bf16 v[56:59], a[236:239], v[180:183], v[56:59]
    buffer_load_dwordx4 v[244:247], v3, s[8:11], s76 offen offset:2048 sc1
    s_waitcnt vmcnt(30)
    v_mfma_f32_16x16x32_bf16 v[60:63], a[0:3], v[184:187], 0
    buffer_load_dwordx4 v[224:227], v123, s[8:11], s67 offen offset:0 sc1
    v_mfma_f32_16x16x32_bf16 v[64:67], a[4:7], v[184:187], 0
    v_mfma_f32_16x16x32_bf16 v[68:71], a[8:11], v[184:187], 0
    buffer_load_dwordx4 v[248:251], v3, s[8:11], s76 offen offset:3072 sc1
    v_mfma_f32_16x16x32_bf16 v[72:75], a[12:15], v[184:187], 0
    v_mfma_f32_16x16x32_bf16 v[76:79], a[16:19], v[184:187], 0
    s_add_u32 s76, s76, 4096
    buffer_load_dwordx4 v[252:255], v3, s[8:11], s76 offen offset:0 sc1
    s_waitcnt vmcnt(30)
    v_mfma_f32_16x16x32_bf16 v[60:63], a[20:23], v[188:191], v[60:63]
    buffer_load_dwordx4 v[228:231], v123, s[8:11], s67 offen offset:3072 sc1
    v_mfma_f32_16x16x32_bf16 v[64:67], a[24:27], v[188:191], v[64:67]
    v_mfma_f32_16x16x32_bf16 v[68:71], a[28:31], v[188:191], v[68:71]
    v_mfma_f32_16x16x32_bf16 v[72:75], a[32:35], v[188:191], v[72:75]
    v_mfma_f32_16x16x32_bf16 v[76:79], a[36:39], v[188:191], v[76:79]
    s_waitcnt vmcnt(28)
    v_mfma_f32_16x16x32_bf16 v[60:63], a[80:83], v[192:195], v[60:63]
    s_waitcnt vmcnt(27)
    v_cmp_ne_u32 vcc, 1, v129
    s_nop 4
    s_cbranch_vccz L_interleave_layers__spectral_fnet__dense_activation_squared_relu__prompt_kernel_late_28
L_interleave_layers__spectral_fnet__dense_activation_squared_relu__prompt_kernel_poll_29:
    buffer_load_dword v14, v126, s[8:11], s63 offen sc1
    s_waitcnt vmcnt(0)
    v_cmp_ne_u32 vcc, 1, v14
    s_nop 4
    s_cbranch_vccz L_interleave_layers__spectral_fnet__dense_activation_squared_relu__prompt_kernel_go_30
    s_cmp_eq_u32 s82, 0
    s_cbranch_scc1 L_interleave_layers__spectral_fnet__dense_activation_squared_relu__prompt_kernel_go_30
    s_sub_u32 s82, s82, 1
    s_branch L_interleave_layers__spectral_fnet__dense_activation_squared_relu__prompt_kernel_poll_29
L_interleave_layers__spectral_fnet__dense_activation_squared_relu__prompt_kernel_go_30:
L_interleave_layers__spectral_fnet__dense_activation_squared_relu__prompt_kernel_late_28:
    buffer_load_dwordx4 v[136:139], v3, s[8:11], s64 offen offset:2048 sc1
    v_mfma_f32_16x16x32_bf16 v[64:67], a[84:87], v[192:195], v[64:67]
    v_mfma_f32_16x16x32_bf16 v[68:71], a[88:91], v[192:195], v[68:71]
    v_mfma_f32_16x16x32_bf16 v[72:75], a[92:95], v[192:195], v[72:75]
    v_mfma_f32_16x16x32_bf16 v[76:79], a[96:99], v[192:195], v[76:79]
    s_waitcnt vmcnt(25)
    v_mfma_f32_16x16x32_bf16 v[60:63], a[140:143], v[196:199], v[60:63]
    buffer_load_dwordx4 v[140:143], v3, s[8:11], s64 offen offset:3072 sc1
    v_mfma_f32_16x16x32_bf16 v[64:67], a[144:147], v[196:199], v[64:67]
    v_mfma_f32_16x16x32_bf16 v[68:71], a[148:151], v[196:199], v[68:71]
    v_mfma_f32_16x16x32_bf16 v[72:75], a[152:155], v[196:199], v[72:75]
    v_mfma_f32_16x16x32_bf16 v[76:79], a[156:159], v[196:199], v[76:79]
    s_waitcnt vmcnt(23)
    v_mfma_f32_16x16x32_bf16 v[60:63], a[160:163], v[200:203], v[60:63]
    buffer_load_dwordx4 v[144:147], v122, s[8:11], s64 offen offset:1024 sc1
    v_mfma_f32_16x16x32_bf16 v[64:67], a[164:167], v[200:203], v[64:67]
    v_mfma_f32_16x16x32_bf16 v[68:71], a[168:171], v[200:203], v[68:71]
    v_mfma_f32_16x16x32_bf16 v[72:75], a[172:175], v[200:203], v[72:75]
    v_mfma_f32_16x16x32_bf16 v[76:79], a[176:179], v[200:203], v[76:79]
    s_waitcnt vmcnt(21)
    v_mfma_f32_16x16x32_bf16 v[60:63], a[220:223], v[204:207], v[60:63]
    buffer_load_dwordx4 v[148:151], v122, s[8:11], s64 offen offset:2048 sc1
    v_mfma_f32_16x16x32_bf16 v[64:67], a[224:227], v[204:207], v[64:67]
    v_mfma_f32_16x16x32_bf16 v[68:71], a[228:231], v[204:207], v[68:71]
    v_mfma_f32_16x16x32_bf16 v[72:75], a[232:235], v[204:207], v[72:75]
    v_mfma_f32_16x16x32_bf16 v[76:79], a[236:239], v[204:207], v[76:79]
    s_waitcnt vmcnt(19)
    v_mfma_f32_16x16x32_bf16 v[80:83], a[0:3], v[208:211], 0
    buffer_load_dwordx4 v[152:155], v123, s[8:11], s64 offen offset:1024 sc1
    v_mfma_f32_16x16x32_bf16 v[84:87], a[4:7], v[208:211], 0
    v_mfma_f32_16x16x32_bf16 v[88:91], a[8:11], v[208:211], 0
    v_mfma_f32_16x16x32_bf16 v[92:95], a[12:15], v[208:211], 0
    v_mfma_f32_16x16x32_bf16 v[96:99], a[16:19], v[208:211], 0
    s_waitcnt vmcnt(17)
    v_mfma_f32_16x16x32_bf16 v[80:83], a[20:23], v[212:215], v[80:83]
    buffer_load_dwordx4 v[156:159], v123, s[8:11], s64 offen offset:2048 sc1
    v_mfma_f32_16x16x32_bf16 v[84:87], a[24:27], v[212:215], v[84:87]
    v_mfma_f32_16x16x32_bf16 v[88:91], a[28:31], v[212:215], v[88:91]
    v_mfma_f32_16x16x32_bf16 v[92:95], a[32:35], v[212:215], v[92:95]
    v_mfma_f32_16x16x32_bf16 v[96:99], a[36:39], v[212:215], v[96:99]
    s_waitcnt vmcnt(15)
    v_mfma_f32_16x16x32_bf16 v[80:83], a[80:83], v[216:219], v[80:83]
    buffer_load_dwordx4 v[160:163], v124, s[8:11], s64 offen offset:0 sc1
    v_mfma_f32_16x16x32_bf16 v[84:87], a[84:87], v[216:219], v[84:87]
    v_mfma_f32_16x16x32_bf16 v[88:91], a[88:91], v[216:219], v[88:91]
    v_mfma_f32_16x16x32_bf16 v[92:95], a[92:95], v[216:219], v[92:95]
    v_mfma_f32_16x16x32_bf16 v[96:99], a[96:99], v[216:219], v[96:99]
    s_waitcnt vmcnt(13)
    v_mfma_f32_16x16x32_bf16 v[80:83], a[140:143], v[220:223], v[80:83]
    buffer_load_dwordx4 v[164:167], v125, s[8:11], s64 offen offset:0 sc1
    v_mfma_f32_16x16x32_bf16 v[84:87], a[144:147], v[220:223], v[84:87]
    v_mfma_f32_16x16x32_bf16 v[88:91], a[148:151], v[220:223], v[88:91]
    v_mfma_f32_16x16x32_bf16 v[92:95], a[152:155], v[220:223], v[92:95]
    v_mfma_f32_16x16x32_bf16 v[96:99], a[156:159], v[220:223], v[96:99]
    s_waitcnt vmcnt(11)
    v_mfma_f32_16x16x32_bf16 v[80:83], a[160:163], v[224:227], v[80:83]
    buffer_load_dwordx4 v[168:171], v3, s[8:11], s65 offen offset:2048 sc1
    v_mfma_f32_16x16x32_bf16 v[84:87], a[164:167], v[224:227], v[84:87]
    v_mfma_f32_16x16x32_bf16 v[88:91], a[168:171], v[224:227], v[88:91]
    v_mfma_f32_16x16x32_bf16 v[92:95], a[172:175], v[224:227], v[92:95]
    v_mfma_f32_16x16x32_bf16 v[96:99], a[176:179], v[224:227], v[96:99]
    s_waitcnt vmcnt(9)
    v_mfma_f32_16x16x32_bf16 v[80:83], a[220:223], v[228:231], v[80:83]
    buffer_load_dwordx4 v[172:175], v3, s[8:11], s65 offen offset:3072 sc1
    v_mfma_f32_16x16x32_bf16 v[84:87], a[224:227], v[228:231], v[84:87]
    v_mfma_f32_16x16x32_bf16 v[88:91], a[228:231], v[228:231], v[88:91]
    v_mfma_f32_16x16x32_bf16 v[92:95], a[232:235], v[228:231], v[92:95]
    v_mfma_f32_16x16x32_bf16 v[96:99], a[236:239], v[228:231], v[96:99]
    s_waitcnt vmcnt(9)
    v_mfma_f32_16x16x32_bf16 v[20:23], a[40:43], v[136:139], v[20:23]
    buffer_load_dwordx4 v[176:179], v122, s[8:11], s65 offen offset:1024 sc1
    v_mfma_f32_16x16x32_bf16 v[24:27], a[44:47], v[136:139], v[24:27]
    v_add_u32 v129, s71, v3
    v_mfma_f32_16x16x32_bf16 v[28:31], a[48:51], v[136:139], v[28:31]
    v_mfma_f32_16x16x32_bf16 v[32:35], a[52:55], v[136:139], v[32:35]
    v_mfma_f32_16x16x32_bf16 v[36:39], a[56:59], v[136:139], v[36:39]
    s_waitcnt vmcnt(9)
    v_mfma_f32_16x16x32_bf16 v[20:23], a[60:63], v[140:143], v[20:23]
    buffer_load_dwordx4 v[180:183], v122, s[8:11], s65 offen offset:2048 sc1
    s_and_b32 s52, s4, 1
    v_mfma_f32_16x16x32_bf16 v[24:27], a[64:67], v[140:143], v[24:27]
    s_lshl_b32 s52, s52, 2
    v_add_u32 v14, 0, v0
    v_mfma_f32_16x16x32_bf16 v[28:31], a[68:71], v[140:143], v[28:31]
    v_mul_u32_u24 v15, 205, v14
    v_lshrrev_b32 v15, 13, v15
    v_mfma_f32_16x16x32_bf16 v[32:35], a[72:75], v[140:143], v[32:35]
    v_mul_u32_u24 v16, 40, v15
    v_sub_u32 v14, v14, v16
    v_mfma_f32_16x16x32_bf16 v[36:39], a[76:79], v[140:143], v[36:39]
    v_lshrrev_b32 v16, 1, v15
    s_waitcnt vmcnt(9)
    v_mfma_f32_16x16x32_bf16 v[20:23], a[100:103], v[144:147], v[20:23]
    buffer_load_dwordx4 v[184:187], v123, s[8:11], s65 offen offset:1024 sc1
    v_add_u32 v16, s52, v16
    v_mfma_f32_16x16x32_bf16 v[24:27], a[104:107], v[144:147], v[24:27]
    v_xor_b32 v14, v14, v16
    v_mul_u32_u24 v15, 80, v15
    v_mfma_f32_16x16x32_bf16 v[28:31], a[108:111], v[144:147], v[28:31]
    v_add_lshl_u32 v130, v14, v15, 4
    v_add_u32 v14, 64, v0
    v_mfma_f32_16x16x32_bf16 v[32:35], a[112:115], v[144:147], v[32:35]
    v_mul_u32_u24 v15, 205, v14
    v_lshrrev_b32 v15, 13, v15
    v_mfma_f32_16x16x32_bf16 v[36:39], a[116:119], v[144:147], v[36:39]
    v_mul_u32_u24 v16, 40, v15
    s_waitcnt vmcnt(9)
    v_mfma_f32_16x16x32_bf16 v[20:23], a[120:123], v[148:151], v[20:23]
    buffer_load_dwordx4 v[188:191], v123, s[8:11], s65 offen offset:2048 sc1
    v_sub_u32 v14, v14, v16
    v_mfma_f32_16x16x32_bf16 v[24:27], a[124:127], v[148:151], v[24:27]
    v_lshrrev_b32 v16, 1, v15
    v_add_u32 v16, s52, v16
    v_mfma_f32_16x16x32_bf16 v[28:31], a[128:131], v[148:151], v[28:31]
    v_xor_b32 v14, v14, v16
    v_mul_u32_u24 v15, 80, v15
    v_mfma_f32_16x16x32_bf16 v[32:35], a[132:135], v[148:151], v[32:35]
    v_add_lshl_u32 v131, v14, v15, 4
    v_add_u32 v14, 128, v0
    v_mfma_f32_16x16x32_bf16 v[36:39], a[136:139], v[148:151], v[36:39]
    v_mul_u32_u24 v15, 205, v14
    s_waitcnt vmcnt(9)
    v_mfma_f32_16x16x32_bf16 v[20:23], a[180:183], v[152:155], v[20:23]
    buffer_load_dwordx4 v[192:195], v124, s[8:11], s65 offen offset:0 sc1
    v_lshrrev_b32 v15, 13, v15
    v_mfma_f32_16x16x32_bf16 v[24:27], a[184:187], v[152:155], v[24:27]
    v_mul_u32_u24 v16, 40, v15
    v_sub_u32 v14, v14, v16
    v_mfma_f32_16x16x32_bf16 v[28:31], a[188:191], v[152:155], v[28:31]
    v_lshrrev_b32 v16, 1, v15
    v_add_u32 v16, s52, v16
    v_mfma_f32_16x16x32_bf16 v[32:35], a[192:195], v[152:155], v[32:35]
    v_xor_b32 v14, v14, v16
    v_mul_u32_u24 v15, 80, v15
    v_mfma_f32_16x16x32_bf16 v[36:39], a[196:199], v[152:155], v[36:39]
    v_add_lshl_u32 v132, v14, v15, 4
    s_waitcnt vmcnt(9)
    v_mfma_f32_16x16x32_bf16 v[20:23], a[200:203], v[156:159], v[20:23]
    buffer_load_dwordx4 v[196:199], v125, s[8:11], s65 offen offset:0 sc1
    v_add_u32 v14, 192, v0
    v_mfma_f32_16x16x32_bf16 v[24:27], a[204:207], v[156:159], v[24:27]
    v_mul_u32_u24 v15, 205, v14
    v_lshrrev_b32 v15, 13, v15
    v_mfma_f32_16x16x32_bf16 v[28:31], a[208:211], v[156:159], v[28:31]
    v_mul_u32_u24 v16, 40, v15
    v_sub_u32 v14, v14, v16
    v_mfma_f32_16x16x32_bf16 v[32:35], a[212:215], v[156:159], v[32:35]
    v_lshrrev_b32 v16, 1, v15
    v_add_u32 v16, s52, v16
    v_mfma_f32_16x16x32_bf16 v[36:39], a[216:219], v[156:159], v[36:39]
    v_xor_b32 v14, v14, v16
    s_waitcnt vmcnt(9)
    v_mfma_f32_16x16x32_bf16 v[20:23], a[240:243], v[160:163], v[20:23]
    buffer_load_dwordx4 v[200:203], v3, s[8:11], s66 offen offset:2048 sc1
    v_mul_u32_u24 v15, 80, v15
    v_mfma_f32_16x16x32_bf16 v[24:27], a[244:247], v[160:163], v[24:27]
    v_add_lshl_u32 v133, v14, v15, 4
    v_add_u32 v14, 256, v0
    v_mfma_f32_16x16x32_bf16 v[28:31], a[248:251], v[160:163], v[28:31]
    v_mul_u32_u24 v15, 205, v14
    v_lshrrev_b32 v15, 13, v15
    v_mfma_f32_16x16x32_bf16 v[32:35], a[252:255], v[160:163], v[32:35]
    v_mul_u32_u24 v16, 40, v15
    v_sub_u32 v14, v14, v16
    v_mfma_f32_16x16x32_bf16 v[36:39], v[232:235], v[160:163], v[36:39]
    v_lshrrev_b32 v16, 1, v15
    s_waitcnt vmcnt(9)
    v_mfma_f32_16x16x32_bf16 v[20:23], v[236:239], v[164:167], v[20:23]
    buffer_load_dwordx4 v[204:207], v3, s[8:11], s66 offen offset:3072 sc1
    v_add_u32 v16, s52, v16
    v_mfma_f32_16x16x32_bf16 v[24:27], v[240:243], v[164:167], v[24:27]
    v_xor_b32 v14, v14, v16
    v_mul_u32_u24 v15, 80, v15
    v_mfma_f32_16x16x32_bf16 v[28:31], v[244:247], v[164:167], v[28:31]
    v_add_lshl_u32 v134, v14, v15, 4
    s_or_b32 s53, s4, s6
    v_mfma_f32_16x16x32_bf16 v[32:35], v[248:251], v[164:167], v[32:35]
    s_cmp_eq_u32 s53, 0
    s_cselect_b32 s53, 409600, 0
    v_mfma_f32_16x16x32_bf16 v[36:39], v[252:255], v[164:167], v[36:39]
    v_cmp_gt_u32 vcc, 40, v0
    s_waitcnt vmcnt(9)
    v_mfma_f32_16x16x32_bf16 v[40:43], a[40:43], v[168:171], v[40:43]
    buffer_load_dwordx4 v[208:211], v122, s[8:11], s66 offen offset:1024 sc1
    v_mov_b32 v15, s53
    v_mfma_f32_16x16x32_bf16 v[44:47], a[44:47], v[168:171], v[44:47]
    v_add_u32 v128, s68, v3
    v_cndmask_b32 v15, 0, v15, vcc
    v_mfma_f32_16x16x32_bf16 v[48:51], a[48:51], v[168:171], v[48:51]
    v_add_u32 v135, v15, v130
    v_mfma_f32_16x16x32_bf16 v[52:55], a[52:55], v[168:171], v[52:55]
    v_mfma_f32_16x16x32_bf16 v[56:59], a[56:59], v[168:171], v[56:59]
    ds_write_b128 v128, v[20:23] offset:0
    s_waitcnt vmcnt(9)
    v_mfma_f32_16x16x32_bf16 v[40:43], a[60:63], v[172:175], v[40:43]
    buffer_load_dwordx4 v[212:215], v122, s[8:11], s66 offen offset:2048 sc1
    v_mfma_f32_16x16x32_bf16 v[44:47], a[64:67], v[172:175], v[44:47]
    v_mfma_f32_16x16x32_bf16 v[48:51], a[68:71], v[172:175], v[48:51]
    ds_write_b128 v128, v[24:27] offset:1024
    v_mfma_f32_16x16x32_bf16 v[52:55], a[72:75], v[172:175], v[52:55]
    v_mfma_f32_16x16x32_bf16 v[56:59], a[76:79], v[172:175], v[56:59]
    s_waitcnt vmcnt(9)
    v_mfma_f32_16x16x32_bf16 v[40:43], a[100:103], v[176:179], v[40:43]
    buffer_load_dwordx4 v[216:219], v123, s[8:11], s66 offen offset:1024 sc1
    ds_write_b128 v128, v[28:31] offset:2048
    v_mfma_f32_16x16x32_bf16 v[44:47], a[104:107], v[176:179], v[44:47]
    v_mfma_f32_16x16x32_bf16 v[48:51], a[108:111], v[176:179], v[48:51]
    v_mfma_f32_16x16x32_bf16 v[52:55], a[112:115], v[176:179], v[52:55]
    ds_write_b128 v128, v[32:35] offset:3072
    v_mfma_f32_16x16x32_bf16 v[56:59], a[116:119], v[176:179], v[56:59]
    s_waitcnt vmcnt(9)
    v_mfma_f32_16x16x32_bf16 v[40:43], a[120:123], v[180:183], v[40:43]
    buffer_load_dwordx4 v[220:223], v123, s[8:11], s66 offen offset:2048 sc1
    v_mfma_f32_16x16x32_bf16 v[44:47], a[124:127], v[180:183], v[44:47]
    ds_write_b128 v128, v[36:39] offset:4096
    v_mfma_f32_16x16x32_bf16 v[48:51], a[128:131], v[180:183], v[48:51]
    v_mfma_f32_16x16x32_bf16 v[52:55], a[132:135], v[180:183], v[52:55]
    v_mfma_f32_16x16x32_bf16 v[56:59], a[136:139], v[180:183], v[56:59]
    s_waitcnt vmcnt(9)
    v_mfma_f32_16x16x32_bf16 v[40:43], a[180:183], v[184:187], v[40:43]
    buffer_load_dwordx4 v[224:227], v124, s[8:11], s66 offen offset:0 sc1
    v_mfma_f32_16x16x32_bf16 v[44:47], a[184:187], v[184:187], v[44:47]
    v_mfma_f32_16x16x32_bf16 v[48:51], a[188:191], v[184:187], v[48:51]
    v_mfma_f32_16x16x32_bf16 v[52:55], a[192:195], v[184:187], v[52:55]
    v_mfma_f32_16x16x32_bf16 v[56:59], a[196:199], v[184:187], v[56:59]
    s_waitcnt vmcnt(9)
    v_mfma_f32_16x16x32_bf16 v[40:43], a[200:203], v[188:191], v[40:43]
    buffer_load_dwordx4 v[228:231], v125, s[8:11], s66 offen offset:0 sc1
    v_mfma_f32_16x16x32_bf16 v[44:47], a[204:207], v[188:191], v[44:47]
    v_mfma_f32_16x16x32_bf16 v[48:51], a[208:211], v[188:191], v[48:51]
    v_mfma_f32_16x16x32_bf16 v[52:55], a[212:215], v[188:191], v[52:55]
    v_mfma_f32_16x16x32_bf16 v[56:59], a[216:219], v[188:191], v[56:59]
    s_waitcnt vmcnt(9)
    v_mfma_f32_16x16x32_bf16 v[40:43], a[240:243], v[192:195], v[40:43]
    buffer_load_dwordx4 v[136:139], v3, s[8:11], s67 offen offset:2048 sc1
    v_mfma_f32_16x16x32_bf16 v[44:47], a[244:247], v[192:195], v[44:47]
    v_mfma_f32_16x16x32_bf16 v[48:51], a[248:251], v[192:195], v[48:51]
    v_mfma_f32_16x16x32_bf16 v[52:55], a[252:255], v[192:195], v[52:55]
    v_mfma_f32_16x16x32_bf16 v[56:59], v[232:235], v[192:195], v[56:59]
    s_waitcnt vmcnt(9)
    v_mfma_f32_16x16x32_bf16 v[40:43], v[236:239], v[196:199], v[40:43]
    buffer_load_dwordx4 v[140:143], v3, s[8:11], s67 offen offset:3072 sc1
    v_mfma_f32_16x16x32_bf16 v[44:47], v[240:243], v[196:199], v[44:47]
    v_mfma_f32_16x16x32_bf16 v[48:51], v[244:247], v[196:199], v[48:51]
    v_mfma_f32_16x16x32_bf16 v[52:55], v[248:251], v[196:199], v[52:55]
    v_mfma_f32_16x16x32_bf16 v[56:59], v[252:255], v[196:199], v[56:59]
    s_waitcnt vmcnt(9)
    v_mfma_f32_16x16x32_bf16 v[60:63], a[40:43], v[200:203], v[60:63]
    buffer_load_dwordx4 v[144:147], v122, s[8:11], s67 offen offset:1024 sc1
    v_mfma_f32_16x16x32_bf16 v[64:67], a[44:47], v[200:203], v[64:67]
    v_add_u32 v128, s69, v3
    v_mfma_f32_16x16x32_bf16 v[68:71], a[48:51], v[200:203], v[68:71]
    v_mfma_f32_16x16x32_bf16 v[72:75], a[52:55], v[200:203], v[72:75]
    v_mfma_f32_16x16x32_bf16 v[76:79], a[56:59], v[200:203], v[76:79]
    ds_write_b128 v128, v[40:43] offset:0
    s_waitcnt vmcnt(9)
    v_mfma_f32_16x16x32_bf16 v[60:63], a[60:63], v[204:207], v[60:63]
    buffer_load_dwordx4 v[148:151], v122, s[8:11], s67 offen offset:2048 sc1
    v_mfma_f32_16x16x32_bf16 v[64:67], a[64:67], v[204:207], v[64:67]
    v_mfma_f32_16x16x32_bf16 v[68:71], a[68:71], v[204:207], v[68:71]
    ds_write_b128 v128, v[44:47] offset:1024
    v_mfma_f32_16x16x32_bf16 v[72:75], a[72:75], v[204:207], v[72:75]
    v_mfma_f32_16x16x32_bf16 v[76:79], a[76:79], v[204:207], v[76:79]
    s_waitcnt vmcnt(9)
    v_mfma_f32_16x16x32_bf16 v[60:63], a[100:103], v[208:211], v[60:63]
    buffer_load_dwordx4 v[152:155], v123, s[8:11], s67 offen offset:1024 sc1
    ds_write_b128 v128, v[48:51] offset:2048
    v_mfma_f32_16x16x32_bf16 v[64:67], a[104:107], v[208:211], v[64:67]
    v_mfma_f32_16x16x32_bf16 v[68:71], a[108:111], v[208:211], v[68:71]
    v_mfma_f32_16x16x32_bf16 v[72:75], a[112:115], v[208:211], v[72:75]
    ds_write_b128 v128, v[52:55] offset:3072
    v_mfma_f32_16x16x32_bf16 v[76:79], a[116:119], v[208:211], v[76:79]
    s_waitcnt vmcnt(9)
    v_mfma_f32_16x16x32_bf16 v[60:63], a[120:123], v[212:215], v[60:63]
    buffer_load_dwordx4 v[156:159], v123, s[8:11], s67 offen offset:2048 sc1
    v_mfma_f32_16x16x32_bf16 v[64:67], a[124:127], v[212:215], v[64:67]
    ds_write_b128 v128, v[56:59] offset:4096
    v_mfma_f32_16x16x32_bf16 v[68:71], a[128:131], v[212:215], v[68:71]
    v_mfma_f32_16x16x32_bf16 v[72:75], a[132:135], v[212:215], v[72:75]
    v_mfma_f32_16x16x32_bf16 v[76:79], a[136:139], v[212:215], v[76:79]
    s_waitcnt lgkmcnt(0)
    s_barrier
    s_waitcnt vmcnt(9)
    v_mfma_f32_16x16x32_bf16 v[60:63], a[180:183], v[216:219], v[60:63]
    buffer_load_dwordx4 v[160:163], v124, s[8:11], s67 offen offset:0 sc1
    ds_read_b128 v[20:23], v129 offset:0
    v_mfma_f32_16x16x32_bf16 v[64:67], a[184:187], v[216:219], v[64:67]
    ds_read_b128 v[24:27], v129 offset:1024
    v_mfma_f32_16x16x32_bf16 v[68:71], a[188:191], v[216:219], v[68:71]
    ds_read_b128 v[28:31], v129 offset:2048
    v_mfma_f32_16x16x32_bf16 v[72:75], a[192:195], v[216:219], v[72:75]
    ds_read_b128 v[32:35], v129 offset:3072
    v_mfma_f32_16x16x32_bf16 v[76:79], a[196:199], v[216:219], v[76:79]
    ds_read_b128 v[36:39], v129 offset:4096
    s_waitcnt vmcnt(9)
    v_mfma_f32_16x16x32_bf16 v[60:63], a[200:203], v[220:223], v[60:63]
    buffer_load_dwordx4 v[164:167], v125, s[8:11], s67 offen offset:0 sc1
    ds_read_b128 v[40:43], v129 offset:5120
    v_mfma_f32_16x16x32_bf16 v[64:67], a[204:207], v[220:223], v[64:67]
    ds_read_b128 v[44:47], v129 offset:6144
    v_mfma_f32_16x16x32_bf16 v[68:71], a[208:211], v[220:223], v[68:71]
    ds_read_b128 v[48:51], v129 offset:7168
    v_mfma_f32_16x16x32_bf16 v[72:75], a[212:215], v[220:223], v[72:75]
    ds_read_b128 v[52:55], v129 offset:8192
    v_mfma_f32_16x16x32_bf16 v[76:79], a[216:219], v[220:223], v[76:79]
    ds_read_b128 v[56:59], v129 offset:9216
    s_waitcnt vmcnt(9)
    v_mfma_f32_16x16x32_bf16 v[60:63], a[240:243], v[224:227], v[60:63]
    s_waitcnt lgkmcnt(5)
    v_fmac_f32 v100, v20, v120
    v_mfma_f32_16x16x32_bf16 v[64:67], a[244:247], v[224:227], v[64:67]
    v_fmac_f32 v101, v21, v120
    v_fmac_f32 v102, v22, v120
    v_mfma_f32_16x16x32_bf16 v[68:71], a[248:251], v[224:227], v[68:71]
    v_fmac_f32 v103, v23, v120
    v_fmac_f32 v104, v24, v120
    v_mfma_f32_16x16x32_bf16 v[72:75], a[252:255], v[224:227], v[72:75]
    v_fmac_f32 v105, v25, v120
    v_fmac_f32 v106, v26, v120
    v_mfma_f32_16x16x32_bf16 v[76:79], v[232:235], v[224:227], v[76:79]
    v_fmac_f32 v107, v27, v120
    s_waitcnt vmcnt(8)
    v_mfma_f32_16x16x32_bf16 v[60:63], v[236:239], v[228:231], v[60:63]
    v_fmac_f32 v108, v28, v120
    v_fmac_f32 v109, v29, v120
    v_mfma_f32_16x16x32_bf16 v[64:67], v[240:243], v[228:231], v[64:67]
    v_fmac_f32 v110, v30, v120
    v_fmac_f32 v111, v31, v120
    v_mfma_f32_16x16x32_bf16 v[68:71], v[244:247], v[228:231], v[68:71]
    v_fmac_f32 v112, v32, v120
    v_fmac_f32 v113, v33, v120
    v_mfma_f32_16x16x32_bf16 v[72:75], v[248:251], v[228:231], v[72:75]
    v_fmac_f32 v114, v34, v120
    v_fmac_f32 v115, v35, v120
    v_mfma_f32_16x16x32_bf16 v[76:79], v[252:255], v[228:231], v[76:79]
    v_fmac_f32 v116, v36, v120
    s_waitcnt vmcnt(7) lgkmcnt(0)
    v_mfma_f32_16x16x32_bf16 v[80:83], a[40:43], v[136:139], v[80:83]
    v_fmac_f32 v117, v37, v120
    v_fmac_f32 v118, v38, v120
    v_mfma_f32_16x16x32_bf16 v[84:87], a[44:47], v[136:139], v[84:87]
    v_add_u32 v128, s70, v3
    v_fmac_f32 v119, v39, v120
    v_mfma_f32_16x16x32_bf16 v[88:91], a[48:51], v[136:139], v[88:91]
    s_barrier
    v_add_u32 v129, s61, v3
    v_mfma_f32_16x16x32_bf16 v[92:95], a[52:55], v[136:139], v[92:95]
    v_fmac_f32 v100, v40, v120
    v_fmac_f32 v101, v41, v120
    v_mfma_f32_16x16x32_bf16 v[96:99], a[56:59], v[136:139], v[96:99]
    ds_write_b128 v128, v[60:63] offset:0
    s_waitcnt vmcnt(6)
    v_mfma_f32_16x16x32_bf16 v[80:83], a[60:63], v[140:143], v[80:83]
    v_fmac_f32 v102, v42, v120
    v_fmac_f32 v103, v43, v120
    v_mfma_f32_16x16x32_bf16 v[84:87], a[64:67], v[140:143], v[84:87]
    v_fmac_f32 v104, v44, v120
    v_fmac_f32 v105, v45, v120
    v_mfma_f32_16x16x32_bf16 v[88:91], a[68:71], v[140:143], v[88:91]
    ds_write_b128 v128, v[64:67] offset:1024
    v_fmac_f32 v106, v46, v120
    v_mfma_f32_16x16x32_bf16 v[92:95], a[72:75], v[140:143], v[92:95]
    v_fmac_f32 v107, v47, v120
    v_fmac_f32 v108, v48, v120
    v_mfma_f32_16x16x32_bf16 v[96:99], a[76:79], v[140:143], v[96:99]
    v_fmac_f32 v109, v49, v120
    s_waitcnt vmcnt(5)
    v_mfma_f32_16x16x32_bf16 v[80:83], a[100:103], v[144:147], v[80:83]
    ds_write_b128 v128, v[68:71] offset:2048
    v_fmac_f32 v110, v50, v120
    v_mfma_f32_16x16x32_bf16 v[84:87], a[104:107], v[144:147], v[84:87]
    v_fmac_f32 v111, v51, v120
    v_fmac_f32 v112, v52, v120
    v_mfma_f32_16x16x32_bf16 v[88:91], a[108:111], v[144:147], v[88:91]
    v_fmac_f32 v113, v53, v120
    v_fmac_f32 v114, v54, v120
    v_mfma_f32_16x16x32_bf16 v[92:95], a[112:115], v[144:147], v[92:95]
    ds_write_b128 v128, v[72:75] offset:3072
    v_fmac_f32 v115, v55, v120
    v_mfma_f32_16x16x32_bf16 v[96:99], a[116:119], v[144:147], v[96:99]
    v_fmac_f32 v116, v56, v120
    s_waitcnt vmcnt(4)
    v_mfma_f32_16x16x32_bf16 v[80:83], a[120:123], v[148:151], v[80:83]
    v_fmac_f32 v117, v57, v120
    v_fmac_f32 v118, v58, v120
    v_mfma_f32_16x16x32_bf16 v[84:87], a[124:127], v[148:151], v[84:87]
    ds_write_b128 v128, v[76:79] offset:4096
    v_fmac_f32 v119, v59, v120
    v_mfma_f32_16x16x32_bf16 v[88:91], a[128:131], v[148:151], v[88:91]
    s_mul_i32 s54, s6, 51200
    s_mov_b32 s55, s4
    v_mfma_f32_16x16x32_bf16 v[92:95], a[132:135], v[148:151], v[92:95]
    s_mov_b32 s53, s4
    s_mul_i32 s53, s53, 10240
    v_mfma_f32_16x16x32_bf16 v[96:99], a[136:139], v[148:151], v[96:99]
    s_waitcnt lgkmcnt(0)
    s_barrier
    s_waitcnt vmcnt(3)
    v_mfma_f32_16x16x32_bf16 v[80:83], a[180:183], v[152:155], v[80:83]
    ds_read_b128 v[60:63], v129 offset:0
    s_add_u32 s53, s53, s54
    v_mfma_f32_16x16x32_bf16 v[84:87], a[184:187], v[152:155], v[84:87]
    ds_read_b128 v[64:67], v129 offset:1024
    s_mul_i32 s55, s55, 5120
    v_mfma_f32_16x16x32_bf16 v[88:91], a[188:191], v[152:155], v[88:91]
    ds_read_b128 v[68:71], v129 offset:2048
    s_add_u32 m0, s55, 81920
    v_mfma_f32_16x16x32_bf16 v[92:95], a[192:195], v[152:155], v[92:95]
    ds_read_b128 v[72:75], v129 offset:3072
    buffer_load_dwordx4 v135, s[16:19], s53 offen  lds
    v_mfma_f32_16x16x32_bf16 v[96:99], a[196:199], v[152:155], v[96:99]
    ds_read_b128 v[76:79], v129 offset:4096
    s_waitcnt vmcnt(3)
    v_mfma_f32_16x16x32_bf16 v[80:83], a[200:203], v[156:159], v[80:83]
    s_add_u32 m0, s55, 82944
    s_nop 0
    buffer_load_dwordx4 v131, s[16:19], s53 offen  lds
    v_mfma_f32_16x16x32_bf16 v[84:87], a[204:207], v[156:159], v[84:87]
    s_add_u32 m0, s55, 83968
    s_nop 0
    buffer_load_dwordx4 v132, s[16:19], s53 offen  lds
    v_mfma_f32_16x16x32_bf16 v[88:91], a[208:211], v[156:159], v[88:91]
    s_add_u32 m0, s55, 84992
    s_nop 0
    buffer_load_dwordx4 v133, s[16:19], s53 offen  lds
    v_mfma_f32_16x16x32_bf16 v[92:95], a[212:215], v[156:159], v[92:95]
    s_add_u32 m0, s55, 86016
    s_nop 0
    buffer_load_dwordx4 v134, s[16:19], s53 offen  lds
    v_mfma_f32_16x16x32_bf16 v[96:99], a[216:219], v[156:159], v[96:99]
    s_add_u32 s55, s4, 4
    s_waitcnt vmcnt(6)
    v_mfma_f32_16x16x32_bf16 v[80:83], a[240:243], v[160:163], v[80:83]
    s_sub_u32 s53, s4, 1
    s_cmp_eq_u32 s4, 0
    v_mfma_f32_16x16x32_bf16 v[84:87], a[244:247], v[160:163], v[84:87]
    s_cselect_b32 s53, 4, s53
    s_mul_i32 s53, s53, 10240
    v_mfma_f32_16x16x32_bf16 v[88:91], a[248:251], v[160:163], v[88:91]
    s_add_u32 s53, s53, s54
    s_mul_i32 s55, s55, 5120
    v_mfma_f32_16x16x32_bf16 v[92:95], a[252:255], v[160:163], v[92:95]
    s_add_u32 m0, s55, 81920
    s_nop 0
    buffer_load_dwordx4 v130, s[48:51], s53 offen  lds
    v_mfma_f32_16x16x32_bf16 v[96:99], v[232:235], v[160:163], v[96:99]
    s_add_u32 m0, s55, 82944
    s_waitcnt vmcnt(6)
    v_mfma_f32_16x16x32_bf16 v[80:83], v[236:239], v[164:167], v[80:83]
    buffer_load_dwordx4 v131, s[48:51], s53 offen  lds
    s_add_u32 m0, s55, 83968
    v_mfma_f32_16x16x32_bf16 v[84:87], v[240:243], v[164:167], v[84:87]
    buffer_load_dwordx4 v132, s[48:51], s53 offen  lds
    s_add_u32 m0, s55, 84992
    v_mfma_f32_16x16x32_bf16 v[88:91], v[244:247], v[164:167], v[88:91]
    buffer_load_dwordx4 v133, s[48:51], s53 offen  lds
    s_add_u32 m0, s55, 86016
    v_mfma_f32_16x16x32_bf16 v[92:95], v[248:251], v[164:167], v[92:95]
    buffer_load_dwordx4 v134, s[48:51], s53 offen  lds
    s_cmp_lt_u32 s4, 2
    v_mfma_f32_16x16x32_bf16 v[96:99], v[252:255], v[164:167], v[96:99]
    s_cselect_b32 s55, 8, 4
    s_add_u32 s55, s55, s4
    s_sub_u32 s53, s55, 5
    s_mul_i32 s53, s53, 10240
    s_add_u32 s53, s53, s54
    s_mul_i32 s55, s55, 5120
    s_add_u32 m0, s55, 81920
    s_nop 0
    buffer_load_dwordx4 v130, s[20:23], s53 offen  lds
    s_add_u32 m0, s55, 82944
    s_nop 0
    buffer_load_dwordx4 v131, s[20:23], s53 offen  lds
    s_waitcnt lgkmcnt(0)
    v_fmac_f32 v100, v60, v120
    v_fmac_f32 v101, v61, v120
    v_fmac_f32 v102, v62, v120
    v_fmac_f32 v103, v63, v120
    v_fmac_f32 v104, v64, v120
    v_fmac_f32 v105, v65, v120
    v_fmac_f32 v106, v66, v120
    v_fmac_f32 v107, v67, v120
    v_fmac_f32 v108, v68, v120
    v_fmac_f32 v109, v69, v120
    v_fmac_f32 v110, v70, v120
    v_fmac_f32 v111, v71, v120
    v_fmac_f32 v112, v72, v120
    v_fmac_f32 v113, v73, v120
    v_fmac_f32 v114, v74, v120
    v_fmac_f32 v115, v75, v120
    v_fmac_f32 v116, v76, v120
    v_fmac_f32 v117, v77, v120
    v_fmac_f32 v118, v78, v120
    v_fmac_f32 v119, v79, v120
    s_add_u32 m0, s55, 83968
    s_nop 0
    buffer_load_dwordx4 v132, s[20:23], s53 offen  lds
    s_add_u32 m0, s55, 84992
    s_nop 0
    buffer_load_dwordx4 v133, s[20:23], s53 offen  lds
    s_add_u32 m0, s55, 86016
    s_nop 0
    buffer_load_dwordx4 v134, s[20:23], s53 offen  lds
    v_pk_fma_f32 v[100:101], v[80:81], v[120:121], v[100:101]
    v_pk_fma_f32 v[102:103], v[82:83], v[120:121], v[102:103]
    v_pk_fma_f32 v[104:105], v[84:85], v[120:121], v[104:105]
    v_pk_fma_f32 v[106:107], v[86:87], v[120:121], v[106:107]
    v_pk_fma_f32 v[108:109], v[88:89], v[120:121], v[108:109]
    v_pk_fma_f32 v[110:111], v[90:91], v[120:121], v[110:111]
    v_pk_fma_f32 v[112:113], v[92:93], v[120:121], v[112:113]
    v_pk_fma_f32 v[114:115], v[94:95], v[120:121], v[114:115]
    v_pk_fma_f32 v[116:117], v[96:97], v[120:121], v[116:117]
    v_pk_fma_f32 v[118:119], v[98:99], v[120:121], v[118:119]
    s_cmp_eq_u32 s6, 0
    s_cselect_b32 s56, 0xffff, 0
    s_mov_b32 s57, 0
    v_pk_add_f32 v[20:21], v[100:101], v[108:109]
    v_pk_add_f32 v[22:23], v[102:103], v[110:111]
    v_pk_add_f32 v[24:25], v[104:105], v[112:113]
    v_pk_add_f32 v[26:27], v[106:107], v[114:115]
    v_cndmask_b32 v20, v20, v100, s[56:57]
    v_cvt_pk_bf16_f32 v40, v20, v21
    v_cvt_pk_bf16_f32 v41, v22, v23
    v_cvt_pk_bf16_f32 v42, v24, v25
    v_cvt_pk_bf16_f32 v43, v26, v27
    buffer_store_dwordx4 v[40:43], v3, s[8:11], s72 offen sc1
    v_pk_add_f32 v[28:29], v[100:101], v[108:109] neg_lo:[0,1] neg_hi:[0,1]
    v_pk_add_f32 v[30:31], v[102:103], v[110:111] neg_lo:[0,1] neg_hi:[0,1]
    v_pk_add_f32 v[32:33], v[104:105], v[112:113] neg_lo:[0,1] neg_hi:[0,1]
    v_pk_add_f32 v[34:35], v[106:107], v[114:115] neg_lo:[0,1] neg_hi:[0,1]
    v_cndmask_b32 v28, v28, v108, s[56:57]
    v_cvt_pk_bf16_f32 v44, v28, v29
    v_cvt_pk_bf16_f32 v45, v30, v31
    v_cvt_pk_bf16_f32 v46, v32, v33
    v_cvt_pk_bf16_f32 v47, v34, v35
    buffer_store_dwordx4 v[44:47], v3, s[8:11], s73 offen sc1
    v_cvt_pk_bf16_f32 v4, v100, v101
    v_cvt_pk_bf16_f32 v5, v102, v103
    v_cvt_pk_bf16_f32 v6, v104, v105
    v_cvt_pk_bf16_f32 v7, v106, v107
    v_cvt_pk_bf16_f32 v8, v108, v109
    v_cvt_pk_bf16_f32 v9, v110, v111
    v_cvt_pk_bf16_f32 v10, v112, v113
    v_cvt_pk_bf16_f32 v11, v114, v115
    v_cvt_pk_bf16_f32 v12, v116, v117
    v_cvt_pk_bf16_f32 v13, v118, v119
    v_cmp_lt_u32 vcc, 1, v2
    s_nop 1
    v_cndmask_b32 v14, 1.0, -1.0, vcc
    v_mov_b32 v36, v116
    v_mov_b32 v37, v117
    v_mov_b32 v38, v118
    v_mov_b32 v39, v119
    v_permlane32_swap_b32 v116, v36
    v_permlane32_swap_b32 v117, v37
    v_permlane32_swap_b32 v118, v38
    v_permlane32_swap_b32 v119, v39
    v_fmac_f32 v116, v36, v14
    v_fmac_f32 v117, v37, v14
    v_fmac_f32 v118, v38, v14
    v_fmac_f32 v119, v39, v14
    v_cvt_pk_bf16_f32 v48, v116, v117
    v_cvt_pk_bf16_f32 v49, v118, v119
    buffer_store_dwordx2 v[48:49], v18, s[8:11], s72 offen offset:1024 sc1
    v_dot2_f32_bf16 v16, v4, s60, 0
    v_dot2_f32_bf16 v17, v4, v4, 0
    v_dot2_f32_bf16 v16, v5, s60, v16
    v_dot2_f32_bf16 v17, v5, v5, v17
    v_dot2_f32_bf16 v16, v6, s60, v16
    v_dot2_f32_bf16 v17, v6, v6, v17
    v_dot2_f32_bf16 v16, v7, s60, v16
    v_dot2_f32_bf16 v17, v7, v7, v17
    v_dot2_f32_bf16 v16, v8, s60, v16
    v_dot2_f32_bf16 v17, v8, v8, v17
    v_dot2_f32_bf16 v16, v9, s60, v16
    v_dot2_f32_bf16 v17, v9, v9, v17
    v_dot2_f32_bf16 v16, v10, s60, v16
    v_dot2_f32_bf16 v17, v10, v10, v17
    v_dot2_f32_bf16 v16, v11, s60, v16
    v_dot2_f32_bf16 v17, v11, v11, v17
    v_dot2_f32_bf16 v16, v12, s60, v16
    v_dot2_f32_bf16 v17, v12, v12, v17
    v_dot2_f32_bf16 v16, v13, s60, v16
    v_dot2_f32_bf16 v17, v13, v13, v17
    s_nop 1
    v_mov_b32 v14, v16
    v_mov_b32 v15, v17
    s_nop 0
    v_permlane32_swap_b32 v16, v14
    v_permlane32_swap_b32 v17, v15
    v_pk_add_f32 v[16:17], v[16:17], v[14:15]
    v_mov_b32 v14, v16
    v_mov_b32 v15, v17
    s_nop 0
    v_permlane16_swap_b32 v16, v14
    v_permlane16_swap_b32 v17, v15
    v_pk_add_f32 v[16:17], v[16:17], v[14:15]
    v_lshlrev_b32 v14, 3, v0
    s_mov_b64 exec, 0xffff
    buffer_store_dwordx2 v[16:17], v14, s[8:11], s75 offen sc1
    s_mov_b64 exec, -1
    v_lshlrev_b32 v14, 4, v1
    v_add_u32 v14, 155968, v14
    ds_read_b128 v[132:135], v14
    v_lshrrev_b32 v14, 1, v1
    v_xor_b32 v14, v14, v2
    v_mul_u32_u24 v15, 640, v1
    v_lshl_add_u32 v14, v14, 4, v15
    v_add_u32 v212, 81920, v14
    v_xor_b32 v213, 64, v212
    v_and_b32 v14, 0x31, v0
    v_cmp_eq_u32 vcc, 1, v14
    v_mov_b32 v15, 0x8000
    s_nop 0
    v_cndmask_b32 v214, 0, v15, vcc
    v_and_b32 v14, 0x39, v0
    v_cmp_eq_u32 vcc, 1, v14
    s_nop 1
    v_cndmask_b32 v215, 0, v15, vcc
    v_mov_b32 v216, 0x3f803f80
    v_mov_b32 v217, 0x3f803f80
    v_mov_b32 v218, 0x3f803f80
    v_mov_b32 v219, 0x3f803f80
    v_cmp_lt_u32 vcc, 1, v2
    s_nop 1
    v_cndmask_b32 v220, 1.0, -1.0, vcc
    s_waitcnt lgkmcnt(0)
    s_mul_i32 s64, s78, 20480
    s_add_u32 s64, s64, 16777216
    s_add_u32 s65, s64, 4096
    s_add_u32 s66, s64, 8192
    s_add_u32 s67, s64, 12288
    s_add_u32 s68, s64, 16384
    s_lshl_b32 s61, s78, 10
    s_add_u32 s61, s61, 393216
    v_lshlrev_b32 v18, 8, v2
    v_lshl_add_u32 v18, v1, 3, v18
    v_and_b32 v228, 7, v0
    v_lshlrev_b32 v228, 2, v228
    s_lshl_b32 s63, s78, 5
    s_add_u32 s63, s63, 20480
    v_mov_b32 v15, 0x3f80
    v_cmp_eq_u32 vcc, 0, v2
    s_nop 1
    v_cndmask_b32 v15, 0, v15, vcc
    v_or_b32 v216, v15, v214
    v_mov_b32 v217, 0
    v_mov_b32 v218, 0
    v_mov_b32 v219, 0
    s_add_u32 s74, s84, 20480
    v_mov_b32 v14, 1
    v_mov_b32 v15, 0
    s_waitcnt vmcnt(0)
    s_mov_b64 exec, 1
    s_cmp_eq_u32 s91, 1
    s_cbranch_scc0 L_interleave_layers__spectral_fnet__dense_activation_squared_relu__prompt_kernel_far_31
    buffer_store_dword v14, v15, s[8:11], s74 offen
    s_branch L_interleave_layers__spectral_fnet__dense_activation_squared_relu__prompt_kernel_set_32
L_interleave_layers__spectral_fnet__dense_activation_squared_relu__prompt_kernel_far_31:
    buffer_store_dword v14, v15, s[8:11], s74 offen sc1
L_interleave_layers__spectral_fnet__dense_activation_squared_relu__prompt_kernel_set_32:
    s_mov_b64 exec, -1
    s_barrier
    ds_read_b128 v[148:151], v212 offset:0
    ds_read_b128 v[152:155], v212 offset:10240
    ds_read_b128 v[156:159], v212 offset:20480
    ds_read_b128 v[160:163], v212 offset:30720
    ds_read_b128 v[164:167], v212 offset:40960
L_interleave_layers__spectral_fnet__dense_activation_squared_relu__prompt_kernel_poll_33:
    buffer_load_dword v14, v228, s[8:11], s63 offen sc1
    s_waitcnt vmcnt(0)
    v_cmp_ne_u32 vcc, 1, v14
    s_nop 4
    s_cbranch_vccz L_interleave_layers__spectral_fnet__dense_activation_squared_relu__prompt_kernel_go_34
    s_cmp_eq_u32 s82, 0
    s_cbranch_scc1 L_interleave_layers__spectral_fnet__dense_activation_squared_relu__prompt_kernel_go_34
    s_sub_u32 s82, s82, 1
    s_branch L_interleave_layers__spectral_fnet__dense_activation_squared_relu__prompt_kernel_poll_33
L_interleave_layers__spectral_fnet__dense_activation_squared_relu__prompt_kernel_go_34:
    buffer_load_dwordx4 v[20:23], v3, s[8:11], s64 offen offset:0 sc1
    buffer_load_dwordx4 v[24:27], v3, s[8:11], s66 offen offset:2048 sc1
    buffer_load_dwordx4 v[28:31], v3, s[8:11], s64 offen offset:1024 sc1
    buffer_load_dwordx4 v[32:35], v3, s[8:11], s66 offen offset:3072 sc1
    buffer_load_dwordx4 v[36:39], v3, s[8:11], s64 offen offset:2048 sc1
    buffer_load_dwordx4 v[40:43], v3, s[8:11], s67 offen offset:0 sc1
    buffer_load_dwordx4 v[44:47], v3, s[8:11], s64 offen offset:3072 sc1
    buffer_load_dwordx4 v[48:51], v3, s[8:11], s67 offen offset:1024 sc1
    buffer_load_dwordx2 v[140:141], v18, s[8:11], s61 offen offset:0 sc1
    buffer_load_dwordx2 v[142:143], v18, s[8:11], s61 offen offset:128 sc1
    s_mul_i32 s52, s4, 2560
    s_add_u32 s52, s52, 143360
    v_mul_u32_u24 v14, 160, v1
    v_lshl_add_u32 v14, v2, 3, v14
    v_add_u32 v120, s52, v14
    v_lshrrev_b32 v14, 2, v0
    v_mul_u32_u24 v14, 160, v14
    v_add_u32 v14, 143360, v14
    v_and_b32 v15, 3, v0
    v_lshl_add_u32 v121, v15, 4, v14
    v_and_b32 v15, 1, v0
    v_lshl_add_u32 v221, v15, 3, v14
    v_mul_u32_u24 v14, 20480, v2
    v_lshl_add_u32 v223, v1, 4, v14
    v_lshl_add_u32 v222, v1, 3, v14
    s_lshl_b32 s69, s6, 2
    s_add_u32 s69, s69, s4
    s_mul_i32 s69, s69, 81920
    s_mul_i32 s53, s5, 640
    s_add_u32 s69, s69, s53
    s_add_u32 s69, s69, 7340032
    s_lshl_b32 s52, s4, 2
    v_lshrrev_b32 v14, 2, v1
    v_add_u32 v14, s52, v14
    v_lshl_add_u32 v15, s52, 2, v1
    v_and_b32 v15, 0x7e, v15
    v_cmp_eq_u32 vcc, 2, v15
    s_nop 1
    v_cndmask_b32 v14, v14, 16, vcc
    v_sub_u32 v15, 64, v14
    v_and_b32 v16, 2, v1
    v_cmp_eq_u32 vcc, 2, v16
    s_nop 1
    v_cndmask_b32 v14, v14, v15, vcc
    v_and_b32 v16, 1, v1
    v_lshlrev_b32 v16, 5, v16
    v_sub_u32 v15, 0, v16
    v_cndmask_b32 v16, v16, v15, vcc
    v_add_u32 v14, v14, v16
    v_lshlrev_b32 v15, 8, v2
    v_add_u32 v15, s5, v15
    v_mul_u32_u24 v15, v14, v15
    v_cvt_f32_u32 v14, v14
    v_cvt_f32_u32 v15, v15
    v_mul_f32 v14, 0.00048828125, v14
    v_mul_f32 v15, 0.00048828125, v15
    v_fmamk_f32 v224, v14, 0.0, v15
    v_fract_f32 v224, v224
    v_fmamk_f32 v225, v14, 64.0, v15
    v_fract_f32 v225, v225
    v_sin_f32 v226, v224
    v_sin_f32 v227, v225
    v_cos_f32 v224, v224
    v_cos_f32 v225, v225
    v_cvt_pk_bf16_f32 v204, v226, v227
    v_cvt_pk_bf16_f32 v188, v224, v225
    v_xor_b32 v196, 0x80008000, v204
    v_fmamk_f32 v224, v14, 128.0, v15
    v_fract_f32 v224, v224
    v_fmamk_f32 v225, v14, 192.0, v15
    v_fract_f32 v225, v225
    v_sin_f32 v226, v224
    v_sin_f32 v227, v225
    v_cos_f32 v224, v224
    v_cos_f32 v225, v225
    v_cvt_pk_bf16_f32 v205, v226, v227
    v_cvt_pk_bf16_f32 v189, v224, v225
    v_xor_b32 v197, 0x80008000, v205
    v_fmamk_f32 v224, v14, 1024.0, v15
    v_fract_f32 v224, v224
    v_fmamk_f32 v225, v14, 1088.0, v15
    v_fract_f32 v225, v225
    v_sin_f32 v226, v224
    v_sin_f32 v227, v225
    v_cos_f32 v224, v224
    v_cos_f32 v225, v225
    v_cvt_pk_bf16_f32 v206, v226, v227
    v_cvt_pk_bf16_f32 v190, v224, v225
    v_xor_b32 v198, 0x80008000, v206
    v_fmamk_f32 v224, v14, 1152.0, v15
    v_fract_f32 v224, v224
    v_fmamk_f32 v225, v14, 1216.0, v15
    v_fract_f32 v225, v225
    v_sin_f32 v226, v224
    v_sin_f32 v227, v225
    v_cos_f32 v224, v224
    v_cos_f32 v225, v225
    v_cvt_pk_bf16_f32 v207, v226, v227
    v_cvt_pk_bf16_f32 v191, v224, v225
    v_xor_b32 v199, 0x80008000, v207
    v_fmamk_f32 v224, v14, 32.0, v15
    v_fract_f32 v224, v224
    v_fmamk_f32 v225, v14, 96.0, v15
    v_fract_f32 v225, v225
    v_sin_f32 v226, v224
    v_sin_f32 v227, v225
    v_cos_f32 v224, v224
    v_cos_f32 v225, v225
    v_cvt_pk_bf16_f32 v208, v226, v227
    v_cvt_pk_bf16_f32 v192, v224, v225
    v_xor_b32 v200, 0x80008000, v208
    v_fmamk_f32 v224, v14, 160.0, v15
    v_fract_f32 v224, v224
    v_fmamk_f32 v225, v14, 224.0, v15
    v_fract_f32 v225, v225
    v_sin_f32 v226, v224
    v_sin_f32 v227, v225
    v_cos_f32 v224, v224
    v_cos_f32 v225, v225
    v_cvt_pk_bf16_f32 v209, v226, v227
    v_cvt_pk_bf16_f32 v193, v224, v225
    v_xor_b32 v201, 0x80008000, v209
    v_fmamk_f32 v224, v14, 1056.0, v15
    v_fract_f32 v224, v224
    v_fmamk_f32 v225, v14, 1120.0, v15
    v_fract_f32 v225, v225
    v_sin_f32 v226, v224
    v_sin_f32 v227, v225
    v_cos_f32 v224, v224
    v_cos_f32 v225, v225
    v_cvt_pk_bf16_f32 v210, v226, v227
    v_cvt_pk_bf16_f32 v194, v224, v225
    v_xor_b32 v202, 0x80008000, v210
    v_fmamk_f32 v224, v14, 1184.0, v15
    v_fract_f32 v224, v224
    v_fmamk_f32 v225, v14, 1248.0, v15
    v_fract_f32 v225, v225
    v_sin_f32 v226, v224
    v_sin_f32 v227, v225
    v_cos_f32 v224, v224
    v_cos_f32 v225, v225
    v_cvt_pk_bf16_f32 v211, v226, v227
    v_cvt_pk_bf16_f32 v195, v224, v225
    v_xor_b32 v203, 0x80008000, v211
    s_waitcnt lgkmcnt(3) vmcnt(8)
    v_mfma_f32_16x16x32_bf16 v[100:103], v[148:151], v[20:23], 0
    ds_read_b128 v[168:171], v213 offset:0
    buffer_load_dwordx4 v[52:55], v3, s[8:11], s65 offen offset:0 sc1
    v_mfma_f32_16x16x32_bf16 v[104:107], v[152:155], v[20:23], 0
    ds_read_b128 v[172:175], v213 offset:10240
    s_waitcnt lgkmcnt(2)
    v_mfma_f32_16x16x32_bf16 v[108:111], v[156:159], v[20:23], 0
    ds_read_b128 v[176:179], v213 offset:20480
    v_mfma_f32_16x16x32_bf16 v[128:131], v[156:159], v[24:27], 0
    v_mfma_f32_16x16x32_bf16 v[112:115], v[160:163], v[24:27], 0
    ds_read_b128 v[180:183], v213 offset:30720
    buffer_load_dwordx4 v[56:59], v3, s[8:11], s67 offen offset:2048 sc1
    v_mfma_f32_16x16x32_bf16 v[116:119], v[164:167], v[24:27], 0
    ds_read_b128 v[184:187], v213 offset:40960
    v_mfma_f32_16x16x32_bf16 v[100:103], v[216:219], v[24:27], v[100:103]
    v_mfma_f32_16x16x32_bf16 v[104:107], v[216:219], v[24:27], v[104:107]
    v_mfma_f32_16x16x32_bf16 v[108:111], v[216:219], v[24:27], v[108:111]
    s_waitcnt lgkmcnt(3) vmcnt(8)
    v_mfma_f32_16x16x32_bf16 v[100:103], v[168:171], v[28:31], v[100:103]
    ds_read_b128 v[148:151], v212 offset:128
    buffer_load_dwordx4 v[60:63], v3, s[8:11], s65 offen offset:1024 sc1
    v_mfma_f32_16x16x32_bf16 v[104:107], v[172:175], v[28:31], v[104:107]
    ds_read_b128 v[152:155], v212 offset:10368
    s_waitcnt lgkmcnt(2)
    v_mfma_f32_16x16x32_bf16 v[108:111], v[176:179], v[28:31], v[108:111]
    ds_read_b128 v[156:159], v212 offset:20608
    v_mfma_f32_16x16x32_bf16 v[128:131], v[176:179], v[32:35], v[128:131]
    v_mfma_f32_16x16x32_bf16 v[112:115], v[180:183], v[32:35], v[112:115]
    ds_read_b128 v[160:163], v212 offset:30848
    buffer_load_dwordx4 v[64:67], v3, s[8:11], s67 offen offset:3072 sc1
    v_mfma_f32_16x16x32_bf16 v[116:119], v[184:187], v[32:35], v[116:119]
    ds_read_b128 v[164:167], v212 offset:41088
    s_waitcnt lgkmcnt(3) vmcnt(8)
    v_mfma_f32_16x16x32_bf16 v[100:103], v[148:151], v[36:39], v[100:103]
    ds_read_b128 v[168:171], v213 offset:128
    buffer_load_dwordx4 v[68:71], v3, s[8:11], s65 offen offset:2048 sc1
    v_mfma_f32_16x16x32_bf16 v[104:107], v[152:155], v[36:39], v[104:107]
    ds_read_b128 v[172:175], v213 offset:10368
    s_waitcnt lgkmcnt(2)
    v_mfma_f32_16x16x32_bf16 v[108:111], v[156:159], v[36:39], v[108:111]
    ds_read_b128 v[176:179], v213 offset:20608
    v_mfma_f32_16x16x32_bf16 v[128:131], v[156:159], v[40:43], v[128:131]
    v_mfma_f32_16x16x32_bf16 v[112:115], v[160:163], v[40:43], v[112:115]
    ds_read_b128 v[180:183], v213 offset:30848
    buffer_load_dwordx4 v[72:75], v3, s[8:11], s68 offen offset:0 sc1
    v_mfma_f32_16x16x32_bf16 v[116:119], v[164:167], v[40:43], v[116:119]
    ds_read_b128 v[184:187], v213 offset:41088
    s_waitcnt lgkmcnt(3) vmcnt(8)
    v_mfma_f32_16x16x32_bf16 v[100:103], v[168:171], v[44:47], v[100:103]
    ds_read_b128 v[148:151], v212 offset:256
    buffer_load_dwordx4 v[76:79], v3, s[8:11], s65 offen offset:3072 sc1
    s_waitcnt vmcnt(7)
    v_mfma_f32_16x16x32_bf16 v[104:107], v[172:175], v[44:47], v[104:107]
    ds_read_b128 v[152:155], v212 offset:10496
    v_add_f32 v144, v140, v142
    s_waitcnt lgkmcnt(2)
    v_mfma_f32_16x16x32_bf16 v[108:111], v[176:179], v[44:47], v[108:111]
    ds_read_b128 v[156:159], v212 offset:20736
    v_add_f32 v16, v141, v143
    v_mov_b32 v17, v144
    v_mfma_f32_16x16x32_bf16 v[128:131], v[176:179], v[48:51], v[128:131]
    s_nop 0
    v_permlane32_swap_b32 v144, v17
    v_add_f32 v144, v144, v17
    v_mfma_f32_16x16x32_bf16 v[112:115], v[180:183], v[48:51], v[112:115]
    ds_read_b128 v[160:163], v212 offset:30976
    buffer_load_dwordx4 v[80:83], v3, s[8:11], s68 offen offset:1024 sc1
    v_mov_b32 v17, v144
    v_mfma_f32_16x16x32_bf16 v[116:119], v[184:187], v[48:51], v[116:119]
    ds_read_b128 v[164:167], v212 offset:41216
    s_waitcnt lgkmcnt(3) vmcnt(6)
    v_mfma_f32_16x16x32_bf16 v[100:103], v[148:151], v[52:55], v[100:103]
    ds_read_b128 v[168:171], v213 offset:256
    buffer_load_dwordx4 v[84:87], v3, s[8:11], s66 offen offset:0 sc1
    v_mfma_f32_16x16x32_bf16 v[104:107], v[152:155], v[52:55], v[104:107]
    ds_read_b128 v[172:175], v213 offset:10496
    s_waitcnt lgkmcnt(2)
    v_mfma_f32_16x16x32_bf16 v[108:111], v[156:159], v[52:55], v[108:111]
    ds_read_b128 v[176:179], v213 offset:20736
    v_permlane16_swap_b32 v144, v17
    v_mfma_f32_16x16x32_bf16 v[128:131], v[156:159], v[56:59], v[128:131]
    v_add_f32 v144, v144, v17
    v_mov_b32 v17, v16
    v_mfma_f32_16x16x32_bf16 v[112:115], v[160:163], v[56:59], v[112:115]
    ds_read_b128 v[180:183], v213 offset:30976
    buffer_load_dwordx4 v[88:91], v3, s[8:11], s68 offen offset:2048 sc1
    v_mfma_f32_16x16x32_bf16 v[116:119], v[164:167], v[56:59], v[116:119]
    ds_read_b128 v[184:187], v213 offset:41216
    s_waitcnt lgkmcnt(3) vmcnt(6)
    v_mfma_f32_16x16x32_bf16 v[100:103], v[168:171], v[60:63], v[100:103]
    ds_read_b128 v[148:151], v212 offset:384
    buffer_load_dwordx4 v[92:95], v3, s[8:11], s66 offen offset:1024 sc1
    v_mfma_f32_16x16x32_bf16 v[104:107], v[172:175], v[60:63], v[104:107]
    ds_read_b128 v[152:155], v212 offset:10624
    s_waitcnt lgkmcnt(2)
    v_mfma_f32_16x16x32_bf16 v[108:111], v[176:179], v[60:63], v[108:111]
    ds_read_b128 v[156:159], v212 offset:20864
    v_permlane32_swap_b32 v16, v17
    v_mfma_f32_16x16x32_bf16 v[128:131], v[176:179], v[64:67], v[128:131]
    v_add_f32 v16, v16, v17
    v_mov_b32 v17, v16
    v_mfma_f32_16x16x32_bf16 v[112:115], v[180:183], v[64:67], v[112:115]
    ds_read_b128 v[160:163], v212 offset:31104
    buffer_load_dwordx4 v[96:99], v3, s[8:11], s68 offen offset:3072 sc1
    v_mfma_f32_16x16x32_bf16 v[116:119], v[184:187], v[64:67], v[116:119]
    ds_read_b128 v[164:167], v212 offset:41344
    s_waitcnt lgkmcnt(3) vmcnt(6)
    v_mfma_f32_16x16x32_bf16 v[100:103], v[148:151], v[68:71], v[100:103]
    ds_read_b128 v[168:171], v213 offset:384
    v_permlane16_swap_b32 v16, v17
    v_mfma_f32_16x16x32_bf16 v[104:107], v[152:155], v[68:71], v[104:107]
    ds_read_b128 v[172:175], v213 offset:10624
    v_add_f32 v16, v16, v17
    s_waitcnt lgkmcnt(2)
    v_mfma_f32_16x16x32_bf16 v[108:111], v[156:159], v[68:71], v[108:111]
    ds_read_b128 v[176:179], v213 offset:20864
    v_mul_f32 v144, 0.0015625, v144
    v_mul_f32 v16, 0.0015625, v16
    v_mfma_f32_16x16x32_bf16 v[128:131], v[156:159], v[72:75], v[128:131]
    v_fma_f32 v16, -v144, v144, v16
    v_max_f32 v16, 0, v16
    v_cvt_pk_bf16_f32 v17, v144, v16
    v_mfma_f32_16x16x32_bf16 v[112:115], v[160:163], v[72:75], v[112:115]
    ds_read_b128 v[180:183], v213 offset:31104
    v_lshlrev_b32 v144, 16, v17
    v_and_b32 v16, 0xffff0000, v17
    v_mfma_f32_16x16x32_bf16 v[116:119], v[164:167], v[72:75], v[116:119]
    ds_read_b128 v[184:187], v213 offset:41344
    v_add_f32 v16, 0x3727c5ac, v16
    s_waitcnt lgkmcnt(3) vmcnt(4)
    v_mfma_f32_16x16x32_bf16 v[100:103], v[168:171], v[76:79], v[100:103]
    ds_read_b128 v[148:151], v212 offset:512
    v_cvt_pk_bf16_f32 v17, v16, v16
    v_lshlrev_b32 v16, 16, v17
    v_mfma_f32_16x16x32_bf16 v[104:107], v[172:175], v[76:79], v[104:107]
    ds_read_b128 v[152:155], v212 offset:10752
    s_waitcnt lgkmcnt(2)
    v_mfma_f32_16x16x32_bf16 v[108:111], v[176:179], v[76:79], v[108:111]
    ds_read_b128 v[156:159], v212 offset:20992
    v_sqrt_f32 v16, v16
    v_mfma_f32_16x16x32_bf16 v[128:131], v[176:179], v[80:83], v[128:131]
    v_cvt_pk_bf16_f32 v17, v16, v16
    v_lshlrev_b32 v16, 16, v17
    v_mfma_f32_16x16x32_bf16 v[112:115], v[180:183], v[80:83], v[112:115]
    ds_read_b128 v[160:163], v212 offset:31232
    v_rcp_f32 v16, v16
    v_mfma_f32_16x16x32_bf16 v[116:119], v[184:187], v[80:83], v[116:119]
    ds_read_b128 v[164:167], v212 offset:41472
    v_mov_b32 v122, 0
    s_waitcnt lgkmcnt(3) vmcnt(2)
    v_mfma_f32_16x16x32_bf16 v[100:103], v[148:151], v[84:87], v[100:103]
    ds_read_b128 v[168:171], v213 offset:512
    v_mov_b32 v123, 0
    v_mov_b32 v125, 0
    v_mfma_f32_16x16x32_bf16 v[104:107], v[152:155], v[84:87], v[104:107]
    ds_read_b128 v[172:175], v213 offset:10752
    v_mov_b32 v126, 0
    s_waitcnt lgkmcnt(2)
    v_mfma_f32_16x16x32_bf16 v[108:111], v[156:159], v[84:87], v[108:111]
    ds_read_b128 v[176:179], v213 offset:20992
    v_mov_b32 v127, 0
    v_mov_b32 v136, 0
    v_mfma_f32_16x16x32_bf16 v[128:131], v[156:159], v[88:91], v[128:131]
    v_mov_b32 v138, 0
    v_mov_b32 v139, 0
    v_cmp_eq_u32 s[58:59], 0, v2
    v_mfma_f32_16x16x32_bf16 v[112:115], v[160:163], v[88:91], v[112:115]
    ds_read_b128 v[180:183], v213 offset:31232
    v_mul_f32 v18, -1.0, v144
    v_cvt_pk_bf16_f32 v18, v18, v18
    v_mfma_f32_16x16x32_bf16 v[116:119], v[164:167], v[88:91], v[116:119]
    ds_read_b128 v[184:187], v213 offset:41472
    v_cndmask_b32 v124, 0, v18, s[58:59]
    s_waitcnt lgkmcnt(3) vmcnt(0)
    v_mfma_f32_16x16x32_bf16 v[100:103], v[168:171], v[92:95], v[100:103]
    v_cndmask_b32 v137, 0, v18, s[58:59]
    v_mfma_f32_16x16x32_bf16 v[104:107], v[172:175], v[92:95], v[104:107]
    s_waitcnt lgkmcnt(0)
    v_mfma_f32_16x16x32_bf16 v[108:111], v[176:179], v[92:95], v[108:111]
    v_mfma_f32_16x16x32_bf16 v[128:131], v[176:179], v[96:99], v[128:131]
    v_mfma_f32_16x16x32_bf16 v[112:115], v[180:183], v[96:99], v[112:115]
    v_mfma_f32_16x16x32_bf16 v[116:119], v[184:187], v[96:99], v[116:119]
    v_mfma_f32_16x16x32_bf16 v[100:103], v[132:135], v[124:127], v[100:103]
    v_mfma_f32_16x16x32_bf16 v[104:107], v[132:135], v[136:139], v[104:107]
    v_mfma_f32_16x16x32_bf16 v[108:111], v[132:135], v[122:125], v[108:111]
    s_waitcnt lgkmcnt(0)
    v_cmp_lt_u32 vcc, 1, v2
    s_nop 5
    v_cndmask_b32 v108, v108, v128, vcc
    v_cndmask_b32 v109, v109, v129, vcc
    v_cndmask_b32 v110, v110, v130, vcc
    v_cndmask_b32 v111, v111, v131, vcc
    v_pk_mul_f32 v[100:101], v[100:101], v[16:17] op_sel_hi:[1,0]
    v_pk_mul_f32 v[102:103], v[102:103], v[16:17] op_sel_hi:[1,0]
    v_cvt_pk_bf16_f32 v100, v100, v101
    v_cvt_pk_bf16_f32 v101, v102, v103
    ds_write_b64 v120, v[100:101] offset:0
    v_pk_mul_f32 v[104:105], v[104:105], v[16:17] op_sel_hi:[1,0]
    v_pk_mul_f32 v[106:107], v[106:107], v[16:17] op_sel_hi:[1,0]
    v_cvt_pk_bf16_f32 v104, v104, v105
    v_cvt_pk_bf16_f32 v105, v106, v107
    ds_write_b64 v120, v[104:105] offset:32
    v_pk_mul_f32 v[108:109], v[108:109], v[16:17] op_sel_hi:[1,0]
    v_pk_mul_f32 v[110:111], v[110:111], v[16:17] op_sel_hi:[1,0]
    v_cvt_pk_bf16_f32 v108, v108, v109
    v_cvt_pk_bf16_f32 v109, v110, v111
    ds_write_b64 v120, v[108:109] offset:64
    v_pk_mul_f32 v[112:113], v[112:113], v[16:17] op_sel_hi:[1,0]
    v_pk_mul_f32 v[114:115], v[114:115], v[16:17] op_sel_hi:[1,0]
    v_cvt_pk_bf16_f32 v112, v112, v113
    v_cvt_pk_bf16_f32 v113, v114, v115
    ds_write_b64 v120, v[112:113] offset:96
    v_pk_mul_f32 v[116:117], v[116:117], v[16:17] op_sel_hi:[1,0]
    v_pk_mul_f32 v[118:119], v[118:119], v[16:17] op_sel_hi:[1,0]
    v_cvt_pk_bf16_f32 v116, v116, v117
    v_cvt_pk_bf16_f32 v117, v118, v119
    ds_write_b64 v120, v[116:117] offset:128
    s_waitcnt lgkmcnt(0)
    s_barrier
    ds_read_b64_tr_b16 v[20:21], v121 offset:0
    ds_read_b64_tr_b16 v[22:23], v121 offset:2560
    ds_read_b64_tr_b16 v[28:29], v121 offset:80
    ds_read_b64_tr_b16 v[30:31], v121 offset:2640
    ds_read_b64_tr_b16 v[24:25], v121 offset:5120
    ds_read_b64_tr_b16 v[26:27], v121 offset:7680
    ds_read_b64_tr_b16 v[32:33], v121 offset:5200
    ds_read_b64_tr_b16 v[34:35], v121 offset:7760
    ds_read_b64_tr_b16 v[36:37], v121 offset:8
    ds_read_b64_tr_b16 v[38:39], v121 offset:2568
    ds_read_b64_tr_b16 v[44:45], v121 offset:88
    ds_read_b64_tr_b16 v[46:47], v121 offset:2648
    ds_read_b64_tr_b16 v[40:41], v121 offset:5128
    ds_read_b64_tr_b16 v[42:43], v121 offset:7688
    ds_read_b64_tr_b16 v[48:49], v121 offset:5208
    ds_read_b64_tr_b16 v[50:51], v121 offset:7768
    ds_read_b64_tr_b16 v[52:53], v221 offset:64
    ds_read_b64_tr_b16 v[54:55], v221 offset:2624
    ds_read_b64_tr_b16 v[60:61], v221 offset:144
    ds_read_b64_tr_b16 v[62:63], v221 offset:2704
    ds_read_b64_tr_b16 v[56:57], v221 offset:5184
    ds_read_b64_tr_b16 v[58:59], v221 offset:7744
    ds_read_b64_tr_b16 v[64:65], v221 offset:5264
    ds_read_b64_tr_b16 v[66:67], v221 offset:7824
    s_waitcnt lgkmcnt(14)
    v_mfma_f32_16x16x32_bf16 v[68:71], v[188:191], v[20:23], 0
    v_mfma_f32_16x16x32_bf16 v[72:75], v[188:191], v[28:31], 0
    v_mfma_f32_16x16x32_bf16 v[68:71], v[204:207], v[28:31], v[68:71]
    v_mfma_f32_16x16x32_bf16 v[72:75], v[196:199], v[20:23], v[72:75]
    s_waitcnt lgkmcnt(14)
    v_mfma_f32_16x16x32_bf16 v[68:71], v[192:195], v[24:27], v[68:71]
    v_mfma_f32_16x16x32_bf16 v[72:75], v[192:195], v[32:35], v[72:75]
    v_mfma_f32_16x16x32_bf16 v[68:71], v[208:211], v[32:35], v[68:71]
    v_mfma_f32_16x16x32_bf16 v[72:75], v[200:203], v[24:27], v[72:75]
    s_waitcnt lgkmcnt(12)
    v_mfma_f32_16x16x32_bf16 v[76:79], v[188:191], v[36:39], 0
    v_mfma_f32_16x16x32_bf16 v[80:83], v[188:191], v[44:47], 0
    v_mfma_f32_16x16x32_bf16 v[76:79], v[204:207], v[44:47], v[76:79]
    v_mfma_f32_16x16x32_bf16 v[80:83], v[196:199], v[36:39], v[80:83]
    s_nop 2
    v_cvt_pk_bf16_f32 v92, v68, v72
    s_waitcnt lgkmcnt(8)
    v_mfma_f32_16x16x32_bf16 v[76:79], v[192:195], v[40:43], v[76:79]
    v_cvt_pk_bf16_f32 v94, v69, v73
    v_cvt_pk_bf16_f32 v96, v70, v74
    v_mfma_f32_16x16x32_bf16 v[80:83], v[192:195], v[48:51], v[80:83]
    v_cvt_pk_bf16_f32 v98, v71, v75
    v_mfma_f32_16x16x32_bf16 v[76:79], v[208:211], v[48:51], v[76:79]
    v_mfma_f32_16x16x32_bf16 v[80:83], v[200:203], v[40:43], v[80:83]
    s_waitcnt lgkmcnt(4)
    v_mfma_f32_16x16x32_bf16 v[84:87], v[188:191], v[52:55], 0
    v_mfma_f32_16x16x32_bf16 v[88:91], v[188:191], v[60:63], 0
    v_mfma_f32_16x16x32_bf16 v[84:87], v[204:207], v[60:63], v[84:87]
    v_mfma_f32_16x16x32_bf16 v[88:91], v[196:199], v[52:55], v[88:91]
    s_nop 2
    v_cvt_pk_bf16_f32 v93, v76, v80
    s_waitcnt lgkmcnt(0)
    v_mfma_f32_16x16x32_bf16 v[84:87], v[192:195], v[56:59], v[84:87]
    buffer_store_dwordx2 v[92:93], v222, s[8:11], s69 offen offset:0 sc1
    v_cvt_pk_bf16_f32 v95, v77, v81
    v_mfma_f32_16x16x32_bf16 v[88:91], v[192:195], v[64:67], v[88:91]
    buffer_store_dwordx2 v[94:95], v222, s[8:11], s69 offen offset:128 sc1
    v_cvt_pk_bf16_f32 v97, v78, v82
    v_mfma_f32_16x16x32_bf16 v[84:87], v[208:211], v[64:67], v[84:87]
    buffer_store_dwordx2 v[96:97], v222, s[8:11], s69 offen offset:256 sc1
    v_cvt_pk_bf16_f32 v99, v79, v83
    v_mfma_f32_16x16x32_bf16 v[88:91], v[200:203], v[56:59], v[88:91]
    buffer_store_dwordx2 v[98:99], v222, s[8:11], s69 offen offset:384 sc1
    s_nop 6
    v_cvt_pk_bf16_f32 v84, v84, v88
    v_cvt_pk_bf16_f32 v85, v85, v89
    v_cvt_pk_bf16_f32 v86, v86, v90
    v_cvt_pk_bf16_f32 v87, v87, v91
    s_mov_b32 exec_lo, 0x00ff00ff
    s_mov_b32 exec_hi, 0x00ff00ff
    buffer_store_dwordx4 v[84:87], v223, s[8:11], s69 offen offset:512 sc1
    s_mov_b64 exec, -1
    s_add_u32 s74, s83, 49152
    v_mov_b32 v14, 1
    v_mov_b32 v15, 0
    s_waitcnt vmcnt(0)
    s_mov_b64 exec, 1
    buffer_store_dword v14, v15, s[8:11], s74 offen sc1
    s_mov_b64 exec, -1
    s_lshl_b32 s58, s4, 12
    s_mul_i32 s57, s7, 143360
    s_add_u32 s57, s57, 37748736
    s_add_u32 s59, s58, 81920
    s_add_u32 m0, s59, 0
    s_add_u32 s59, s59, s57
    buffer_load_dwordx4 v3, s[8:11], s59 offen offset:0 sc1 lds
    buffer_load_dwordx4 v3, s[8:11], s59 offen offset:1024 sc1 lds
    buffer_load_dwordx4 v3, s[8:11], s59 offen offset:2048 sc1 lds
    buffer_load_dwordx4 v3, s[8:11], s59 offen offset:3072 sc1 lds
    s_add_u32 s59, s58, 98304
    s_add_u32 m0, s59, 0
    s_add_u32 s59, s59, s57
    buffer_load_dwordx4 v3, s[8:11], s59 offen offset:0 sc1 lds
    buffer_load_dwordx4 v3, s[8:11], s59 offen offset:1024 sc1 lds
    buffer_load_dwordx4 v3, s[8:11], s59 offen offset:2048 sc1 lds
    buffer_load_dwordx4 v3, s[8:11], s59 offen offset:3072 sc1 lds
    s_and_b32 s52, s4, 1
    s_lshl_b32 s52, s52, 4
    v_add_u32 v14, s52, v1
    s_cmp_eq_u32 s87, 0
    s_cselect_b32 s53, 32, 31
    v_sub_u32 v15, s53, v14
    v_and_b32 v15, 31, v15
    v_cvt_f32_u32 v16, v2
    v_cvt_f32_u32 v17, v14
    v_mul_f32 v17, 0.03125, v17
    v_mul_f32 v18, v16, v17
    v_fmamk_f32 v224, v17, 0.0, v18
    v_fract_f32 v224, v224
    v_fmamk_f32 v225, v17, 4.0, v18
    v_fract_f32 v225, v225
    v_sin_f32 v226, v224
    v_sin_f32 v227, v225
    v_cos_f32 v224, v224
    v_cos_f32 v225, v225
    v_cvt_pk_bf16_f32 v20, v224, v226
    v_cvt_pk_bf16_f32 v21, v225, v227
    v_fmamk_f32 v224, v17, 8.0, v18
    v_fract_f32 v224, v224
    v_fmamk_f32 v225, v17, 12.0, v18
    v_fract_f32 v225, v225
    v_sin_f32 v226, v224
    v_sin_f32 v227, v225
    v_cos_f32 v224, v224
    v_cos_f32 v225, v225
    v_cvt_pk_bf16_f32 v22, v224, v226
    v_cvt_pk_bf16_f32 v23, v225, v227
    v_fmamk_f32 v224, v17, 16.0, v18
    v_fract_f32 v224, v224
    v_fmamk_f32 v225, v17, 20.0, v18
    v_fract_f32 v225, v225
    v_sin_f32 v226, v224
    v_sin_f32 v227, v225
    v_cos_f32 v224, v224
    v_cos_f32 v225, v225
    v_cvt_pk_bf16_f32 v24, v224, v226
    v_cvt_pk_bf16_f32 v25, v225, v227
    v_fmamk_f32 v224, v17, 24.0, v18
    v_fract_f32 v224, v224
    v_fmamk_f32 v225, v17, 28.0, v18
    v_fract_f32 v225, v225
    v_sin_f32 v226, v224
    v_sin_f32 v227, v225
    v_cos_f32 v224, v224
    v_cos_f32 v225, v225
    v_cvt_pk_bf16_f32 v26, v224, v226
    v_cvt_pk_bf16_f32 v27, v225, v227
    v_cvt_f32_u32 v17, v15
    v_mul_f32 v17, 0.03125, v17
    v_mul_f32 v18, v16, v17
    v_fmamk_f32 v224, v17, 0.0, v18
    v_fract_f32 v224, v224
    v_fmamk_f32 v225, v17, 4.0, v18
    v_fract_f32 v225, v225
    v_sin_f32 v226, v224
    v_sin_f32 v227, v225
    v_cos_f32 v224, v224
    v_cos_f32 v225, v225
    v_cvt_pk_bf16_f32 v28, v224, v226
    v_cvt_pk_bf16_f32 v29, v225, v227
    v_fmamk_f32 v224, v17, 8.0, v18
    v_fract_f32 v224, v224
    v_fmamk_f32 v225, v17, 12.0, v18
    v_fract_f32 v225, v225
    v_sin_f32 v226, v224
    v_sin_f32 v227, v225
    v_cos_f32 v224, v224
    v_cos_f32 v225, v225
    v_cvt_pk_bf16_f32 v30, v224, v226
    v_cvt_pk_bf16_f32 v31, v225, v227
    v_fmamk_f32 v224, v17, 16.0, v18
    v_fract_f32 v224, v224
    v_fmamk_f32 v225, v17, 20.0, v18
    v_fract_f32 v225, v225
    v_sin_f32 v226, v224
    v_sin_f32 v227, v225
    v_cos_f32 v224, v224
    v_cos_f32 v225, v225
    v_cvt_pk_bf16_f32 v32, v224, v226
    v_cvt_pk_bf16_f32 v33, v225, v227
    v_fmamk_f32 v224, v17, 24.0, v18
    v_fract_f32 v224, v224
    v_fmamk_f32 v225, v17, 28.0, v18
    v_fract_f32 v225, v225
    v_sin_f32 v226, v224
    v_sin_f32 v227, v225
    v_cos_f32 v224, v224
    v_cos_f32 v225, v225
    v_cvt_pk_bf16_f32 v34, v224, v226
    v_cvt_pk_bf16_f32 v35, v225, v227
    v_lshlrev_b32 v124, 16, v4
    v_and_b32 v125, 0xffff0000, v4
    v_lshlrev_b32 v126, 16, v5
    v_and_b32 v127, 0xffff0000, v5
    v_lshlrev_b32 v128, 16, v6
    v_and_b32 v129, 0xffff0000, v6
    v_lshlrev_b32 v130, 16, v7
    v_and_b32 v131, 0xffff0000, v7
    v_lshlrev_b32 v132, 16, v8
    v_and_b32 v133, 0xffff0000, v8
    v_lshlrev_b32 v134, 16, v9
    v_and_b32 v135, 0xffff0000, v9
    v_lshlrev_b32 v136, 16, v10
    v_and_b32 v137, 0xffff0000, v10
    v_lshlrev_b32 v138, 16, v11
    v_and_b32 v139, 0xffff0000, v11
    v_lshlrev_b32 v140, 16, v12
    v_and_b32 v141, 0xffff0000, v12
    v_lshlrev_b32 v142, 16, v13
    v_and_b32 v143, 0xffff0000, v13
    s_and_b32 s52, s5, 15
    s_sub_u32 s53, 16, s52
    s_and_b32 s53, s53, 15
    s_bitcmp1_b32 s5, 4
    s_cselect_b32 s52, s53, s52
    s_lshr_b32 s53, s87, 4
    s_lshl_b32 s53, s53, 1
    s_lshr_b32 s54, 0x9c, s53
    s_and_b32 s54, s54, 3
    s_lshr_b32 s53, s88, 4
    s_lshl_b32 s53, s53, 1
    s_lshr_b32 s55, 0x9c, s53
    s_and_b32 s55, s55, 3
    v_mul_u32_u24 v14, 640, v2
    v_add_u32 v14, 122880, v14
    v_lshl_add_u32 v15, v1, 3, v14
    s_lshl_b32 s53, s54, 7
    v_add_u32 v112, s53, v15
    s_lshl_b32 s53, s55, 7
    v_add_u32 v113, s53, v15
    v_and_b32 v15, 7, v1
    v_lshl_add_u32 v14, v15, 4, v14
    v_mov_b32 v15, s54
    v_mov_b32 v16, s55
    v_cmp_lt_u32 vcc, 7, v1
    s_nop 1
    v_cndmask_b32 v15, v15, v16, vcc
    v_lshl_add_u32 v114, v15, 2, v14
    v_mov_b32 v14, s4
    v_and_b32 v15, 7, v0
    v_lshl_add_u32 v14, v14, 5, v15
    v_lshlrev_b32 v115, 2, v14
    s_lshl_b32 s63, s6, 2
    s_lshr_b32 s53, s52, 2
    s_add_u32 s63, s63, s53
    s_lshl_b32 s63, s63, 9
    s_add_u32 s63, s63, 49152
    s_lshl_b32 s61, s6, 4
    s_add_u32 s61, s61, s52
    s_mul_i32 s61, s61, 20480
    s_mul_i32 s62, s4, 5120
    s_add_u32 s61, s61, s62
    s_add_u32 s61, s61, 7340032
    s_add_u32 m0, s62, 122880
L_interleave_layers__spectral_fnet__dense_activation_squared_relu__prompt_kernel_poll_35:
    buffer_load_dword v14, v115, s[8:11], s63 offen sc1
    s_waitcnt vmcnt(0)
    v_cmp_ne_u32 vcc, 1, v14
    s_nop 4
    s_cbranch_vccz L_interleave_layers__spectral_fnet__dense_activation_squared_relu__prompt_kernel_go_36
    s_cmp_eq_u32 s82, 0
    s_cbranch_scc1 L_interleave_layers__spectral_fnet__dense_activation_squared_relu__prompt_kernel_go_36
    s_sub_u32 s82, s82, 1
    s_branch L_interleave_layers__spectral_fnet__dense_activation_squared_relu__prompt_kernel_poll_35
L_interleave_layers__spectral_fnet__dense_activation_squared_relu__prompt_kernel_go_36:
    buffer_load_dwordx4 v3, s[8:11], s61 offen offset:0 sc1 lds
    buffer_load_dwordx4 v3, s[8:11], s61 offen offset:1024 sc1 lds
    buffer_load_dwordx4 v3, s[8:11], s61 offen offset:2048 sc1 lds
    buffer_load_dwordx4 v3, s[8:11], s61 offen offset:3072 sc1 lds
    s_add_u32 m0, m0, 4096
    s_add_u32 s61, s61, 4096
    buffer_load_dwordx4 v3, s[8:11], s61 offen sc1 lds
    s_mul_i32 s72, s78, 20480
    s_mul_i32 s73, s6, 1280
    s_add_u32 s72, s72, s73
    s_add_u32 s72, s72, 10485760
    s_add_u32 s73, s72, 10240
    v_lshrrev_b32 v14, 1, v2
    v_mul_u32_u24 v14, 10240, v14
    v_lshl_add_u32 v14, v1, 4, v14
    v_and_b32 v15, 1, v2
    v_lshl_add_u32 v18, v15, 3, v14
    s_lshl_b32 s75, s78, 3
    s_add_u32 s75, s75, s6
    s_lshl_b32 s75, s75, 7
    s_add_u32 s75, s75, 131072
    s_mov_b32 s60, 0x3f803f80
    s_cmp_eq_u32 s6, 0
    s_cselect_b32 s56, 0xffff, 0
    s_mov_b32 s57, 0
    v_cmp_lt_u32 vcc, 1, v2
    s_waitcnt vmcnt(0)
    s_barrier
    ds_read_b64 v[144:145], v112 offset:0
    ds_read_b64 v[146:147], v112 offset:2560
    ds_read_b64 v[148:149], v112 offset:5120
    ds_read_b64 v[150:151], v112 offset:7680
    ds_read_b64 v[152:153], v112 offset:10240
    ds_read_b64 v[154:155], v112 offset:12800
    ds_read_b64 v[156:157], v112 offset:15360
    ds_read_b64 v[158:159], v112 offset:17920
    ds_read_b64 v[160:161], v113 offset:0
    ds_read_b64 v[162:163], v113 offset:2560
    ds_read_b64 v[164:165], v113 offset:5120
    ds_read_b64 v[166:167], v113 offset:7680
    ds_read_b64 v[168:169], v113 offset:10240
    ds_read_b64 v[170:171], v113 offset:12800
    ds_read_b64 v[172:173], v113 offset:15360
    ds_read_b64 v[174:175], v113 offset:17920
    ds_read_b32 v68, v114 offset:512
    ds_read_b32 v69, v114 offset:3072
    ds_read_b32 v70, v114 offset:5632
    ds_read_b32 v71, v114 offset:8192
    ds_read_b32 v72, v114 offset:10752
    ds_read_b32 v73, v114 offset:13312
    ds_read_b32 v74, v114 offset:15872
    ds_read_b32 v75, v114 offset:18432
    s_waitcnt lgkmcnt(14)
    v_pk_mov_b32 v[36:37], v[144:145], v[146:147] op_sel:[0,0]
    v_pk_mov_b32 v[38:39], v[148:149], v[150:151] op_sel:[0,0]
    v_pk_mov_b32 v[44:45], v[144:145], v[146:147] op_sel:[1,1]
    v_pk_mov_b32 v[46:47], v[148:149], v[150:151] op_sel:[1,1]
    v_mfma_f32_16x16x32_bf16 v[76:79], v[36:39], v[20:23], v[124:127]
    s_nop 0
    v_mfma_f32_16x16x32_bf16 v[80:83], v[44:47], v[20:23], v[128:131]
    s_waitcnt lgkmcnt(14)
    v_pk_mov_b32 v[40:41], v[152:153], v[154:155] op_sel:[0,0]
    v_pk_mov_b32 v[42:43], v[156:157], v[158:159] op_sel:[0,0]
    v_pk_mov_b32 v[48:49], v[152:153], v[154:155] op_sel:[1,1]
    v_pk_mov_b32 v[50:51], v[156:157], v[158:159] op_sel:[1,1]
    v_mfma_f32_16x16x32_bf16 v[76:79], v[40:43], v[24:27], v[76:79]
    s_nop 0
    v_mfma_f32_16x16x32_bf16 v[80:83], v[48:51], v[24:27], v[80:83]
    s_waitcnt lgkmcnt(12)
    v_pk_mov_b32 v[52:53], v[160:161], v[162:163] op_sel:[0,0]
    v_pk_mov_b32 v[54:55], v[164:165], v[166:167] op_sel:[0,0]
    v_pk_mov_b32 v[60:61], v[160:161], v[162:163] op_sel:[1,1]
    v_pk_mov_b32 v[62:63], v[164:165], v[166:167] op_sel:[1,1]
    v_mfma_f32_16x16x32_bf16 v[84:87], v[52:55], v[28:31], v[132:135]
    s_nop 0
    v_mfma_f32_16x16x32_bf16 v[88:91], v[60:63], v[28:31], v[136:139]
    s_waitcnt lgkmcnt(8)
    v_pk_mov_b32 v[56:57], v[168:169], v[170:171] op_sel:[0,0]
    v_pk_mov_b32 v[58:59], v[172:173], v[174:175] op_sel:[0,0]
    v_pk_mov_b32 v[64:65], v[168:169], v[170:171] op_sel:[1,1]
    v_pk_mov_b32 v[66:67], v[172:173], v[174:175] op_sel:[1,1]
    v_mfma_f32_16x16x32_bf16 v[84:87], v[56:59], v[32:35], v[84:87]
    s_nop 0
    v_mfma_f32_16x16x32_bf16 v[88:91], v[64:67], v[32:35], v[88:91]
    s_waitcnt lgkmcnt(0)
    v_mfma_f32_16x16x32_bf16 v[92:95], v[68:71], v[20:23], v[140:143]
    v_mfma_f32_16x16x32_bf16 v[96:99], v[68:71], v[28:31], v[140:143]
    v_mfma_f32_16x16x32_bf16 v[92:95], v[72:75], v[24:27], v[92:95]
    v_mfma_f32_16x16x32_bf16 v[96:99], v[72:75], v[32:35], v[96:99]
    v_cndmask_b32 v76, v76, v124, s[56:57]
    v_cvt_pk_bf16_f32 v4, v76, v77
    v_cvt_pk_bf16_f32 v5, v78, v79
    v_cvt_pk_bf16_f32 v6, v80, v81
    v_cvt_pk_bf16_f32 v7, v82, v83
    buffer_store_dwordx4 v[4:7], v3, s[8:11], s72 offen sc1
    v_cvt_pk_bf16_f32 v8, v84, v85
    v_cvt_pk_bf16_f32 v9, v86, v87
    v_cvt_pk_bf16_f32 v10, v88, v89
    v_cvt_pk_bf16_f32 v11, v90, v91
    buffer_store_dwordx4 v[8:11], v3, s[8:11], s73 offen sc1
    v_cndmask_b32 v92, v92, v96, vcc
    v_cndmask_b32 v93, v93, v97, vcc
    v_cndmask_b32 v94, v94, v98, vcc
    v_cndmask_b32 v95, v95, v99, vcc
    v_cvt_pk_bf16_f32 v12, v92, v93
    v_cvt_pk_bf16_f32 v13, v94, v95
    buffer_store_dwordx2 v[12:13], v18, s[8:11], s72 offen offset:1024 sc1
    v_dot2_f32_bf16 v16, v4, s60, 0
    v_dot2_f32_bf16 v17, v4, v4, 0
    v_dot2_f32_bf16 v16, v5, s60, v16
    v_dot2_f32_bf16 v17, v5, v5, v17
    v_dot2_f32_bf16 v16, v6, s60, v16
    v_dot2_f32_bf16 v17, v6, v6, v17
    v_dot2_f32_bf16 v16, v7, s60, v16
    v_dot2_f32_bf16 v17, v7, v7, v17
    v_dot2_f32_bf16 v16, v8, s60, v16
    v_dot2_f32_bf16 v17, v8, v8, v17
    v_dot2_f32_bf16 v16, v9, s60, v16
    v_dot2_f32_bf16 v17, v9, v9, v17
    v_dot2_f32_bf16 v16, v10, s60, v16
    v_dot2_f32_bf16 v17, v10, v10, v17
    v_dot2_f32_bf16 v16, v11, s60, v16
    v_dot2_f32_bf16 v17, v11, v11, v17
    v_dot2_f32_bf16 v16, v12, s60, v16
    v_dot2_f32_bf16 v17, v12, v12, v17
    v_dot2_f32_bf16 v16, v13, s60, v16
    v_dot2_f32_bf16 v17, v13, v13, v17
    s_nop 1
    v_mov_b32 v14, v16
    v_mov_b32 v15, v17
    s_nop 0
    v_permlane32_swap_b32 v16, v14
    v_permlane32_swap_b32 v17, v15
    v_pk_add_f32 v[16:17], v[16:17], v[14:15]
    v_mov_b32 v14, v16
    v_mov_b32 v15, v17
    s_nop 0
    v_permlane16_swap_b32 v16, v14
    v_permlane16_swap_b32 v17, v15
    v_pk_add_f32 v[16:17], v[16:17], v[14:15]
    v_lshlrev_b32 v14, 3, v0
    s_mov_b64 exec, 0xffff
    buffer_store_dwordx2 v[16:17], v14, s[8:11], s75 offen sc1
    s_mov_b64 exec, -1
    v_add_u32 v224, 64512, v3
    v_add_u32 v225, 129024, v3
    v_lshlrev_b32 v226, 4, v1
    v_add_u32 v226, 153600, v226
    v_and_b32 v14, 1, v2
    v_mul_u32_u24 v14, 55296, v14
    v_lshl_add_u32 v14, v1, 4, v14
    v_lshrrev_b32 v15, 1, v2
    v_lshl_add_u32 v227, v15, 8, v14
    s_mul_i32 s61, s89, 55296
    s_lshl_b32 s53, s80, 5
    s_add_u32 s61, s61, s53
    s_add_u32 s61, s61, 20971520
    s_add_u32 s64, s61, s86
    s_mov_b32 s63, 8192
    s_mul_i32 s65, s89, 20480
    s_add_u32 s65, s65, 10485760
    s_add_u32 s66, s65, 4096
    s_add_u32 s67, s65, 8192
    s_add_u32 s68, s65, 12288
    s_add_u32 s69, s65, 16384
    s_add_u32 s70, s65, 20480
    s_add_u32 s71, s65, 24576
    s_add_u32 s72, s65, 28672
    s_add_u32 s73, s65, 32768
    s_add_u32 s60, s65, 36864
    s_lshl_b32 s62, s89, 10
    s_add_u32 s62, s62, 131072
    s_lshl_b32 s75, s78, 10
    s_add_u32 s75, s75, 131072
    s_lshl_b32 s52, s89, 3
    v_add_u32 v14, s52, v1
    s_lshl_b32 s52, s78, 3
    v_and_b32 v15, 7, v0
    v_add_u32 v15, s52, v15
    v_cmp_gt_u32 vcc, 16, v0
    s_nop 1
    v_cndmask_b32 v14, v15, v14, vcc
    v_lshlrev_b32 v228, 2, v14
    v_lshlrev_b32 v18, 8, v2
    v_lshl_add_u32 v18, v1, 3, v18
    s_add_u32 s74, s84, 8192
    v_mov_b32 v14, 1
    v_mov_b32 v15, 0
    s_waitcnt vmcnt(0)
    s_mov_b64 exec, 1
    s_cmp_eq_u32 s91, 1
    s_cbranch_scc0 L_interleave_layers__spectral_fnet__dense_activation_squared_relu__prompt_kernel_far_37
    buffer_store_dword v14, v15, s[8:11], s74 offen
    s_branch L_interleave_layers__spectral_fnet__dense_activation_squared_relu__prompt_kernel_set_38
L_interleave_layers__spectral_fnet__dense_activation_squared_relu__prompt_kernel_far_37:
    buffer_store_dword v14, v15, s[8:11], s74 offen sc1
L_interleave_layers__spectral_fnet__dense_activation_squared_relu__prompt_kernel_set_38:
    s_mov_b64 exec, -1
    s_lshl_b32 s58, s4, 12
    s_mul_i32 s57, s7, 143360
    s_add_u32 s57, s57, 37748736
    ds_read_b128 v[76:79], v3 offset:0
    ds_read_b128 v[80:83], v3 offset:1024
    ds_read_b128 v[84:87], v3 offset:2048
    ds_read_b128 v[88:91], v3 offset:3072
    ds_read_b128 v[92:95], v3 offset:4096
    ds_read_b128 v[96:99], v3 offset:5120
    ds_read_b128 v[100:103], v3 offset:6144
L_interleave_layers__spectral_fnet__dense_activation_squared_relu__prompt_kernel_poll_39:
    buffer_load_dword v14, v228, s[8:11], s63 offen sc1
    s_waitcnt vmcnt(0)
    v_cmp_ne_u32 vcc, 1, v14
    s_nop 4
    s_cbranch_vccz L_interleave_layers__spectral_fnet__dense_activation_squared_relu__prompt_kernel_go_40
    s_cmp_eq_u32 s82, 0
    s_cbranch_scc1 L_interleave_layers__spectral_fnet__dense_activation_squared_relu__prompt_kernel_go_40
    s_sub_u32 s82, s82, 1
    s_branch L_interleave_layers__spectral_fnet__dense_activation_squared_relu__prompt_kernel_poll_39
L_interleave_layers__spectral_fnet__dense_activation_squared_relu__prompt_kernel_go_40:
    buffer_load_dwordx4 v[108:111], v3, s[8:11], s65 offen offset:0 sc1
    buffer_load_dwordx4 v[112:115], v3, s[8:11], s70 offen offset:0 sc1
    buffer_load_dwordx4 v[116:119], v3, s[8:11], s65 offen offset:1024 sc1
    buffer_load_dwordx4 v[120:123], v3, s[8:11], s70 offen offset:1024 sc1
    buffer_load_dwordx4 v[124:127], v3, s[8:11], s65 offen offset:2048 sc1
    buffer_load_dwordx4 v[128:131], v3, s[8:11], s70 offen offset:2048 sc1
    buffer_load_dwordx4 v[132:135], v3, s[8:11], s65 offen offset:3072 sc1
    buffer_load_dwordx4 v[136:139], v3, s[8:11], s70 offen offset:3072 sc1
    buffer_load_dwordx2 v[212:213], v18, s[8:11], s62 offen offset:0 sc1
    buffer_load_dwordx2 v[214:215], v18, s[8:11], s62 offen offset:128 sc1
    buffer_load_dwordx2 v[216:217], v18, s[8:11], s62 offen offset:1024 sc1
    buffer_load_dwordx2 v[218:219], v18, s[8:11], s62 offen offset:1152 sc1
    s_barrier
    s_waitcnt vmcnt(10) lgkmcnt(5)
    v_mfma_f32_16x16x32_bf16 v[20:23], v[76:79], v[108:111], 0
    v_mfma_f32_16x16x32_bf16 v[48:51], v[76:79], v[112:115], 0
    ds_read_b128 v[104:107], v3 offset:7168
    v_mfma_f32_16x16x32_bf16 v[24:27], v[80:83], v[108:111], 0
    buffer_load_dwordx4 v[140:143], v3, s[8:11], s66 offen offset:0 sc1
    v_mfma_f32_16x16x32_bf16 v[52:55], v[80:83], v[112:115], 0
    ds_read_b128 v[76:79], v3 offset:8192
    s_waitcnt lgkmcnt(5)
    v_mfma_f32_16x16x32_bf16 v[28:31], v[84:87], v[108:111], 0
    v_mfma_f32_16x16x32_bf16 v[56:59], v[84:87], v[112:115], 0
    ds_read_b128 v[80:83], v3 offset:9216
    v_mfma_f32_16x16x32_bf16 v[32:35], v[88:91], v[108:111], 0
    buffer_load_dwordx4 v[144:147], v3, s[8:11], s71 offen offset:0 sc1
    v_mfma_f32_16x16x32_bf16 v[60:63], v[88:91], v[112:115], 0
    ds_read_b128 v[84:87], v3 offset:10240
    s_waitcnt lgkmcnt(5)
    v_mfma_f32_16x16x32_bf16 v[36:39], v[92:95], v[108:111], 0
    v_mfma_f32_16x16x32_bf16 v[64:67], v[92:95], v[112:115], 0
    ds_read_b128 v[88:91], v3 offset:11264
    v_mfma_f32_16x16x32_bf16 v[40:43], v[96:99], v[108:111], 0
    buffer_load_dwordx4 v[148:151], v3, s[8:11], s66 offen offset:1024 sc1
    v_mfma_f32_16x16x32_bf16 v[68:71], v[96:99], v[112:115], 0
    ds_read_b128 v[92:95], v3 offset:12288
    s_waitcnt lgkmcnt(5)
    v_mfma_f32_16x16x32_bf16 v[44:47], v[100:103], v[108:111], 0
    v_mfma_f32_16x16x32_bf16 v[72:75], v[100:103], v[112:115], 0
    ds_read_b128 v[96:99], v3 offset:13312
    s_waitcnt vmcnt(11)
    v_mfma_f32_16x16x32_bf16 v[20:23], v[104:107], v[116:119], v[20:23]
    buffer_load_dwordx4 v[152:155], v3, s[8:11], s71 offen offset:1024 sc1
    v_mfma_f32_16x16x32_bf16 v[48:51], v[104:107], v[120:123], v[48:51]
    ds_read_b128 v[100:103], v3 offset:14336
    s_waitcnt lgkmcnt(5)
    v_mfma_f32_16x16x32_bf16 v[24:27], v[76:79], v[116:119], v[24:27]
    v_mfma_f32_16x16x32_bf16 v[52:55], v[76:79], v[120:123], v[52:55]
    ds_read_b128 v[104:107], v3 offset:15360
    v_mfma_f32_16x16x32_bf16 v[28:31], v[80:83], v[116:119], v[28:31]
    buffer_load_dwordx4 v[156:159], v3, s[8:11], s66 offen offset:2048 sc1
    v_mfma_f32_16x16x32_bf16 v[56:59], v[80:83], v[120:123], v[56:59]
    ds_read_b128 v[76:79], v3 offset:16384
    s_waitcnt lgkmcnt(5)
    v_mfma_f32_16x16x32_bf16 v[32:35], v[84:87], v[116:119], v[32:35]
    buffer_load_dwordx4 v[160:163], v3, s[8:11], s71 offen offset:2048 sc1
    v_mfma_f32_16x16x32_bf16 v[60:63], v[84:87], v[120:123], v[60:63]
    ds_read_b128 v[80:83], v3 offset:17408
    v_mfma_f32_16x16x32_bf16 v[36:39], v[88:91], v[116:119], v[36:39]
    v_mfma_f32_16x16x32_bf16 v[64:67], v[88:91], v[120:123], v[64:67]
    ds_read_b128 v[84:87], v3 offset:18432
    s_waitcnt lgkmcnt(5)
    v_mfma_f32_16x16x32_bf16 v[40:43], v[92:95], v[116:119], v[40:43]
    buffer_load_dwordx4 v[164:167], v3, s[8:11], s66 offen offset:3072 sc1
    v_mfma_f32_16x16x32_bf16 v[68:71], v[92:95], v[120:123], v[68:71]
    ds_read_b128 v[88:91], v3 offset:19456
    v_mfma_f32_16x16x32_bf16 v[44:47], v[96:99], v[116:119], v[44:47]
    v_mfma_f32_16x16x32_bf16 v[72:75], v[96:99], v[120:123], v[72:75]
    ds_read_b128 v[92:95], v3 offset:20480
    s_waitcnt vmcnt(13) lgkmcnt(5)
    v_mfma_f32_16x16x32_bf16 v[20:23], v[100:103], v[124:127], v[20:23]
    buffer_load_dwordx4 v[168:171], v3, s[8:11], s71 offen offset:3072 sc1
    v_mfma_f32_16x16x32_bf16 v[48:51], v[100:103], v[128:131], v[48:51]
    ds_read_b128 v[96:99], v3 offset:21504
    v_mfma_f32_16x16x32_bf16 v[24:27], v[104:107], v[124:127], v[24:27]
    v_mfma_f32_16x16x32_bf16 v[52:55], v[104:107], v[128:131], v[52:55]
    ds_read_b128 v[100:103], v3 offset:22528
    s_waitcnt lgkmcnt(5)
    v_mfma_f32_16x16x32_bf16 v[28:31], v[76:79], v[124:127], v[28:31]
    s_add_u32 s59, s58, 114688
    s_add_u32 m0, s59, 0
    s_add_u32 s59, s59, s57
    buffer_load_dwordx4 v3, s[8:11], s59 offen offset:0 sc1 lds
    v_mfma_f32_16x16x32_bf16 v[56:59], v[76:79], v[128:131], v[56:59]
    ds_read_b128 v[104:107], v3 offset:23552
    v_mfma_f32_16x16x32_bf16 v[32:35], v[80:83], v[124:127], v[32:35]
    v_mfma_f32_16x16x32_bf16 v[60:63], v[80:83], v[128:131], v[60:63]
    ds_read_b128 v[76:79], v3 offset:24576
    s_waitcnt lgkmcnt(5)
    v_mfma_f32_16x16x32_bf16 v[36:39], v[84:87], v[124:127], v[36:39]
    buffer_load_dwordx4 v3, s[8:11], s59 offen offset:1024 sc1 lds
    v_mfma_f32_16x16x32_bf16 v[64:67], v[84:87], v[128:131], v[64:67]
    ds_read_b128 v[80:83], v3 offset:25600
    v_mfma_f32_16x16x32_bf16 v[40:43], v[88:91], v[124:127], v[40:43]
    buffer_load_dwordx4 v3, s[8:11], s59 offen offset:2048 sc1 lds
    v_mfma_f32_16x16x32_bf16 v[68:71], v[88:91], v[128:131], v[68:71]
    ds_read_b128 v[84:87], v3 offset:26624
    s_waitcnt lgkmcnt(5)
    v_mfma_f32_16x16x32_bf16 v[44:47], v[92:95], v[124:127], v[44:47]
    v_mfma_f32_16x16x32_bf16 v[72:75], v[92:95], v[128:131], v[72:75]
    ds_read_b128 v[88:91], v3 offset:27648
    s_waitcnt vmcnt(15)
    v_mfma_f32_16x16x32_bf16 v[20:23], v[96:99], v[132:135], v[20:23]
    buffer_load_dwordx4 v3, s[8:11], s59 offen offset:3072 sc1 lds
    s_waitcnt vmcnt(12)
    v_mfma_f32_16x16x32_bf16 v[48:51], v[96:99], v[136:139], v[48:51]
    ds_read_b128 v[92:95], v3 offset:28672
    s_waitcnt lgkmcnt(5)
    v_mfma_f32_16x16x32_bf16 v[24:27], v[100:103], v[132:135], v[24:27]
    v_add_f32 v220, v212, v214
    v_add_f32 v222, v216, v218
    v_mfma_f32_16x16x32_bf16 v[52:55], v[100:103], v[136:139], v[52:55]
    ds_read_b128 v[96:99], v3 offset:29696
    v_add_f32 v221, v213, v215
    v_mfma_f32_16x16x32_bf16 v[28:31], v[104:107], v[132:135], v[28:31]
    s_add_u32 s59, s58, 131072
    s_min_u32 s59, s59, 139264
    s_add_u32 m0, s59, 0
    s_add_u32 s59, s59, s57
    buffer_load_dwordx4 v3, s[8:11], s59 offen offset:0 sc1 lds
    v_mfma_f32_16x16x32_bf16 v[56:59], v[104:107], v[136:139], v[56:59]
    ds_read_b128 v[100:103], v3 offset:30720
    s_waitcnt lgkmcnt(5)
    v_mfma_f32_16x16x32_bf16 v[32:35], v[76:79], v[132:135], v[32:35]
    v_add_f32 v223, v217, v219
    v_mfma_f32_16x16x32_bf16 v[60:63], v[76:79], v[136:139], v[60:63]
    ds_read_b128 v[104:107], v3 offset:31744
    v_mfma_f32_16x16x32_bf16 v[36:39], v[80:83], v[132:135], v[36:39]
    buffer_load_dwordx4 v3, s[8:11], s59 offen offset:1024 sc1 lds
    v_mfma_f32_16x16x32_bf16 v[64:67], v[80:83], v[136:139], v[64:67]
    ds_read_b128 v[76:79], v3 offset:32768
    s_waitcnt lgkmcnt(5)
    v_mfma_f32_16x16x32_bf16 v[40:43], v[84:87], v[132:135], v[40:43]
    v_permlane32_swap_b32 v220, v222
    v_mfma_f32_16x16x32_bf16 v[68:71], v[84:87], v[136:139], v[68:71]
    ds_read_b128 v[80:83], v3 offset:33792
    v_mfma_f32_16x16x32_bf16 v[44:47], v[88:91], v[132:135], v[44:47]
    buffer_load_dwordx4 v3, s[8:11], s59 offen offset:2048 sc1 lds
    v_mfma_f32_16x16x32_bf16 v[72:75], v[88:91], v[136:139], v[72:75]
    ds_read_b128 v[84:87], v3 offset:34816
    s_waitcnt vmcnt(13) lgkmcnt(5)
    v_mfma_f32_16x16x32_bf16 v[20:23], v[92:95], v[140:143], v[20:23]
    v_permlane32_swap_b32 v221, v223
    v_mfma_f32_16x16x32_bf16 v[48:51], v[92:95], v[144:147], v[48:51]
    ds_read_b128 v[88:91], v3 offset:35840
    v_add_f32 v220, v220, v222
    v_mfma_f32_16x16x32_bf16 v[24:27], v[96:99], v[140:143], v[24:27]
    buffer_load_dwordx4 v3, s[8:11], s59 offen offset:3072 sc1 lds
    v_add_f32 v221, v221, v223
    v_mfma_f32_16x16x32_bf16 v[52:55], v[96:99], v[144:147], v[52:55]
    ds_read_b128 v[92:95], v3 offset:36864
    s_waitcnt lgkmcnt(5)
    v_mfma_f32_16x16x32_bf16 v[28:31], v[100:103], v[140:143], v[28:31]
    buffer_load_dwordx4 v[172:175], v3, s[8:11], s67 offen offset:0 sc1
    v_mov_b32 v222, v220
    v_mfma_f32_16x16x32_bf16 v[56:59], v[100:103], v[144:147], v[56:59]
    ds_read_b128 v[96:99], v3 offset:37888
    v_mov_b32 v223, v221
    v_mfma_f32_16x16x32_bf16 v[32:35], v[104:107], v[140:143], v[32:35]
    v_permlane16_swap_b32 v220, v222
    v_mfma_f32_16x16x32_bf16 v[60:63], v[104:107], v[144:147], v[60:63]
    ds_read_b128 v[100:103], v3 offset:38912
    s_waitcnt lgkmcnt(5)
    v_mfma_f32_16x16x32_bf16 v[36:39], v[76:79], v[140:143], v[36:39]
    buffer_load_dwordx4 v[176:179], v3, s[8:11], s72 offen offset:0 sc1
    v_mfma_f32_16x16x32_bf16 v[64:67], v[76:79], v[144:147], v[64:67]
    ds_read_b128 v[104:107], v3 offset:39936
    v_mfma_f32_16x16x32_bf16 v[40:43], v[80:83], v[140:143], v[40:43]
    v_permlane16_swap_b32 v221, v223
    v_mfma_f32_16x16x32_bf16 v[68:71], v[80:83], v[144:147], v[68:71]
    ds_read_b128 v[76:79], v3 offset:40960
    s_waitcnt lgkmcnt(5)
    v_mfma_f32_16x16x32_bf16 v[44:47], v[84:87], v[140:143], v[44:47]
    buffer_load_dwordx4 v[180:183], v3, s[8:11], s67 offen offset:1024 sc1
    v_add_f32 v220, v220, v222
    v_mfma_f32_16x16x32_bf16 v[72:75], v[84:87], v[144:147], v[72:75]
    ds_read_b128 v[80:83], v3 offset:41984
    s_waitcnt vmcnt(15)
    v_mfma_f32_16x16x32_bf16 v[20:23], v[88:91], v[148:151], v[20:23]
    v_add_f32 v221, v221, v223
    v_mul_f32 v220, 0.0015625, v220
    v_mfma_f32_16x16x32_bf16 v[48:51], v[88:91], v[152:155], v[48:51]
    ds_read_b128 v[84:87], v3 offset:43008
    s_waitcnt lgkmcnt(5)
    v_mfma_f32_16x16x32_bf16 v[24:27], v[92:95], v[148:151], v[24:27]
    buffer_load_dwordx4 v[184:187], v3, s[8:11], s72 offen offset:1024 sc1
    v_mul_f32 v221, 0.0015625, v221
    v_mfma_f32_16x16x32_bf16 v[52:55], v[92:95], v[152:155], v[52:55]
    ds_read_b128 v[88:91], v3 offset:44032
    v_fma_f32 v221, -v220, v220, v221
    v_mfma_f32_16x16x32_bf16 v[28:31], v[96:99], v[148:151], v[28:31]
    v_max_f32 v221, 0, v221
    v_cvt_pk_bf16_f32 v14, v220, v221
    v_mfma_f32_16x16x32_bf16 v[56:59], v[96:99], v[152:155], v[56:59]
    ds_read_b128 v[92:95], v3 offset:45056
    s_waitcnt lgkmcnt(5)
    v_mfma_f32_16x16x32_bf16 v[32:35], v[100:103], v[148:151], v[32:35]
    buffer_load_dwordx4 v[188:191], v3, s[8:11], s67 offen offset:2048 sc1
    v_lshlrev_b32 v220, 16, v14
    v_mfma_f32_16x16x32_bf16 v[60:63], v[100:103], v[152:155], v[60:63]
    ds_read_b128 v[96:99], v3 offset:46080
    v_and_b32 v221, 0xffff0000, v14
    v_mfma_f32_16x16x32_bf16 v[36:39], v[104:107], v[148:151], v[36:39]
    buffer_load_dwordx4 v[192:195], v3, s[8:11], s72 offen offset:2048 sc1
    v_add_f32 v221, 0x3727c5ac, v221
    v_mfma_f32_16x16x32_bf16 v[64:67], v[104:107], v[152:155], v[64:67]
    ds_read_b128 v[100:103], v3 offset:47104
    s_waitcnt lgkmcnt(5)
    v_mfma_f32_16x16x32_bf16 v[40:43], v[76:79], v[148:151], v[40:43]
    v_cvt_pk_bf16_f32 v14, v221, v221
    v_lshlrev_b32 v221, 16, v14
    v_mfma_f32_16x16x32_bf16 v[68:71], v[76:79], v[152:155], v[68:71]
    ds_read_b128 v[104:107], v3 offset:48128
    v_mfma_f32_16x16x32_bf16 v[44:47], v[80:83], v[148:151], v[44:47]
    buffer_load_dwordx4 v[196:199], v3, s[8:11], s67 offen offset:3072 sc1
    v_mfma_f32_16x16x32_bf16 v[72:75], v[80:83], v[152:155], v[72:75]
    ds_read_b128 v[76:79], v3 offset:49152
    s_waitcnt vmcnt(17) lgkmcnt(5)
    v_mfma_f32_16x16x32_bf16 v[20:23], v[84:87], v[156:159], v[20:23]
    v_sqrt_f32 v221, v221
    v_mfma_f32_16x16x32_bf16 v[48:51], v[84:87], v[160:163], v[48:51]
    ds_read_b128 v[80:83], v3 offset:50176
    v_cvt_pk_bf16_f32 v14, v221, v221
    v_mfma_f32_16x16x32_bf16 v[24:27], v[88:91], v[156:159], v[24:27]
    buffer_load_dwordx4 v[200:203], v3, s[8:11], s72 offen offset:3072 sc1
    v_lshlrev_b32 v221, 16, v14
    v_mfma_f32_16x16x32_bf16 v[52:55], v[88:91], v[160:163], v[52:55]
    ds_read_b128 v[84:87], v3 offset:51200
    s_waitcnt lgkmcnt(5)
    v_mfma_f32_16x16x32_bf16 v[28:31], v[92:95], v[156:159], v[28:31]
    v_mov_b32 v222, v220
    v_mov_b32 v223, v221
    v_mfma_f32_16x16x32_bf16 v[56:59], v[92:95], v[160:163], v[56:59]
    ds_read_b128 v[88:91], v3 offset:52224
    v_mfma_f32_16x16x32_bf16 v[32:35], v[96:99], v[156:159], v[32:35]
    buffer_load_dwordx4 v[108:111], v3, s[8:11], s68 offen offset:0 sc1
    v_mfma_f32_16x16x32_bf16 v[60:63], v[96:99], v[160:163], v[60:63]
    ds_read_b128 v[92:95], v3 offset:53248
    s_waitcnt lgkmcnt(5)
    v_mfma_f32_16x16x32_bf16 v[36:39], v[100:103], v[156:159], v[36:39]
    v_permlane32_swap_b32 v220, v222
    v_mfma_f32_16x16x32_bf16 v[64:67], v[100:103], v[160:163], v[64:67]
    ds_read_b128 v[96:99], v3 offset:54272
    v_mfma_f32_16x16x32_bf16 v[40:43], v[104:107], v[156:159], v[40:43]
    buffer_load_dwordx4 v[112:115], v3, s[8:11], s73 offen offset:0 sc1
    v_mfma_f32_16x16x32_bf16 v[68:71], v[104:107], v[160:163], v[68:71]
    ds_read_b128 v[100:103], v3 offset:55296
    s_waitcnt lgkmcnt(5)
    v_mfma_f32_16x16x32_bf16 v[44:47], v[76:79], v[156:159], v[44:47]
    v_permlane32_swap_b32 v221, v223
    v_mfma_f32_16x16x32_bf16 v[72:75], v[76:79], v[160:163], v[72:75]
    ds_read_b128 v[104:107], v3 offset:56320
    s_waitcnt vmcnt(18)
    v_mfma_f32_16x16x32_bf16 v[20:23], v[80:83], v[164:167], v[20:23]
    buffer_load_dwordx4 v[116:119], v3, s[8:11], s68 offen offset:1024 sc1
    v_cmp_eq_u32 vcc, 0, v2
    v_mfma_f32_16x16x32_bf16 v[48:51], v[80:83], v[168:171], v[48:51]
    ds_read_b128 v[76:79], v226 offset:0
    s_waitcnt lgkmcnt(5)
    v_mfma_f32_16x16x32_bf16 v[24:27], v[84:87], v[164:167], v[24:27]
    buffer_load_dwordx4 v[120:123], v3, s[8:11], s73 offen offset:1024 sc1
    v_cvt_pk_bf16_f32 v14, -v220, -v220
    v_mfma_f32_16x16x32_bf16 v[52:55], v[84:87], v[168:171], v[52:55]
    ds_read_b128 v[80:83], v226 offset:256
    v_lshrrev_b32 v15, 16, v221
    v_mfma_f32_16x16x32_bf16 v[28:31], v[88:91], v[164:167], v[28:31]
    v_cndmask_b32 v212, 0, v14, vcc
    v_cndmask_b32 v213, 0, v15, vcc
    v_mfma_f32_16x16x32_bf16 v[56:59], v[88:91], v[168:171], v[56:59]
    ds_read_b128 v[84:87], v226 offset:512
    s_waitcnt lgkmcnt(5)
    v_mfma_f32_16x16x32_bf16 v[32:35], v[92:95], v[164:167], v[32:35]
    buffer_load_dwordx4 v[124:127], v3, s[8:11], s68 offen offset:2048 sc1
    v_mov_b32 v214, 0
    v_mfma_f32_16x16x32_bf16 v[60:63], v[92:95], v[168:171], v[60:63]
    ds_read_b128 v[88:91], v226 offset:768
    v_mov_b32 v215, 0
    v_mfma_f32_16x16x32_bf16 v[36:39], v[96:99], v[164:167], v[36:39]
    v_cvt_pk_bf16_f32 v14, -v222, -v222
    v_lshrrev_b32 v15, 16, v223
    v_mfma_f32_16x16x32_bf16 v[64:67], v[96:99], v[168:171], v[64:67]
    ds_read_b128 v[92:95], v226 offset:1024
    s_waitcnt lgkmcnt(5)
    v_mfma_f32_16x16x32_bf16 v[40:43], v[100:103], v[164:167], v[40:43]
    buffer_load_dwordx4 v[128:131], v3, s[8:11], s73 offen offset:2048 sc1
    v_cndmask_b32 v216, 0, v14, vcc
    v_mfma_f32_16x16x32_bf16 v[68:71], v[100:103], v[168:171], v[68:71]
    ds_read_b128 v[96:99], v226 offset:1280
    v_cndmask_b32 v217, 0, v15, vcc
    v_mfma_f32_16x16x32_bf16 v[44:47], v[104:107], v[164:167], v[44:47]
    v_mov_b32 v218, 0
    v_mov_b32 v219, 0
    v_mfma_f32_16x16x32_bf16 v[72:75], v[104:107], v[168:171], v[72:75]
    ds_read_b128 v[100:103], v226 offset:1536
    s_waitcnt lgkmcnt(5)
    v_mfma_f32_16x16x32_bf16 v[20:23], v[76:79], v[212:215], v[20:23]
    buffer_load_dwordx4 v[132:135], v3, s[8:11], s68 offen offset:3072 sc1
    v_mfma_f32_16x16x32_bf16 v[48:51], v[76:79], v[216:219], v[48:51]
    ds_read_b128 v[104:107], v3 offset:57344
    v_mfma_f32_16x16x32_bf16 v[24:27], v[80:83], v[212:215], v[24:27]
    v_mfma_f32_16x16x32_bf16 v[52:55], v[80:83], v[216:219], v[52:55]
    ds_read_b128 v[76:79], v3 offset:58368
    s_waitcnt lgkmcnt(5)
    v_mfma_f32_16x16x32_bf16 v[28:31], v[84:87], v[212:215], v[28:31]
    buffer_load_dwordx4 v[136:139], v3, s[8:11], s73 offen offset:3072 sc1
    v_mfma_f32_16x16x32_bf16 v[56:59], v[84:87], v[216:219], v[56:59]
    ds_read_b128 v[80:83], v3 offset:59392
    v_mfma_f32_16x16x32_bf16 v[32:35], v[88:91], v[212:215], v[32:35]
    buffer_load_dwordx4 v[140:143], v3, s[8:11], s69 offen offset:0 sc1
    v_mfma_f32_16x16x32_bf16 v[60:63], v[88:91], v[216:219], v[60:63]
    ds_read_b128 v[84:87], v3 offset:60416
    s_waitcnt lgkmcnt(5)
    v_mfma_f32_16x16x32_bf16 v[36:39], v[92:95], v[212:215], v[36:39]
    v_mfma_f32_16x16x32_bf16 v[64:67], v[92:95], v[216:219], v[64:67]
    ds_read_b128 v[88:91], v3 offset:61440
    v_mfma_f32_16x16x32_bf16 v[40:43], v[96:99], v[212:215], v[40:43]
    buffer_load_dwordx4 v[144:147], v3, s[8:11], s60 offen offset:0 sc1
    v_mfma_f32_16x16x32_bf16 v[68:71], v[96:99], v[216:219], v[68:71]
    ds_read_b128 v[92:95], v3 offset:62464
    s_waitcnt lgkmcnt(5)
    v_mfma_f32_16x16x32_bf16 v[44:47], v[100:103], v[212:215], v[44:47]
    v_mfma_f32_16x16x32_bf16 v[72:75], v[100:103], v[216:219], v[72:75]
    ds_read_b128 v[96:99], v3 offset:63488
    s_waitcnt vmcnt(16)
    v_mfma_f32_16x16x32_bf16 v[20:23], v[104:107], v[172:175], v[20:23]
    buffer_load_dwordx4 v[148:151], v3, s[8:11], s69 offen offset:1024 sc1
    v_mfma_f32_16x16x32_bf16 v[48:51], v[104:107], v[176:179], v[48:51]
    ds_read_b128 v[100:103], v224 offset:0
    s_waitcnt lgkmcnt(5)
    v_mfma_f32_16x16x32_bf16 v[24:27], v[76:79], v[172:175], v[24:27]
    v_mfma_f32_16x16x32_bf16 v[52:55], v[76:79], v[176:179], v[52:55]
    ds_read_b128 v[104:107], v224 offset:1024
    v_mfma_f32_16x16x32_bf16 v[28:31], v[80:83], v[172:175], v[28:31]
    buffer_load_dwordx4 v[152:155], v3, s[8:11], s60 offen offset:1024 sc1
    v_mfma_f32_16x16x32_bf16 v[56:59], v[80:83], v[176:179], v[56:59]
    ds_read_b128 v[76:79], v224 offset:2048
    s_waitcnt lgkmcnt(5)
    v_mfma_f32_16x16x32_bf16 v[32:35], v[84:87], v[172:175], v[32:35]
    v_mfma_f32_16x16x32_bf16 v[60:63], v[84:87], v[176:179], v[60:63]
    ds_read_b128 v[80:83], v224 offset:3072
    v_mfma_f32_16x16x32_bf16 v[36:39], v[88:91], v[172:175], v[36:39]
    buffer_load_dwordx4 v[156:159], v3, s[8:11], s69 offen offset:2048 sc1
    v_mfma_f32_16x16x32_bf16 v[64:67], v[88:91], v[176:179], v[64:67]
    ds_read_b128 v[84:87], v224 offset:4096
    s_waitcnt lgkmcnt(5)
    v_mfma_f32_16x16x32_bf16 v[40:43], v[92:95], v[172:175], v[40:43]
    v_mfma_f32_16x16x32_bf16 v[68:71], v[92:95], v[176:179], v[68:71]
    ds_read_b128 v[88:91], v224 offset:5120
    v_mfma_f32_16x16x32_bf16 v[44:47], v[96:99], v[172:175], v[44:47]
    buffer_load_dwordx4 v[160:163], v3, s[8:11], s60 offen offset:2048 sc1
    v_mfma_f32_16x16x32_bf16 v[72:75], v[96:99], v[176:179], v[72:75]
    ds_read_b128 v[92:95], v224 offset:6144
    s_waitcnt vmcnt(18) lgkmcnt(5)
    v_mfma_f32_16x16x32_bf16 v[20:23], v[100:103], v[180:183], v[20:23]
    buffer_load_dwordx4 v[164:167], v3, s[8:11], s69 offen offset:3072 sc1
    v_mfma_f32_16x16x32_bf16 v[48:51], v[100:103], v[184:187], v[48:51]
    ds_read_b128 v[96:99], v224 offset:7168
    v_mfma_f32_16x16x32_bf16 v[24:27], v[104:107], v[180:183], v[24:27]
    v_mfma_f32_16x16x32_bf16 v[52:55], v[104:107], v[184:187], v[52:55]
    ds_read_b128 v[100:103], v224 offset:14336
    s_waitcnt lgkmcnt(5)
    v_mfma_f32_16x16x32_bf16 v[28:31], v[76:79], v[180:183], v[28:31]
    buffer_load_dwordx4 v[168:171], v3, s[8:11], s60 offen offset:3072 sc1
    v_mfma_f32_16x16x32_bf16 v[56:59], v[76:79], v[184:187], v[56:59]
    s_barrier
    ds_read_b128 v[104:107], v224 offset:21504
    v_mfma_f32_16x16x32_bf16 v[32:35], v[80:83], v[180:183], v[32:35]
    v_mfma_f32_16x16x32_bf16 v[60:63], v[80:83], v[184:187], v[60:63]
    ds_read_b128 v[76:79], v224 offset:28672
    s_waitcnt lgkmcnt(5)
    v_mfma_f32_16x16x32_bf16 v[36:39], v[84:87], v[180:183], v[36:39]
    v_mfma_f32_16x16x32_bf16 v[64:67], v[84:87], v[184:187], v[64:67]
    ds_read_b128 v[80:83], v224 offset:35840
    v_mfma_f32_16x16x32_bf16 v[40:43], v[88:91], v[180:183], v[40:43]
    v_mfma_f32_16x16x32_bf16 v[68:71], v[88:91], v[184:187], v[68:71]
    ds_read_b128 v[84:87], v224 offset:43008
    s_waitcnt lgkmcnt(5)
    v_mfma_f32_16x16x32_bf16 v[44:47], v[92:95], v[180:183], v[44:47]
    v_mfma_f32_16x16x32_bf16 v[72:75], v[92:95], v[184:187], v[72:75]
    ds_read_b128 v[88:91], v224 offset:50176
    s_waitcnt vmcnt(18)
    v_mfma_f32_16x16x32_bf16 v[20:23], v[96:99], v[188:191], v[20:23]
    buffer_load_dwordx2 v[228:229], v18, s[8:11], s75 offen offset:0 sc1
    buffer_load_dwordx2 v[230:231], v18, s[8:11], s75 offen offset:128 sc1
    v_mfma_f32_16x16x32_bf16 v[48:51], v[96:99], v[192:195], v[48:51]
    ds_read_b128 v[92:95], v224 offset:57344
    s_waitcnt vmcnt(18) lgkmcnt(5)
    v_mfma_f32_16x16x32_bf16 v[20:23], v[100:103], v[196:199], v[20:23]
    v_mfma_f32_16x16x32_bf16 v[48:51], v[100:103], v[200:203], v[48:51]
    ds_read_b128 v[96:99], v225 offset:0
    s_waitcnt vmcnt(16)
    v_mfma_f32_16x16x32_bf16 v[20:23], v[104:107], v[108:111], v[20:23]
    v_mfma_f32_16x16x32_bf16 v[48:51], v[104:107], v[112:115], v[48:51]
    ds_read_b128 v[100:103], v225 offset:7168
    s_waitcnt vmcnt(14) lgkmcnt(5)
    v_mfma_f32_16x16x32_bf16 v[20:23], v[76:79], v[116:119], v[20:23]
    v_mfma_f32_16x16x32_bf16 v[48:51], v[76:79], v[120:123], v[48:51]
    ds_read_b128 v[104:107], v224 offset:8192
    s_waitcnt vmcnt(12)
    v_mfma_f32_16x16x32_bf16 v[20:23], v[80:83], v[124:127], v[20:23]
    v_mfma_f32_16x16x32_bf16 v[48:51], v[80:83], v[128:131], v[48:51]
    ds_read_b128 v[76:79], v224 offset:15360
    s_waitcnt vmcnt(10) lgkmcnt(5)
    v_mfma_f32_16x16x32_bf16 v[20:23], v[84:87], v[132:135], v[20:23]
    v_mfma_f32_16x16x32_bf16 v[48:51], v[84:87], v[136:139], v[48:51]
    ds_read_b128 v[80:83], v224 offset:22528
    s_waitcnt vmcnt(8)
    v_mfma_f32_16x16x32_bf16 v[20:23], v[88:91], v[140:143], v[20:23]
    v_mfma_f32_16x16x32_bf16 v[48:51], v[88:91], v[144:147], v[48:51]
    ds_read_b128 v[84:87], v224 offset:29696
    s_waitcnt vmcnt(6) lgkmcnt(5)
    v_mfma_f32_16x16x32_bf16 v[20:23], v[92:95], v[148:151], v[20:23]
    v_mfma_f32_16x16x32_bf16 v[48:51], v[92:95], v[152:155], v[48:51]
    ds_read_b128 v[88:91], v224 offset:36864
    s_waitcnt vmcnt(4)
    v_mfma_f32_16x16x32_bf16 v[20:23], v[96:99], v[156:159], v[20:23]
    v_mfma_f32_16x16x32_bf16 v[48:51], v[96:99], v[160:163], v[48:51]
    ds_read_b128 v[92:95], v224 offset:44032
    s_waitcnt vmcnt(2) lgkmcnt(5)
    v_mfma_f32_16x16x32_bf16 v[20:23], v[100:103], v[164:167], v[20:23]
    v_mfma_f32_16x16x32_bf16 v[48:51], v[100:103], v[168:171], v[48:51]
    ds_read_b128 v[96:99], v224 offset:51200
    v_mfma_f32_16x16x32_bf16 v[24:27], v[104:107], v[188:191], v[24:27]
    v_mfma_f32_16x16x32_bf16 v[52:55], v[104:107], v[192:195], v[52:55]
    ds_read_b128 v[100:103], v224 offset:58368
    s_waitcnt lgkmcnt(5)
    v_mfma_f32_16x16x32_bf16 v[24:27], v[76:79], v[196:199], v[24:27]
    v_mfma_f32_16x16x32_bf16 v[52:55], v[76:79], v[200:203], v[52:55]
    ds_read_b128 v[104:107], v225 offset:1024
    v_max_f32 v14, 0, v20
    v_mfma_f32_16x16x32_bf16 v[24:27], v[80:83], v[108:111], v[24:27]
    v_max_f32 v15, 0, v21
    v_max_f32 v16, 0, v22
    v_mfma_f32_16x16x32_bf16 v[52:55], v[80:83], v[112:115], v[52:55]
    ds_read_b128 v[76:79], v225 offset:8192
    s_waitcnt lgkmcnt(5)
    v_mfma_f32_16x16x32_bf16 v[24:27], v[84:87], v[116:119], v[24:27]
    v_max_f32 v17, 0, v23
    v_mul_f32 v20, v14, v20
    v_mfma_f32_16x16x32_bf16 v[52:55], v[84:87], v[120:123], v[52:55]
    ds_read_b128 v[80:83], v224 offset:9216
    v_mul_f32 v21, v15, v21
    v_mfma_f32_16x16x32_bf16 v[24:27], v[88:91], v[124:127], v[24:27]
    v_mul_f32 v22, v16, v22
    v_mul_f32 v23, v17, v23
    v_mfma_f32_16x16x32_bf16 v[52:55], v[88:91], v[128:131], v[52:55]
    ds_read_b128 v[84:87], v224 offset:16384
    s_waitcnt lgkmcnt(5)
    v_mfma_f32_16x16x32_bf16 v[24:27], v[92:95], v[132:135], v[24:27]
    v_cvt_pk_bf16_f32 v204, v20, v21
    v_cvt_pk_bf16_f32 v205, v22, v23
    v_mfma_f32_16x16x32_bf16 v[52:55], v[92:95], v[136:139], v[52:55]
    ds_read_b128 v[88:91], v224 offset:23552
    v_max_f32 v14, 0, v48
    v_mfma_f32_16x16x32_bf16 v[24:27], v[96:99], v[140:143], v[24:27]
    v_max_f32 v15, 0, v49
    v_max_f32 v16, 0, v50
    v_mfma_f32_16x16x32_bf16 v[52:55], v[96:99], v[144:147], v[52:55]
    ds_read_b128 v[92:95], v224 offset:30720
    s_waitcnt lgkmcnt(5)
    v_mfma_f32_16x16x32_bf16 v[24:27], v[100:103], v[148:151], v[24:27]
    v_max_f32 v17, 0, v51
    v_mul_f32 v48, v14, v48
    v_mfma_f32_16x16x32_bf16 v[52:55], v[100:103], v[152:155], v[52:55]
    ds_read_b128 v[96:99], v224 offset:37888
    v_mul_f32 v49, v15, v49
    v_mfma_f32_16x16x32_bf16 v[24:27], v[104:107], v[156:159], v[24:27]
    v_mul_f32 v50, v16, v50
    v_mul_f32 v51, v17, v51
    v_mfma_f32_16x16x32_bf16 v[52:55], v[104:107], v[160:163], v[52:55]
    ds_read_b128 v[100:103], v224 offset:45056
    s_waitcnt lgkmcnt(5)
    v_mfma_f32_16x16x32_bf16 v[24:27], v[76:79], v[164:167], v[24:27]
    v_cvt_pk_bf16_f32 v206, v48, v49
    v_cvt_pk_bf16_f32 v207, v50, v51
    v_mfma_f32_16x16x32_bf16 v[52:55], v[76:79], v[168:171], v[52:55]
    ds_read_b128 v[104:107], v224 offset:52224
    v_mfma_f32_16x16x32_bf16 v[28:31], v[80:83], v[188:191], v[28:31]
    v_permlane16_swap_b32 v204, v206
    v_mfma_f32_16x16x32_bf16 v[56:59], v[80:83], v[192:195], v[56:59]
    ds_read_b128 v[76:79], v224 offset:59392
    s_waitcnt lgkmcnt(5)
    v_mfma_f32_16x16x32_bf16 v[28:31], v[84:87], v[196:199], v[28:31]
    v_permlane16_swap_b32 v205, v207
    v_mfma_f32_16x16x32_bf16 v[56:59], v[84:87], v[200:203], v[56:59]
    ds_read_b128 v[80:83], v225 offset:2048
    buffer_store_dwordx4 v[204:207], v227, s[8:11], s61 offen offset:0 sc1
    v_mfma_f32_16x16x32_bf16 v[28:31], v[88:91], v[108:111], v[28:31]
    v_max_f32 v14, 0, v24
    v_max_f32 v15, 0, v25
    v_mfma_f32_16x16x32_bf16 v[56:59], v[88:91], v[112:115], v[56:59]
    ds_read_b128 v[84:87], v225 offset:9216
    s_waitcnt lgkmcnt(5)
    v_mfma_f32_16x16x32_bf16 v[28:31], v[92:95], v[116:119], v[28:31]
    v_max_f32 v16, 0, v26
    v_max_f32 v17, 0, v27
    v_mfma_f32_16x16x32_bf16 v[56:59], v[92:95], v[120:123], v[56:59]
    ds_read_b128 v[88:91], v224 offset:10240
    v_mul_f32 v24, v14, v24
    v_mfma_f32_16x16x32_bf16 v[28:31], v[96:99], v[124:127], v[28:31]
    v_mul_f32 v25, v15, v25
    v_mul_f32 v26, v16, v26
    v_mfma_f32_16x16x32_bf16 v[56:59], v[96:99], v[128:131], v[56:59]
    ds_read_b128 v[92:95], v224 offset:17408
    s_waitcnt lgkmcnt(5)
    v_mfma_f32_16x16x32_bf16 v[28:31], v[100:103], v[132:135], v[28:31]
    v_mul_f32 v27, v17, v27
    v_cvt_pk_bf16_f32 v208, v24, v25
    v_mfma_f32_16x16x32_bf16 v[56:59], v[100:103], v[136:139], v[56:59]
    ds_read_b128 v[96:99], v224 offset:24576
    v_cvt_pk_bf16_f32 v209, v26, v27
    v_mfma_f32_16x16x32_bf16 v[28:31], v[104:107], v[140:143], v[28:31]
    v_max_f32 v14, 0, v52
    v_max_f32 v15, 0, v53
    v_mfma_f32_16x16x32_bf16 v[56:59], v[104:107], v[144:147], v[56:59]
    ds_read_b128 v[100:103], v224 offset:31744
    s_waitcnt lgkmcnt(5)
    v_mfma_f32_16x16x32_bf16 v[28:31], v[76:79], v[148:151], v[28:31]
    v_max_f32 v16, 0, v54
    v_max_f32 v17, 0, v55
    v_mfma_f32_16x16x32_bf16 v[56:59], v[76:79], v[152:155], v[56:59]
    ds_read_b128 v[104:107], v224 offset:38912
    v_mul_f32 v52, v14, v52
    v_mfma_f32_16x16x32_bf16 v[28:31], v[80:83], v[156:159], v[28:31]
    v_mul_f32 v53, v15, v53
    v_mul_f32 v54, v16, v54
    v_mfma_f32_16x16x32_bf16 v[56:59], v[80:83], v[160:163], v[56:59]
    ds_read_b128 v[76:79], v224 offset:46080
    s_waitcnt lgkmcnt(5)
    v_mfma_f32_16x16x32_bf16 v[28:31], v[84:87], v[164:167], v[28:31]
    v_mul_f32 v55, v17, v55
    v_cvt_pk_bf16_f32 v210, v52, v53
    v_mfma_f32_16x16x32_bf16 v[56:59], v[84:87], v[168:171], v[56:59]
    ds_read_b128 v[80:83], v224 offset:53248
    v_cvt_pk_bf16_f32 v211, v54, v55
    v_mfma_f32_16x16x32_bf16 v[32:35], v[88:91], v[188:191], v[32:35]
    v_permlane16_swap_b32 v208, v210
    v_mfma_f32_16x16x32_bf16 v[60:63], v[88:91], v[192:195], v[60:63]
    ds_read_b128 v[84:87], v224 offset:60416
    s_waitcnt lgkmcnt(5)
    v_mfma_f32_16x16x32_bf16 v[32:35], v[92:95], v[196:199], v[32:35]
    v_permlane16_swap_b32 v209, v211
    v_mfma_f32_16x16x32_bf16 v[60:63], v[92:95], v[200:203], v[60:63]
    ds_read_b128 v[88:91], v225 offset:3072
    buffer_store_dwordx4 v[208:211], v227, s[8:11], s61 offen offset:512 sc1
    v_mfma_f32_16x16x32_bf16 v[32:35], v[96:99], v[108:111], v[32:35]
    v_max_f32 v14, 0, v28
    v_max_f32 v15, 0, v29
    v_mfma_f32_16x16x32_bf16 v[60:63], v[96:99], v[112:115], v[60:63]
    ds_read_b128 v[92:95], v225 offset:10240
    s_waitcnt lgkmcnt(5)
    v_mfma_f32_16x16x32_bf16 v[32:35], v[100:103], v[116:119], v[32:35]
    v_max_f32 v16, 0, v30
    v_max_f32 v17, 0, v31
    v_mfma_f32_16x16x32_bf16 v[60:63], v[100:103], v[120:123], v[60:63]
    ds_read_b128 v[96:99], v224 offset:11264
    v_mul_f32 v28, v14, v28
    v_mfma_f32_16x16x32_bf16 v[32:35], v[104:107], v[124:127], v[32:35]
    v_mul_f32 v29, v15, v29
    v_mul_f32 v30, v16, v30
    v_mfma_f32_16x16x32_bf16 v[60:63], v[104:107], v[128:131], v[60:63]
    ds_read_b128 v[100:103], v224 offset:18432
    s_waitcnt lgkmcnt(5)
    v_mfma_f32_16x16x32_bf16 v[32:35], v[76:79], v[132:135], v[32:35]
    v_mul_f32 v31, v17, v31
    v_cvt_pk_bf16_f32 v204, v28, v29
    v_mfma_f32_16x16x32_bf16 v[60:63], v[76:79], v[136:139], v[60:63]
    ds_read_b128 v[104:107], v224 offset:25600
    v_cvt_pk_bf16_f32 v205, v30, v31
    v_mfma_f32_16x16x32_bf16 v[32:35], v[80:83], v[140:143], v[32:35]
    v_max_f32 v14, 0, v56
    v_max_f32 v15, 0, v57
    v_mfma_f32_16x16x32_bf16 v[60:63], v[80:83], v[144:147], v[60:63]
    ds_read_b128 v[76:79], v224 offset:32768
    s_waitcnt lgkmcnt(5)
    v_mfma_f32_16x16x32_bf16 v[32:35], v[84:87], v[148:151], v[32:35]
    v_max_f32 v16, 0, v58
    v_max_f32 v17, 0, v59
    v_mfma_f32_16x16x32_bf16 v[60:63], v[84:87], v[152:155], v[60:63]
    ds_read_b128 v[80:83], v224 offset:39936
    v_mul_f32 v56, v14, v56
    v_mfma_f32_16x16x32_bf16 v[32:35], v[88:91], v[156:159], v[32:35]
    v_mul_f32 v57, v15, v57
    v_mul_f32 v58, v16, v58
    v_mfma_f32_16x16x32_bf16 v[60:63], v[88:91], v[160:163], v[60:63]
    ds_read_b128 v[84:87], v224 offset:47104
    s_waitcnt lgkmcnt(5)
    v_mfma_f32_16x16x32_bf16 v[32:35], v[92:95], v[164:167], v[32:35]
    v_mul_f32 v59, v17, v59
    v_cvt_pk_bf16_f32 v206, v56, v57
    v_mfma_f32_16x16x32_bf16 v[60:63], v[92:95], v[168:171], v[60:63]
    ds_read_b128 v[88:91], v224 offset:54272
    v_cvt_pk_bf16_f32 v207, v58, v59
    v_mfma_f32_16x16x32_bf16 v[36:39], v[96:99], v[188:191], v[36:39]
    v_permlane16_swap_b32 v204, v206
    v_mfma_f32_16x16x32_bf16 v[64:67], v[96:99], v[192:195], v[64:67]
    ds_read_b128 v[92:95], v224 offset:61440
    s_waitcnt lgkmcnt(5)
    v_mfma_f32_16x16x32_bf16 v[36:39], v[100:103], v[196:199], v[36:39]
    v_permlane16_swap_b32 v205, v207
    v_mfma_f32_16x16x32_bf16 v[64:67], v[100:103], v[200:203], v[64:67]
    ds_read_b128 v[96:99], v225 offset:4096
    buffer_store_dwordx4 v[204:207], v227, s[8:11], s61 offen offset:1024 sc1
    v_mfma_f32_16x16x32_bf16 v[36:39], v[104:107], v[108:111], v[36:39]
    v_max_f32 v14, 0, v32
    v_max_f32 v15, 0, v33
    v_mfma_f32_16x16x32_bf16 v[64:67], v[104:107], v[112:115], v[64:67]
    ds_read_b128 v[100:103], v225 offset:11264
    s_waitcnt lgkmcnt(5)
    v_mfma_f32_16x16x32_bf16 v[36:39], v[76:79], v[116:119], v[36:39]
    v_max_f32 v16, 0, v34
    v_max_f32 v17, 0, v35
    v_mfma_f32_16x16x32_bf16 v[64:67], v[76:79], v[120:123], v[64:67]
    ds_read_b128 v[104:107], v224 offset:12288
    v_mul_f32 v32, v14, v32
    v_mfma_f32_16x16x32_bf16 v[36:39], v[80:83], v[124:127], v[36:39]
    v_mul_f32 v33, v15, v33
    v_mul_f32 v34, v16, v34
    v_mfma_f32_16x16x32_bf16 v[64:67], v[80:83], v[128:131], v[64:67]
    ds_read_b128 v[76:79], v224 offset:19456
    s_waitcnt lgkmcnt(5)
    v_mfma_f32_16x16x32_bf16 v[36:39], v[84:87], v[132:135], v[36:39]
    v_mul_f32 v35, v17, v35
    v_cvt_pk_bf16_f32 v208, v32, v33
    v_mfma_f32_16x16x32_bf16 v[64:67], v[84:87], v[136:139], v[64:67]
    ds_read_b128 v[80:83], v224 offset:26624
    v_cvt_pk_bf16_f32 v209, v34, v35
    v_mfma_f32_16x16x32_bf16 v[36:39], v[88:91], v[140:143], v[36:39]
    v_max_f32 v14, 0, v60
    v_max_f32 v15, 0, v61
    v_mfma_f32_16x16x32_bf16 v[64:67], v[88:91], v[144:147], v[64:67]
    ds_read_b128 v[84:87], v224 offset:33792
    s_waitcnt lgkmcnt(5)
    v_mfma_f32_16x16x32_bf16 v[36:39], v[92:95], v[148:151], v[36:39]
    v_max_f32 v16, 0, v62
    v_max_f32 v17, 0, v63
    v_mfma_f32_16x16x32_bf16 v[64:67], v[92:95], v[152:155], v[64:67]
    ds_read_b128 v[88:91], v224 offset:40960
    v_mul_f32 v60, v14, v60
    v_mfma_f32_16x16x32_bf16 v[36:39], v[96:99], v[156:159], v[36:39]
    v_mul_f32 v61, v15, v61
    v_mul_f32 v62, v16, v62
    v_mfma_f32_16x16x32_bf16 v[64:67], v[96:99], v[160:163], v[64:67]
    ds_read_b128 v[92:95], v224 offset:48128
    s_waitcnt lgkmcnt(5)
    v_mfma_f32_16x16x32_bf16 v[36:39], v[100:103], v[164:167], v[36:39]
    v_mul_f32 v63, v17, v63
    v_cvt_pk_bf16_f32 v210, v60, v61
    v_mfma_f32_16x16x32_bf16 v[64:67], v[100:103], v[168:171], v[64:67]
    ds_read_b128 v[96:99], v224 offset:55296
    v_cvt_pk_bf16_f32 v211, v62, v63
    v_mfma_f32_16x16x32_bf16 v[40:43], v[104:107], v[188:191], v[40:43]
    v_permlane16_swap_b32 v208, v210
    v_mfma_f32_16x16x32_bf16 v[68:71], v[104:107], v[192:195], v[68:71]
    ds_read_b128 v[100:103], v224 offset:62464
    s_waitcnt lgkmcnt(5)
    v_mfma_f32_16x16x32_bf16 v[40:43], v[76:79], v[196:199], v[40:43]
    v_permlane16_swap_b32 v209, v211
    v_mfma_f32_16x16x32_bf16 v[68:71], v[76:79], v[200:203], v[68:71]
    ds_read_b128 v[104:107], v225 offset:5120
    buffer_store_dwordx4 v[208:211], v227, s[8:11], s61 offen offset:1536 sc1
    v_mfma_f32_16x16x32_bf16 v[40:43], v[80:83], v[108:111], v[40:43]
    v_max_f32 v14, 0, v36
    v_max_f32 v15, 0, v37
    v_mfma_f32_16x16x32_bf16 v[68:71], v[80:83], v[112:115], v[68:71]
    ds_read_b128 v[76:79], v225 offset:12288
    s_waitcnt lgkmcnt(5)
    v_mfma_f32_16x16x32_bf16 v[40:43], v[84:87], v[116:119], v[40:43]
    v_max_f32 v16, 0, v38
    v_max_f32 v17, 0, v39
    v_mfma_f32_16x16x32_bf16 v[68:71], v[84:87], v[120:123], v[68:71]
    ds_read_b128 v[80:83], v224 offset:13312
    v_mul_f32 v36, v14, v36
    v_mfma_f32_16x16x32_bf16 v[40:43], v[88:91], v[124:127], v[40:43]
    v_mul_f32 v37, v15, v37
    v_mul_f32 v38, v16, v38
    v_mfma_f32_16x16x32_bf16 v[68:71], v[88:91], v[128:131], v[68:71]
    ds_read_b128 v[84:87], v224 offset:20480
    s_waitcnt lgkmcnt(5)
    v_mfma_f32_16x16x32_bf16 v[40:43], v[92:95], v[132:135], v[40:43]
    v_mul_f32 v39, v17, v39
    v_cvt_pk_bf16_f32 v204, v36, v37
    v_mfma_f32_16x16x32_bf16 v[68:71], v[92:95], v[136:139], v[68:71]
    ds_read_b128 v[88:91], v224 offset:27648
    v_cvt_pk_bf16_f32 v205, v38, v39
    v_mfma_f32_16x16x32_bf16 v[40:43], v[96:99], v[140:143], v[40:43]
    v_max_f32 v14, 0, v64
    v_max_f32 v15, 0, v65
    v_mfma_f32_16x16x32_bf16 v[68:71], v[96:99], v[144:147], v[68:71]
    ds_read_b128 v[92:95], v224 offset:34816
    s_waitcnt lgkmcnt(5)
    v_mfma_f32_16x16x32_bf16 v[40:43], v[100:103], v[148:151], v[40:43]
    v_max_f32 v16, 0, v66
    v_max_f32 v17, 0, v67
    v_mfma_f32_16x16x32_bf16 v[68:71], v[100:103], v[152:155], v[68:71]
    ds_read_b128 v[96:99], v224 offset:41984
    v_mul_f32 v64, v14, v64
    v_mfma_f32_16x16x32_bf16 v[40:43], v[104:107], v[156:159], v[40:43]
    v_mul_f32 v65, v15, v65
    v_mul_f32 v66, v16, v66
    v_mfma_f32_16x16x32_bf16 v[68:71], v[104:107], v[160:163], v[68:71]
    ds_read_b128 v[100:103], v224 offset:49152
    s_waitcnt lgkmcnt(5)
    v_mfma_f32_16x16x32_bf16 v[40:43], v[76:79], v[164:167], v[40:43]
    v_mul_f32 v67, v17, v67
    v_cvt_pk_bf16_f32 v206, v64, v65
    v_mfma_f32_16x16x32_bf16 v[68:71], v[76:79], v[168:171], v[68:71]
    ds_read_b128 v[104:107], v224 offset:56320
    v_cvt_pk_bf16_f32 v207, v66, v67
    v_mfma_f32_16x16x32_bf16 v[44:47], v[80:83], v[188:191], v[44:47]
    v_permlane16_swap_b32 v204, v206
    v_mfma_f32_16x16x32_bf16 v[72:75], v[80:83], v[192:195], v[72:75]
    ds_read_b128 v[76:79], v224 offset:63488
    s_waitcnt lgkmcnt(5)
    v_mfma_f32_16x16x32_bf16 v[44:47], v[84:87], v[196:199], v[44:47]
    v_permlane16_swap_b32 v205, v207
    v_mfma_f32_16x16x32_bf16 v[72:75], v[84:87], v[200:203], v[72:75]
    ds_read_b128 v[80:83], v225 offset:6144
    buffer_store_dwordx4 v[204:207], v227, s[8:11], s61 offen offset:2048 sc1
    v_mfma_f32_16x16x32_bf16 v[44:47], v[88:91], v[108:111], v[44:47]
    v_max_f32 v14, 0, v40
    v_max_f32 v15, 0, v41
    v_mfma_f32_16x16x32_bf16 v[72:75], v[88:91], v[112:115], v[72:75]
    ds_read_b128 v[84:87], v225 offset:13312
    s_waitcnt lgkmcnt(5)
    v_mfma_f32_16x16x32_bf16 v[44:47], v[92:95], v[116:119], v[44:47]
    v_max_f32 v16, 0, v42
    v_max_f32 v17, 0, v43
    v_mfma_f32_16x16x32_bf16 v[72:75], v[92:95], v[120:123], v[72:75]
    v_mul_f32 v40, v14, v40
    v_mul_f32 v41, v15, v41
    v_mfma_f32_16x16x32_bf16 v[44:47], v[96:99], v[124:127], v[44:47]
    v_mul_f32 v42, v16, v42
    v_mul_f32 v43, v17, v43
    v_mfma_f32_16x16x32_bf16 v[72:75], v[96:99], v[128:131], v[72:75]
    v_cvt_pk_bf16_f32 v208, v40, v41
    s_waitcnt lgkmcnt(3)
    v_mfma_f32_16x16x32_bf16 v[44:47], v[100:103], v[132:135], v[44:47]
    v_cvt_pk_bf16_f32 v209, v42, v43
    v_max_f32 v14, 0, v68
    v_mfma_f32_16x16x32_bf16 v[72:75], v[100:103], v[136:139], v[72:75]
    v_max_f32 v15, 0, v69
    v_max_f32 v16, 0, v70
    v_mfma_f32_16x16x32_bf16 v[44:47], v[104:107], v[140:143], v[44:47]
    v_max_f32 v17, 0, v71
    v_mul_f32 v68, v14, v68
    v_mfma_f32_16x16x32_bf16 v[72:75], v[104:107], v[144:147], v[72:75]
    v_mul_f32 v69, v15, v69
    s_waitcnt lgkmcnt(1)
    v_mfma_f32_16x16x32_bf16 v[44:47], v[76:79], v[148:151], v[44:47]
    v_mul_f32 v70, v16, v70
    v_mul_f32 v71, v17, v71
    v_mfma_f32_16x16x32_bf16 v[72:75], v[76:79], v[152:155], v[72:75]
    v_cvt_pk_bf16_f32 v210, v68, v69
    v_cvt_pk_bf16_f32 v211, v70, v71
    v_mfma_f32_16x16x32_bf16 v[44:47], v[80:83], v[156:159], v[44:47]
    v_permlane16_swap_b32 v208, v210
    v_mfma_f32_16x16x32_bf16 v[72:75], v[80:83], v[160:163], v[72:75]
    s_waitcnt lgkmcnt(0)
    v_mfma_f32_16x16x32_bf16 v[44:47], v[84:87], v[164:167], v[44:47]
    v_permlane16_swap_b32 v209, v211
    v_mfma_f32_16x16x32_bf16 v[72:75], v[84:87], v[168:171], v[72:75]
    buffer_store_dwordx4 v[208:211], v227, s[8:11], s61 offen offset:2560 sc1
    s_nop 4
    v_max_f32 v14, 0, v44
    v_max_f32 v15, 0, v45
    v_max_f32 v16, 0, v46
    v_max_f32 v17, 0, v47
    v_mul_f32 v44, v14, v44
    v_mul_f32 v45, v15, v45
    v_mul_f32 v46, v16, v46
    v_mul_f32 v47, v17, v47
    v_cvt_pk_bf16_f32 v204, v44, v45
    v_cvt_pk_bf16_f32 v205, v46, v47
    v_max_f32 v14, 0, v72
    v_max_f32 v15, 0, v73
    v_max_f32 v16, 0, v74
    v_max_f32 v17, 0, v75
    v_mul_f32 v72, v14, v72
    v_mul_f32 v73, v15, v73
    v_mul_f32 v74, v16, v74
    v_mul_f32 v75, v17, v75
    v_cvt_pk_bf16_f32 v206, v72, v73
    v_cvt_pk_bf16_f32 v207, v74, v75
    s_nop 0
    v_permlane16_swap_b32 v204, v206
    v_permlane16_swap_b32 v205, v207
    s_add_u32 s74, s85, 28672
    v_mov_b32 v14, 1
    v_mov_b32 v15, 0
    s_waitcnt vmcnt(2)
    s_mov_b64 exec, 1
    s_cmp_eq_u32 s91, 1
    s_cbranch_scc0 L_interleave_layers__spectral_fnet__dense_activation_squared_relu__prompt_kernel_far_41
    buffer_store_dword v14, v15, s[8:11], s74 offen
    s_branch L_interleave_layers__spectral_fnet__dense_activation_squared_relu__prompt_kernel_set_42
L_interleave_layers__spectral_fnet__dense_activation_squared_relu__prompt_kernel_far_41:
    buffer_store_dword v14, v15, s[8:11], s74 offen sc1
L_interleave_layers__spectral_fnet__dense_activation_squared_relu__prompt_kernel_set_42:
    s_mov_b64 exec, -1
    buffer_store_dwordx4 v[204:207], v227, s[8:11], s64 offen offset:3072 sc1
    s_waitcnt lgkmcnt(0)
    v_mul_u32_u24 v14, 80, v2
    v_add_u32 v14, 155648, v14
    ds_read_b128 v[100:103], v14 offset:0
    ds_read_b128 v[104:107], v14 offset:16
    ds_read_b128 v[108:111], v14 offset:32
    ds_read_b128 v[112:115], v14 offset:48
    ds_read_b128 v[116:119], v14 offset:64
    v_add_u32 v122, 4096, v3
    v_add_u32 v123, 8192, v3
    v_add_u32 v124, 12288, v3
    s_cmp_ge_u32 s4, 2
    s_mov_b32 s52, 13312
    s_cselect_b32 s52, 117440512, s52
    v_add_u32 v125, s52, v3
    s_add_u32 s52, s4, 1
    s_and_b32 s52, s52, 3
    s_mul_i32 s68, s52, 15360
    s_add_u32 s68, s68, 81920
    s_lshl_b32 s53, s5, 2
    s_add_u32 s52, s52, s53
    s_mul_i32 s52, s52, 54
    s_add_u32 s52, s52, s90
    s_lshl_b32 s52, s52, 10
    s_add_u32 s64, s52, 20971520
    s_add_u32 s52, s4, 2
    s_and_b32 s52, s52, 3
    s_mul_i32 s69, s52, 15360
    s_add_u32 s69, s69, 87040
    s_lshl_b32 s53, s5, 2
    s_add_u32 s52, s52, s53
    s_mul_i32 s52, s52, 54
    s_add_u32 s52, s52, s90
    s_lshl_b32 s52, s52, 10
    s_add_u32 s65, s52, 20971520
    s_add_u32 s52, s4, 3
    s_and_b32 s52, s52, 3
    s_mul_i32 s70, s52, 15360
    s_add_u32 s70, s70, 92160
    s_lshl_b32 s53, s5, 2
    s_add_u32 s52, s52, s53
    s_mul_i32 s52, s52, 54
    s_add_u32 s52, s52, s90
    s_lshl_b32 s52, s52, 10
    s_add_u32 s66, s52, 20971520
    s_add_u32 s52, s4, 4
    s_and_b32 s52, s52, 3
    s_mul_i32 s71, s52, 15360
    s_add_u32 s71, s71, 81920
    s_lshl_b32 s53, s5, 2
    s_add_u32 s52, s52, s53
    s_mul_i32 s52, s52, 54
    s_add_u32 s52, s52, s90
    s_lshl_b32 s52, s52, 10
    s_add_u32 s67, s52, 20971520
    v_add_f32 v16, v228, v230
    v_add_f32 v17, v229, v231
    v_mov_b32 v14, v16
    s_nop 1
    v_permlane32_swap_b32 v16, v14
    v_add_f32 v16, v16, v14
    v_mov_b32 v14, v16
    s_nop 1
    v_permlane16_swap_b32 v16, v14
    v_add_f32 v16, v16, v14
    v_mov_b32 v14, v17
    s_nop 1
    v_permlane32_swap_b32 v17, v14
    v_add_f32 v17, v17, v14
    v_mov_b32 v14, v17
    s_nop 1
    v_permlane16_swap_b32 v17, v14
    v_add_f32 v17, v17, v14
    v_mul_f32 v16, 0.0015625, v16
    v_mul_f32 v17, 0.0015625, v17
    v_fma_f32 v17, -v16, v16, v17
    v_max_f32 v17, 0, v17
    v_cvt_pk_bf16_f32 v14, v16, v17
    v_lshlrev_b32 v16, 16, v14
    v_and_b32 v17, 0xffff0000, v14
    v_add_f32 v17, 0x3727c5ac, v17
    v_cvt_pk_bf16_f32 v14, v17, v17
    v_lshlrev_b32 v17, 16, v14
    v_sqrt_f32 v17, v17
    s_nop 0
    v_cvt_pk_bf16_f32 v14, v17, v17
    v_lshlrev_b32 v17, 16, v14
    v_rcp_f32 v17, v17
    s_nop 0
    v_mul_f32 v120, v17, v17
    v_mov_b32 v121, v120
    v_lshlrev_b32 v14, 6, v1
    v_add_u32 v14, s81, v14
    v_mul_u32_u24 v130, 1280, v14
    s_mul_i32 s72, s6, 80
    v_lshl_add_u32 v131, v2, 4, v130
    s_sub_u32 s53, 1266, s72
    v_lshlrev_b32 v15, 4, v2
    v_sub_u32 v15, s53, v15
    v_add_u32 v132, v15, v130
    v_lshlrev_b32 v14, 3, v2
    s_add_u32 s53, s72, 64
    v_add_u32 v16, s53, v14
    s_sub_u32 s53, 1226, s72
    v_sub_u32 v17, s53, v14
    v_cmp_lt_u32 vcc, 1, v2
    s_nop 1
    v_cndmask_b32 v16, v16, v17, vcc
    v_add_u32 v133, v16, v130
    s_cmp_eq_u32 s6, 0
    s_cselect_b32 s73, 0xffff0000, -1
    v_lshlrev_b32 v127, 2, v0
    v_and_b32 v15, 7, v0
    v_min_u32 v15, 4, v15
    s_lshl_b32 s63, s4, 2
    v_add_u32 v15, s63, v15
    v_max_u32 v15, 1, v15
    v_subrev_u32 v15, 1, v15
    v_bfe_u32 v14, v0, 3, 1
    v_lshl_add_u32 v15, v14, 4, v15
    v_lshlrev_b32 v126, 2, v15
    s_lshl_b32 s63, s5, 7
    s_add_u32 s62, s63, 28672
    s_add_u32 s63, s63, 16384
    s_add_u32 s74, s85, 16384
    v_mov_b32 v14, 1
    v_mov_b32 v15, 0
    buffer_load_dword v129, v126, s[8:11], s62 offen sc1
    s_waitcnt vmcnt(1)
    s_mov_b64 exec, 1
    s_cmp_eq_u32 s91, 1
    s_cbranch_scc0 L_interleave_layers__spectral_fnet__dense_activation_squared_relu__prompt_kernel_far_43
    buffer_store_dword v14, v15, s[8:11], s74 offen
    s_branch L_interleave_layers__spectral_fnet__dense_activation_squared_relu__prompt_kernel_set_44
L_interleave_layers__spectral_fnet__dense_activation_squared_relu__prompt_kernel_far_43:
    buffer_store_dword v14, v15, s[8:11], s74 offen sc1
L_interleave_layers__spectral_fnet__dense_activation_squared_relu__prompt_kernel_set_44:
    s_mov_b64 exec, -1
    s_waitcnt vmcnt(1)
    v_cmp_ne_u32 vcc, 1, v129
    s_nop 4
    s_cbranch_vccz L_interleave_layers__spectral_fnet__dense_activation_squared_relu__prompt_kernel_early_45
L_interleave_layers__spectral_fnet__dense_activation_squared_relu__prompt_kernel_poll_46:
    buffer_load_dword v14, v126, s[8:11], s62 offen sc1
    s_waitcnt vmcnt(0)
    v_cmp_ne_u32 vcc, 1, v14
    s_nop 4
    s_cbranch_vccz L_interleave_layers__spectral_fnet__dense_activation_squared_relu__prompt_kernel_go_47
    s_cmp_eq_u32 s82, 0
    s_cbranch_scc1 L_interleave_layers__spectral_fnet__dense_activation_squared_relu__prompt_kernel_go_47
    s_sub_u32 s82, s82, 1
    s_branch L_interleave_layers__spectral_fnet__dense_activation_squared_relu__prompt_kernel_poll_46
L_interleave_layers__spectral_fnet__dense_activation_squared_relu__prompt_kernel_go_47:
L_interleave_layers__spectral_fnet__dense_activation_squared_relu__prompt_kernel_early_45:
    buffer_load_dwordx4 v[136:139], v3, s[8:11], s64 offen offset:0 sc1
    buffer_load_dwordx4 v[140:143], v3, s[8:11], s64 offen offset:1024 sc1
    buffer_load_dwordx4 v[144:147], v122, s[8:11], s64 offen offset:0 sc1
    buffer_load_dwordx4 v[148:151], v122, s[8:11], s64 offen offset:3072 sc1
    buffer_load_dwordx4 v[152:155], v123, s[8:11], s64 offen offset:0 sc1
    buffer_load_dwordx4 v[156:159], v123, s[8:11], s64 offen offset:3072 sc1
    buffer_load_dwordx4 v[160:163], v3, s[8:11], s65 offen offset:0 sc1
    buffer_load_dwordx4 v[164:167], v3, s[8:11], s65 offen offset:1024 sc1
    buffer_load_dwordx4 v[168:171], v122, s[8:11], s65 offen offset:0 sc1
    buffer_load_dwordx4 v[172:175], v122, s[8:11], s65 offen offset:3072 sc1
    s_waitcnt lgkmcnt(0)
    s_barrier
    v_lshlrev_b32 v14, 16, v4
    v_and_b32 v15, 0xffff0000, v4
    v_pk_add_f32 v[100:101], v[100:101], v[14:15]
    v_lshlrev_b32 v14, 16, v5
    v_and_b32 v15, 0xffff0000, v5
    v_pk_add_f32 v[102:103], v[102:103], v[14:15]
    v_lshlrev_b32 v14, 16, v6
    v_and_b32 v15, 0xffff0000, v6
    v_pk_add_f32 v[104:105], v[104:105], v[14:15]
    v_lshlrev_b32 v14, 16, v7
    v_and_b32 v15, 0xffff0000, v7
    v_pk_add_f32 v[106:107], v[106:107], v[14:15]
    v_lshlrev_b32 v14, 16, v8
    v_and_b32 v15, 0xffff0000, v8
    v_pk_add_f32 v[108:109], v[108:109], v[14:15]
    v_lshlrev_b32 v14, 16, v9
    v_and_b32 v15, 0xffff0000, v9
    v_pk_add_f32 v[110:111], v[110:111], v[14:15]
    v_lshlrev_b32 v14, 16, v10
    v_and_b32 v15, 0xffff0000, v10
    v_pk_add_f32 v[112:113], v[112:113], v[14:15]
    v_lshlrev_b32 v14, 16, v11
    v_and_b32 v15, 0xffff0000, v11
    v_pk_add_f32 v[114:115], v[114:115], v[14:15]
    v_lshlrev_b32 v14, 16, v12
    v_and_b32 v15, 0xffff0000, v12
    v_pk_add_f32 v[116:117], v[116:117], v[14:15]
    v_lshlrev_b32 v14, 16, v13
    v_and_b32 v15, 0xffff0000, v13
    v_pk_add_f32 v[118:119], v[118:119], v[14:15]
    s_waitcnt vmcnt(9)
    v_mfma_f32_16x16x32_bf16 v[20:23], a[0:3], v[136:139], 0
    buffer_load_dwordx4 v[176:179], v123, s[8:11], s65 offen offset:0 sc1
    v_mfma_f32_16x16x32_bf16 v[24:27], a[4:7], v[136:139], 0
    v_mfma_f32_16x16x32_bf16 v[28:31], a[8:11], v[136:139], 0
    v_mfma_f32_16x16x32_bf16 v[32:35], a[12:15], v[136:139], 0
    v_mfma_f32_16x16x32_bf16 v[36:39], a[16:19], v[136:139], 0
    s_waitcnt vmcnt(9)
    v_mfma_f32_16x16x32_bf16 v[20:23], a[20:23], v[140:143], v[20:23]
    buffer_load_dwordx4 v[180:183], v123, s[8:11], s65 offen offset:3072 sc1
    v_mfma_f32_16x16x32_bf16 v[24:27], a[24:27], v[140:143], v[24:27]
    v_mfma_f32_16x16x32_bf16 v[28:31], a[28:31], v[140:143], v[28:31]
    v_mfma_f32_16x16x32_bf16 v[32:35], a[32:35], v[140:143], v[32:35]
    v_mfma_f32_16x16x32_bf16 v[36:39], a[36:39], v[140:143], v[36:39]
    s_waitcnt vmcnt(9)
    v_mfma_f32_16x16x32_bf16 v[20:23], a[80:83], v[144:147], v[20:23]
    buffer_load_dwordx4 v[184:187], v3, s[8:11], s66 offen offset:0 sc1
    v_mfma_f32_16x16x32_bf16 v[24:27], a[84:87], v[144:147], v[24:27]
    v_mfma_f32_16x16x32_bf16 v[28:31], a[88:91], v[144:147], v[28:31]
    v_mfma_f32_16x16x32_bf16 v[32:35], a[92:95], v[144:147], v[32:35]
    v_mfma_f32_16x16x32_bf16 v[36:39], a[96:99], v[144:147], v[36:39]
    s_waitcnt vmcnt(9)
    v_mfma_f32_16x16x32_bf16 v[20:23], a[140:143], v[148:151], v[20:23]
    buffer_load_dwordx4 v[188:191], v3, s[8:11], s66 offen offset:1024 sc1
    v_mfma_f32_16x16x32_bf16 v[24:27], a[144:147], v[148:151], v[24:27]
    v_mfma_f32_16x16x32_bf16 v[28:31], a[148:151], v[148:151], v[28:31]
    v_mfma_f32_16x16x32_bf16 v[32:35], a[152:155], v[148:151], v[32:35]
    v_mfma_f32_16x16x32_bf16 v[36:39], a[156:159], v[148:151], v[36:39]
    s_waitcnt vmcnt(9)
    v_mfma_f32_16x16x32_bf16 v[20:23], a[160:163], v[152:155], v[20:23]
    buffer_load_dwordx4 v[192:195], v122, s[8:11], s66 offen offset:0 sc1
    v_mfma_f32_16x16x32_bf16 v[24:27], a[164:167], v[152:155], v[24:27]
    v_mfma_f32_16x16x32_bf16 v[28:31], a[168:171], v[152:155], v[28:31]
    buffer_load_dword v129, v126, s[8:11], s63 offen sc1
    v_mfma_f32_16x16x32_bf16 v[32:35], a[172:175], v[152:155], v[32:35]
    v_mfma_f32_16x16x32_bf16 v[36:39], a[176:179], v[152:155], v[36:39]
    s_waitcnt vmcnt(10)
    v_mfma_f32_16x16x32_bf16 v[20:23], a[220:223], v[156:159], v[20:23]
    buffer_load_dwordx4 v[196:199], v122, s[8:11], s66 offen offset:3072 sc1
    v_mfma_f32_16x16x32_bf16 v[24:27], a[224:227], v[156:159], v[24:27]
    v_mfma_f32_16x16x32_bf16 v[28:31], a[228:231], v[156:159], v[28:31]
    v_mfma_f32_16x16x32_bf16 v[32:35], a[232:235], v[156:159], v[32:35]
    v_mfma_f32_16x16x32_bf16 v[36:39], a[236:239], v[156:159], v[36:39]
    s_waitcnt vmcnt(10)
    v_mfma_f32_16x16x32_bf16 v[40:43], a[0:3], v[160:163], 0
    buffer_load_dwordx4 v[200:203], v123, s[8:11], s66 offen offset:0 sc1
    v_mfma_f32_16x16x32_bf16 v[44:47], a[4:7], v[160:163], 0
    v_mfma_f32_16x16x32_bf16 v[48:51], a[8:11], v[160:163], 0
    v_mfma_f32_16x16x32_bf16 v[52:55], a[12:15], v[160:163], 0
    v_mfma_f32_16x16x32_bf16 v[56:59], a[16:19], v[160:163], 0
    s_waitcnt vmcnt(10)
    v_mfma_f32_16x16x32_bf16 v[40:43], a[20:23], v[164:167], v[40:43]
    buffer_load_dwordx4 v[204:207], v123, s[8:11], s66 offen offset:3072 sc1
    v_mfma_f32_16x16x32_bf16 v[44:47], a[24:27], v[164:167], v[44:47]
    v_mfma_f32_16x16x32_bf16 v[48:51], a[28:31], v[164:167], v[48:51]
    v_mfma_f32_16x16x32_bf16 v[52:55], a[32:35], v[164:167], v[52:55]
    v_mfma_f32_16x16x32_bf16 v[56:59], a[36:39], v[164:167], v[56:59]
    s_waitcnt vmcnt(10)
    v_mfma_f32_16x16x32_bf16 v[40:43], a[80:83], v[168:171], v[40:43]
    buffer_load_dwordx4 v[208:211], v3, s[8:11], s67 offen offset:0 sc1
    v_mfma_f32_16x16x32_bf16 v[44:47], a[84:87], v[168:171], v[44:47]
    v_mfma_f32_16x16x32_bf16 v[48:51], a[88:91], v[168:171], v[48:51]
    v_mfma_f32_16x16x32_bf16 v[52:55], a[92:95], v[168:171], v[52:55]
    v_mfma_f32_16x16x32_bf16 v[56:59], a[96:99], v[168:171], v[56:59]
    s_waitcnt vmcnt(10)
    v_mfma_f32_16x16x32_bf16 v[40:43], a[140:143], v[172:175], v[40:43]
    buffer_load_dwordx4 v[212:215], v3, s[8:11], s67 offen offset:1024 sc1
    v_mfma_f32_16x16x32_bf16 v[44:47], a[144:147], v[172:175], v[44:47]
    v_mfma_f32_16x16x32_bf16 v[48:51], a[148:151], v[172:175], v[48:51]
    v_mfma_f32_16x16x32_bf16 v[52:55], a[152:155], v[172:175], v[52:55]
    v_mfma_f32_16x16x32_bf16 v[56:59], a[156:159], v[172:175], v[56:59]
    s_waitcnt vmcnt(10)
    v_mfma_f32_16x16x32_bf16 v[40:43], a[160:163], v[176:179], v[40:43]
    buffer_load_dwordx4 v[216:219], v122, s[8:11], s67 offen offset:0 sc1
    v_mfma_f32_16x16x32_bf16 v[44:47], a[164:167], v[176:179], v[44:47]
    v_mfma_f32_16x16x32_bf16 v[48:51], a[168:171], v[176:179], v[48:51]
    v_mfma_f32_16x16x32_bf16 v[52:55], a[172:175], v[176:179], v[52:55]
    v_mfma_f32_16x16x32_bf16 v[56:59], a[176:179], v[176:179], v[56:59]
    s_waitcnt vmcnt(10)
    v_mfma_f32_16x16x32_bf16 v[40:43], a[220:223], v[180:183], v[40:43]
    buffer_load_dwordx4 v[220:223], v122, s[8:11], s67 offen offset:3072 sc1
    v_mfma_f32_16x16x32_bf16 v[44:47], a[224:227], v[180:183], v[44:47]
    v_mfma_f32_16x16x32_bf16 v[48:51], a[228:231], v[180:183], v[48:51]
    v_mfma_f32_16x16x32_bf16 v[52:55], a[232:235], v[180:183], v[52:55]
    v_mfma_f32_16x16x32_bf16 v[56:59], a[236:239], v[180:183], v[56:59]
    s_waitcnt vmcnt(10)
    v_mfma_f32_16x16x32_bf16 v[60:63], a[0:3], v[184:187], 0
    buffer_load_dwordx4 v[224:227], v123, s[8:11], s67 offen offset:0 sc1
    v_mfma_f32_16x16x32_bf16 v[64:67], a[4:7], v[184:187], 0
    v_mfma_f32_16x16x32_bf16 v[68:71], a[8:11], v[184:187], 0
    v_mfma_f32_16x16x32_bf16 v[72:75], a[12:15], v[184:187], 0
    v_mfma_f32_16x16x32_bf16 v[76:79], a[16:19], v[184:187], 0
    s_waitcnt vmcnt(10)
    v_mfma_f32_16x16x32_bf16 v[60:63], a[20:23], v[188:191], v[60:63]
    buffer_load_dwordx4 v[228:231], v123, s[8:11], s67 offen offset:3072 sc1
    v_mfma_f32_16x16x32_bf16 v[64:67], a[24:27], v[188:191], v[64:67]
    v_mfma_f32_16x16x32_bf16 v[68:71], a[28:31], v[188:191], v[68:71]
    v_mfma_f32_16x16x32_bf16 v[72:75], a[32:35], v[188:191], v[72:75]
    v_mfma_f32_16x16x32_bf16 v[76:79], a[36:39], v[188:191], v[76:79]
    s_waitcnt vmcnt(10)
    v_mfma_f32_16x16x32_bf16 v[60:63], a[80:83], v[192:195], v[60:63]
    s_waitcnt vmcnt(9)
    v_cmp_ne_u32 vcc, 1, v129
    s_nop 4
    s_cbranch_vccz L_interleave_layers__spectral_fnet__dense_activation_squared_relu__prompt_kernel_late_48
L_interleave_layers__spectral_fnet__dense_activation_squared_relu__prompt_kernel_poll_49:
    buffer_load_dword v14, v126, s[8:11], s63 offen sc1
    s_waitcnt vmcnt(0)
    v_cmp_ne_u32 vcc, 1, v14
    s_nop 4
    s_cbranch_vccz L_interleave_layers__spectral_fnet__dense_activation_squared_relu__prompt_kernel_go_50
    s_cmp_eq_u32 s82, 0
    s_cbranch_scc1 L_interleave_layers__spectral_fnet__dense_activation_squared_relu__prompt_kernel_go_50
    s_sub_u32 s82, s82, 1
    s_branch L_interleave_layers__spectral_fnet__dense_activation_squared_relu__prompt_kernel_poll_49
L_interleave_layers__spectral_fnet__dense_activation_squared_relu__prompt_kernel_go_50:
L_interleave_layers__spectral_fnet__dense_activation_squared_relu__prompt_kernel_late_48:
    buffer_load_dwordx4 v[136:139], v3, s[8:11], s64 offen offset:2048 sc1
    v_mfma_f32_16x16x32_bf16 v[64:67], a[84:87], v[192:195], v[64:67]
    v_mfma_f32_16x16x32_bf16 v[68:71], a[88:91], v[192:195], v[68:71]
    v_mfma_f32_16x16x32_bf16 v[72:75], a[92:95], v[192:195], v[72:75]
    v_mfma_f32_16x16x32_bf16 v[76:79], a[96:99], v[192:195], v[76:79]
    s_waitcnt vmcnt(9)
    v_mfma_f32_16x16x32_bf16 v[60:63], a[140:143], v[196:199], v[60:63]
    buffer_load_dwordx4 v[140:143], v3, s[8:11], s64 offen offset:3072 sc1
    v_mfma_f32_16x16x32_bf16 v[64:67], a[144:147], v[196:199], v[64:67]
    v_mfma_f32_16x16x32_bf16 v[68:71], a[148:151], v[196:199], v[68:71]
    v_mfma_f32_16x16x32_bf16 v[72:75], a[152:155], v[196:199], v[72:75]
    v_mfma_f32_16x16x32_bf16 v[76:79], a[156:159], v[196:199], v[76:79]
    s_waitcnt vmcnt(9)
    v_mfma_f32_16x16x32_bf16 v[60:63], a[160:163], v[200:203], v[60:63]
    buffer_load_dwordx4 v[144:147], v122, s[8:11], s64 offen offset:1024 sc1
    v_mfma_f32_16x16x32_bf16 v[64:67], a[164:167], v[200:203], v[64:67]
    v_mfma_f32_16x16x32_bf16 v[68:71], a[168:171], v[200:203], v[68:71]
    v_mfma_f32_16x16x32_bf16 v[72:75], a[172:175], v[200:203], v[72:75]
    v_mfma_f32_16x16x32_bf16 v[76:79], a[176:179], v[200:203], v[76:79]
    s_waitcnt vmcnt(9)
    v_mfma_f32_16x16x32_bf16 v[60:63], a[220:223], v[204:207], v[60:63]
    buffer_load_dwordx4 v[148:151], v122, s[8:11], s64 offen offset:2048 sc1
    v_mfma_f32_16x16x32_bf16 v[64:67], a[224:227], v[204:207], v[64:67]
    v_mfma_f32_16x16x32_bf16 v[68:71], a[228:231], v[204:207], v[68:71]
    v_mfma_f32_16x16x32_bf16 v[72:75], a[232:235], v[204:207], v[72:75]
    v_mfma_f32_16x16x32_bf16 v[76:79], a[236:239], v[204:207], v[76:79]
    s_waitcnt vmcnt(9)
    v_mfma_f32_16x16x32_bf16 v[80:83], a[0:3], v[208:211], 0
    buffer_load_dwordx4 v[152:155], v123, s[8:11], s64 offen offset:1024 sc1
    v_mfma_f32_16x16x32_bf16 v[84:87], a[4:7], v[208:211], 0
    v_mfma_f32_16x16x32_bf16 v[88:91], a[8:11], v[208:211], 0
    v_mfma_f32_16x16x32_bf16 v[92:95], a[12:15], v[208:211], 0
    v_mfma_f32_16x16x32_bf16 v[96:99], a[16:19], v[208:211], 0
    s_waitcnt vmcnt(9)
    v_mfma_f32_16x16x32_bf16 v[80:83], a[20:23], v[212:215], v[80:83]
    buffer_load_dwordx4 v[156:159], v123, s[8:11], s64 offen offset:2048 sc1
    v_mfma_f32_16x16x32_bf16 v[84:87], a[24:27], v[212:215], v[84:87]
    v_mfma_f32_16x16x32_bf16 v[88:91], a[28:31], v[212:215], v[88:91]
    v_mfma_f32_16x16x32_bf16 v[92:95], a[32:35], v[212:215], v[92:95]
    v_mfma_f32_16x16x32_bf16 v[96:99], a[36:39], v[212:215], v[96:99]
    s_waitcnt vmcnt(9)
    v_mfma_f32_16x16x32_bf16 v[80:83], a[80:83], v[216:219], v[80:83]
    buffer_load_dwordx4 v[160:163], v124, s[8:11], s64 offen offset:0 sc1
    v_mfma_f32_16x16x32_bf16 v[84:87], a[84:87], v[216:219], v[84:87]
    v_mfma_f32_16x16x32_bf16 v[88:91], a[88:91], v[216:219], v[88:91]
    v_mfma_f32_16x16x32_bf16 v[92:95], a[92:95], v[216:219], v[92:95]
    v_mfma_f32_16x16x32_bf16 v[96:99], a[96:99], v[216:219], v[96:99]
    s_waitcnt vmcnt(9)
    v_mfma_f32_16x16x32_bf16 v[80:83], a[140:143], v[220:223], v[80:83]
    buffer_load_dwordx4 v[164:167], v125, s[8:11], s64 offen offset:0 sc1
    v_mfma_f32_16x16x32_bf16 v[84:87], a[144:147], v[220:223], v[84:87]
    v_mfma_f32_16x16x32_bf16 v[88:91], a[148:151], v[220:223], v[88:91]
    v_mfma_f32_16x16x32_bf16 v[92:95], a[152:155], v[220:223], v[92:95]
    v_mfma_f32_16x16x32_bf16 v[96:99], a[156:159], v[220:223], v[96:99]
    s_waitcnt vmcnt(9)
    v_mfma_f32_16x16x32_bf16 v[80:83], a[160:163], v[224:227], v[80:83]
    buffer_load_dwordx4 v[168:171], v3, s[8:11], s65 offen offset:2048 sc1
    v_mfma_f32_16x16x32_bf16 v[84:87], a[164:167], v[224:227], v[84:87]
    v_mfma_f32_16x16x32_bf16 v[88:91], a[168:171], v[224:227], v[88:91]
    v_mfma_f32_16x16x32_bf16 v[92:95], a[172:175], v[224:227], v[92:95]
    v_mfma_f32_16x16x32_bf16 v[96:99], a[176:179], v[224:227], v[96:99]
    s_waitcnt vmcnt(9)
    v_mfma_f32_16x16x32_bf16 v[80:83], a[220:223], v[228:231], v[80:83]
    buffer_load_dwordx4 v[172:175], v3, s[8:11], s65 offen offset:3072 sc1
    v_mfma_f32_16x16x32_bf16 v[84:87], a[224:227], v[228:231], v[84:87]
    v_mfma_f32_16x16x32_bf16 v[88:91], a[228:231], v[228:231], v[88:91]
    v_mfma_f32_16x16x32_bf16 v[92:95], a[232:235], v[228:231], v[92:95]
    v_mfma_f32_16x16x32_bf16 v[96:99], a[236:239], v[228:231], v[96:99]
    s_waitcnt vmcnt(9)
    v_mfma_f32_16x16x32_bf16 v[20:23], a[40:43], v[136:139], v[20:23]
    buffer_load_dwordx4 v[176:179], v122, s[8:11], s65 offen offset:1024 sc1
    v_mfma_f32_16x16x32_bf16 v[24:27], a[44:47], v[136:139], v[24:27]
    v_add_u32 v129, s71, v3
    v_mfma_f32_16x16x32_bf16 v[28:31], a[48:51], v[136:139], v[28:31]
    v_mfma_f32_16x16x32_bf16 v[32:35], a[52:55], v[136:139], v[32:35]
    v_mfma_f32_16x16x32_bf16 v[36:39], a[56:59], v[136:139], v[36:39]
    s_waitcnt vmcnt(9)
    v_mfma_f32_16x16x32_bf16 v[20:23], a[60:63], v[140:143], v[20:23]
    buffer_load_dwordx4 v[180:183], v122, s[8:11], s65 offen offset:2048 sc1
    v_mfma_f32_16x16x32_bf16 v[24:27], a[64:67], v[140:143], v[24:27]
    v_mfma_f32_16x16x32_bf16 v[28:31], a[68:71], v[140:143], v[28:31]
    v_mfma_f32_16x16x32_bf16 v[32:35], a[72:75], v[140:143], v[32:35]
    v_mfma_f32_16x16x32_bf16 v[36:39], a[76:79], v[140:143], v[36:39]
    s_waitcnt vmcnt(9)
    v_mfma_f32_16x16x32_bf16 v[20:23], a[100:103], v[144:147], v[20:23]
    buffer_load_dwordx4 v[184:187], v123, s[8:11], s65 offen offset:1024 sc1
    v_mfma_f32_16x16x32_bf16 v[24:27], a[104:107], v[144:147], v[24:27]
    v_mfma_f32_16x16x32_bf16 v[28:31], a[108:111], v[144:147], v[28:31]
    v_mfma_f32_16x16x32_bf16 v[32:35], a[112:115], v[144:147], v[32:35]
    v_mfma_f32_16x16x32_bf16 v[36:39], a[116:119], v[144:147], v[36:39]
    s_waitcnt vmcnt(9)
    v_mfma_f32_16x16x32_bf16 v[20:23], a[120:123], v[148:151], v[20:23]
    buffer_load_dwordx4 v[188:191], v123, s[8:11], s65 offen offset:2048 sc1
    v_mfma_f32_16x16x32_bf16 v[24:27], a[124:127], v[148:151], v[24:27]
    v_mfma_f32_16x16x32_bf16 v[28:31], a[128:131], v[148:151], v[28:31]
    v_mfma_f32_16x16x32_bf16 v[32:35], a[132:135], v[148:151], v[32:35]
    v_mfma_f32_16x16x32_bf16 v[36:39], a[136:139], v[148:151], v[36:39]
    s_waitcnt vmcnt(9)
    v_mfma_f32_16x16x32_bf16 v[20:23], a[180:183], v[152:155], v[20:23]
    buffer_load_dwordx4 v[192:195], v124, s[8:11], s65 offen offset:0 sc1
    v_mfma_f32_16x16x32_bf16 v[24:27], a[184:187], v[152:155], v[24:27]
    v_mfma_f32_16x16x32_bf16 v[28:31], a[188:191], v[152:155], v[28:31]
    v_mfma_f32_16x16x32_bf16 v[32:35], a[192:195], v[152:155], v[32:35]
    v_mfma_f32_16x16x32_bf16 v[36:39], a[196:199], v[152:155], v[36:39]
    s_waitcnt vmcnt(9)
    v_mfma_f32_16x16x32_bf16 v[20:23], a[200:203], v[156:159], v[20:23]
    buffer_load_dwordx4 v[196:199], v125, s[8:11], s65 offen offset:0 sc1
    v_mfma_f32_16x16x32_bf16 v[24:27], a[204:207], v[156:159], v[24:27]
    v_mfma_f32_16x16x32_bf16 v[28:31], a[208:211], v[156:159], v[28:31]
    v_mfma_f32_16x16x32_bf16 v[32:35], a[212:215], v[156:159], v[32:35]
    v_mfma_f32_16x16x32_bf16 v[36:39], a[216:219], v[156:159], v[36:39]
    s_waitcnt vmcnt(9)
    v_mfma_f32_16x16x32_bf16 v[20:23], a[240:243], v[160:163], v[20:23]
    buffer_load_dwordx4 v[200:203], v3, s[8:11], s66 offen offset:2048 sc1
    v_mfma_f32_16x16x32_bf16 v[24:27], a[244:247], v[160:163], v[24:27]
    v_mfma_f32_16x16x32_bf16 v[28:31], a[248:251], v[160:163], v[28:31]
    v_mfma_f32_16x16x32_bf16 v[32:35], a[252:255], v[160:163], v[32:35]
    v_mfma_f32_16x16x32_bf16 v[36:39], v[232:235], v[160:163], v[36:39]
    s_waitcnt vmcnt(9)
    v_mfma_f32_16x16x32_bf16 v[20:23], v[236:239], v[164:167], v[20:23]
    buffer_load_dwordx4 v[204:207], v3, s[8:11], s66 offen offset:3072 sc1
    v_mfma_f32_16x16x32_bf16 v[24:27], v[240:243], v[164:167], v[24:27]
    v_mfma_f32_16x16x32_bf16 v[28:31], v[244:247], v[164:167], v[28:31]
    v_mfma_f32_16x16x32_bf16 v[32:35], v[248:251], v[164:167], v[32:35]
    v_mfma_f32_16x16x32_bf16 v[36:39], v[252:255], v[164:167], v[36:39]
    s_waitcnt vmcnt(9)
    v_mfma_f32_16x16x32_bf16 v[40:43], a[40:43], v[168:171], v[40:43]
    buffer_load_dwordx4 v[208:211], v122, s[8:11], s66 offen offset:1024 sc1
    v_mfma_f32_16x16x32_bf16 v[44:47], a[44:47], v[168:171], v[44:47]
    v_add_u32 v128, s68, v3
    v_mfma_f32_16x16x32_bf16 v[48:51], a[48:51], v[168:171], v[48:51]
    v_mfma_f32_16x16x32_bf16 v[52:55], a[52:55], v[168:171], v[52:55]
    v_mfma_f32_16x16x32_bf16 v[56:59], a[56:59], v[168:171], v[56:59]
    ds_write_b128 v128, v[20:23] offset:0
    s_waitcnt vmcnt(9)
    v_mfma_f32_16x16x32_bf16 v[40:43], a[60:63], v[172:175], v[40:43]
    buffer_load_dwordx4 v[212:215], v122, s[8:11], s66 offen offset:2048 sc1
    v_mfma_f32_16x16x32_bf16 v[44:47], a[64:67], v[172:175], v[44:47]
    v_mfma_f32_16x16x32_bf16 v[48:51], a[68:71], v[172:175], v[48:51]
    ds_write_b128 v128, v[24:27] offset:1024
    v_mfma_f32_16x16x32_bf16 v[52:55], a[72:75], v[172:175], v[52:55]
    v_mfma_f32_16x16x32_bf16 v[56:59], a[76:79], v[172:175], v[56:59]
    s_waitcnt vmcnt(9)
    v_mfma_f32_16x16x32_bf16 v[40:43], a[100:103], v[176:179], v[40:43]
    buffer_load_dwordx4 v[216:219], v123, s[8:11], s66 offen offset:1024 sc1
    ds_write_b128 v128, v[28:31] offset:2048
    v_mfma_f32_16x16x32_bf16 v[44:47], a[104:107], v[176:179], v[44:47]
    v_mfma_f32_16x16x32_bf16 v[48:51], a[108:111], v[176:179], v[48:51]
    v_mfma_f32_16x16x32_bf16 v[52:55], a[112:115], v[176:179], v[52:55]
    ds_write_b128 v128, v[32:35] offset:3072
    v_mfma_f32_16x16x32_bf16 v[56:59], a[116:119], v[176:179], v[56:59]
    s_waitcnt vmcnt(9)
    v_mfma_f32_16x16x32_bf16 v[40:43], a[120:123], v[180:183], v[40:43]
    buffer_load_dwordx4 v[220:223], v123, s[8:11], s66 offen offset:2048 sc1
    v_mfma_f32_16x16x32_bf16 v[44:47], a[124:127], v[180:183], v[44:47]
    ds_write_b128 v128, v[36:39] offset:4096
    v_mfma_f32_16x16x32_bf16 v[48:51], a[128:131], v[180:183], v[48:51]
    v_mfma_f32_16x16x32_bf16 v[52:55], a[132:135], v[180:183], v[52:55]
    v_mfma_f32_16x16x32_bf16 v[56:59], a[136:139], v[180:183], v[56:59]
    s_waitcnt vmcnt(9)
    v_mfma_f32_16x16x32_bf16 v[40:43], a[180:183], v[184:187], v[40:43]
    buffer_load_dwordx4 v[224:227], v124, s[8:11], s66 offen offset:0 sc1
    v_mfma_f32_16x16x32_bf16 v[44:47], a[184:187], v[184:187], v[44:47]
    v_mfma_f32_16x16x32_bf16 v[48:51], a[188:191], v[184:187], v[48:51]
    v_mfma_f32_16x16x32_bf16 v[52:55], a[192:195], v[184:187], v[52:55]
    v_mfma_f32_16x16x32_bf16 v[56:59], a[196:199], v[184:187], v[56:59]
    s_waitcnt vmcnt(9)
    v_mfma_f32_16x16x32_bf16 v[40:43], a[200:203], v[188:191], v[40:43]
    buffer_load_dwordx4 v[228:231], v125, s[8:11], s66 offen offset:0 sc1
    v_mfma_f32_16x16x32_bf16 v[44:47], a[204:207], v[188:191], v[44:47]
    v_mfma_f32_16x16x32_bf16 v[48:51], a[208:211], v[188:191], v[48:51]
    v_mfma_f32_16x16x32_bf16 v[52:55], a[212:215], v[188:191], v[52:55]
    v_mfma_f32_16x16x32_bf16 v[56:59], a[216:219], v[188:191], v[56:59]
    s_waitcnt vmcnt(9)
    v_mfma_f32_16x16x32_bf16 v[40:43], a[240:243], v[192:195], v[40:43]
    buffer_load_dwordx4 v[136:139], v3, s[8:11], s67 offen offset:2048 sc1
    v_mfma_f32_16x16x32_bf16 v[44:47], a[244:247], v[192:195], v[44:47]
    v_mfma_f32_16x16x32_bf16 v[48:51], a[248:251], v[192:195], v[48:51]
    v_mfma_f32_16x16x32_bf16 v[52:55], a[252:255], v[192:195], v[52:55]
    v_mfma_f32_16x16x32_bf16 v[56:59], v[232:235], v[192:195], v[56:59]
    s_waitcnt vmcnt(9)
    v_mfma_f32_16x16x32_bf16 v[40:43], v[236:239], v[196:199], v[40:43]
    buffer_load_dwordx4 v[140:143], v3, s[8:11], s67 offen offset:3072 sc1
    v_mfma_f32_16x16x32_bf16 v[44:47], v[240:243], v[196:199], v[44:47]
    v_mfma_f32_16x16x32_bf16 v[48:51], v[244:247], v[196:199], v[48:51]
    v_mfma_f32_16x16x32_bf16 v[52:55], v[248:251], v[196:199], v[52:55]
    v_mfma_f32_16x16x32_bf16 v[56:59], v[252:255], v[196:199], v[56:59]
    s_waitcnt vmcnt(9)
    v_mfma_f32_16x16x32_bf16 v[60:63], a[40:43], v[200:203], v[60:63]
    buffer_load_dwordx4 v[144:147], v122, s[8:11], s67 offen offset:1024 sc1
    v_mfma_f32_16x16x32_bf16 v[64:67], a[44:47], v[200:203], v[64:67]
    v_add_u32 v128, s69, v3
    v_mfma_f32_16x16x32_bf16 v[68:71], a[48:51], v[200:203], v[68:71]
    v_mfma_f32_16x16x32_bf16 v[72:75], a[52:55], v[200:203], v[72:75]
    v_mfma_f32_16x16x32_bf16 v[76:79], a[56:59], v[200:203], v[76:79]
    ds_write_b128 v128, v[40:43] offset:0
    s_waitcnt vmcnt(9)
    v_mfma_f32_16x16x32_bf16 v[60:63], a[60:63], v[204:207], v[60:63]
    buffer_load_dwordx4 v[148:151], v122, s[8:11], s67 offen offset:2048 sc1
    v_mfma_f32_16x16x32_bf16 v[64:67], a[64:67], v[204:207], v[64:67]
    v_mfma_f32_16x16x32_bf16 v[68:71], a[68:71], v[204:207], v[68:71]
    ds_write_b128 v128, v[44:47] offset:1024
    v_mfma_f32_16x16x32_bf16 v[72:75], a[72:75], v[204:207], v[72:75]
    v_mfma_f32_16x16x32_bf16 v[76:79], a[76:79], v[204:207], v[76:79]
    s_waitcnt vmcnt(9)
    v_mfma_f32_16x16x32_bf16 v[60:63], a[100:103], v[208:211], v[60:63]
    buffer_load_dwordx4 v[152:155], v123, s[8:11], s67 offen offset:1024 sc1
    ds_write_b128 v128, v[48:51] offset:2048
    v_mfma_f32_16x16x32_bf16 v[64:67], a[104:107], v[208:211], v[64:67]
    v_mfma_f32_16x16x32_bf16 v[68:71], a[108:111], v[208:211], v[68:71]
    v_mfma_f32_16x16x32_bf16 v[72:75], a[112:115], v[208:211], v[72:75]
    ds_write_b128 v128, v[52:55] offset:3072
    v_mfma_f32_16x16x32_bf16 v[76:79], a[116:119], v[208:211], v[76:79]
    s_waitcnt vmcnt(9)
    v_mfma_f32_16x16x32_bf16 v[60:63], a[120:123], v[212:215], v[60:63]
    buffer_load_dwordx4 v[156:159], v123, s[8:11], s67 offen offset:2048 sc1
    v_mfma_f32_16x16x32_bf16 v[64:67], a[124:127], v[212:215], v[64:67]
    ds_write_b128 v128, v[56:59] offset:4096
    v_mfma_f32_16x16x32_bf16 v[68:71], a[128:131], v[212:215], v[68:71]
    v_mfma_f32_16x16x32_bf16 v[72:75], a[132:135], v[212:215], v[72:75]
    v_mfma_f32_16x16x32_bf16 v[76:79], a[136:139], v[212:215], v[76:79]
    s_waitcnt lgkmcnt(0)
    s_barrier
    s_waitcnt vmcnt(9)
    v_mfma_f32_16x16x32_bf16 v[60:63], a[180:183], v[216:219], v[60:63]
    buffer_load_dwordx4 v[160:163], v124, s[8:11], s67 offen offset:0 sc1
    ds_read_b128 v[20:23], v129 offset:0
    v_mfma_f32_16x16x32_bf16 v[64:67], a[184:187], v[216:219], v[64:67]
    ds_read_b128 v[24:27], v129 offset:1024
    v_mfma_f32_16x16x32_bf16 v[68:71], a[188:191], v[216:219], v[68:71]
    ds_read_b128 v[28:31], v129 offset:2048
    v_mfma_f32_16x16x32_bf16 v[72:75], a[192:195], v[216:219], v[72:75]
    ds_read_b128 v[32:35], v129 offset:3072
    v_mfma_f32_16x16x32_bf16 v[76:79], a[196:199], v[216:219], v[76:79]
    ds_read_b128 v[36:39], v129 offset:4096
    s_waitcnt vmcnt(9)
    v_mfma_f32_16x16x32_bf16 v[60:63], a[200:203], v[220:223], v[60:63]
    buffer_load_dwordx4 v[164:167], v125, s[8:11], s67 offen offset:0 sc1
    ds_read_b128 v[40:43], v129 offset:5120
    v_mfma_f32_16x16x32_bf16 v[64:67], a[204:207], v[220:223], v[64:67]
    ds_read_b128 v[44:47], v129 offset:6144
    v_mfma_f32_16x16x32_bf16 v[68:71], a[208:211], v[220:223], v[68:71]
    ds_read_b128 v[48:51], v129 offset:7168
    v_mfma_f32_16x16x32_bf16 v[72:75], a[212:215], v[220:223], v[72:75]
    ds_read_b128 v[52:55], v129 offset:8192
    v_mfma_f32_16x16x32_bf16 v[76:79], a[216:219], v[220:223], v[76:79]
    ds_read_b128 v[56:59], v129 offset:9216
    s_waitcnt vmcnt(9)
    v_mfma_f32_16x16x32_bf16 v[60:63], a[240:243], v[224:227], v[60:63]
    s_waitcnt lgkmcnt(5)
    v_fmac_f32 v100, v20, v120
    v_mfma_f32_16x16x32_bf16 v[64:67], a[244:247], v[224:227], v[64:67]
    v_fmac_f32 v101, v21, v120
    v_fmac_f32 v102, v22, v120
    v_mfma_f32_16x16x32_bf16 v[68:71], a[248:251], v[224:227], v[68:71]
    v_fmac_f32 v103, v23, v120
    v_fmac_f32 v104, v24, v120
    v_mfma_f32_16x16x32_bf16 v[72:75], a[252:255], v[224:227], v[72:75]
    v_fmac_f32 v105, v25, v120
    v_fmac_f32 v106, v26, v120
    v_mfma_f32_16x16x32_bf16 v[76:79], v[232:235], v[224:227], v[76:79]
    v_fmac_f32 v107, v27, v120
    s_waitcnt vmcnt(8)
    v_mfma_f32_16x16x32_bf16 v[60:63], v[236:239], v[228:231], v[60:63]
    v_fmac_f32 v108, v28, v120
    v_fmac_f32 v109, v29, v120
    v_mfma_f32_16x16x32_bf16 v[64:67], v[240:243], v[228:231], v[64:67]
    v_fmac_f32 v110, v30, v120
    v_fmac_f32 v111, v31, v120
    v_mfma_f32_16x16x32_bf16 v[68:71], v[244:247], v[228:231], v[68:71]
    v_fmac_f32 v112, v32, v120
    v_fmac_f32 v113, v33, v120
    v_mfma_f32_16x16x32_bf16 v[72:75], v[248:251], v[228:231], v[72:75]
    v_fmac_f32 v114, v34, v120
    v_fmac_f32 v115, v35, v120
    v_mfma_f32_16x16x32_bf16 v[76:79], v[252:255], v[228:231], v[76:79]
    v_fmac_f32 v116, v36, v120
    s_waitcnt vmcnt(7)
    v_mfma_f32_16x16x32_bf16 v[80:83], a[40:43], v[136:139], v[80:83]
    v_fmac_f32 v117, v37, v120
    v_fmac_f32 v118, v38, v120
    v_mfma_f32_16x16x32_bf16 v[84:87], a[44:47], v[136:139], v[84:87]
    v_add_u32 v128, s70, v3
    v_fmac_f32 v119, v39, v120
    v_mfma_f32_16x16x32_bf16 v[88:91], a[48:51], v[136:139], v[88:91]
    s_waitcnt lgkmcnt(0)
    v_fmac_f32 v100, v40, v120
    v_mfma_f32_16x16x32_bf16 v[92:95], a[52:55], v[136:139], v[92:95]
    v_fmac_f32 v101, v41, v120
    v_fmac_f32 v102, v42, v120
    v_mfma_f32_16x16x32_bf16 v[96:99], a[56:59], v[136:139], v[96:99]
    ds_write_b128 v128, v[60:63] offset:0
    s_waitcnt vmcnt(6)
    v_mfma_f32_16x16x32_bf16 v[80:83], a[60:63], v[140:143], v[80:83]
    v_fmac_f32 v103, v43, v120
    v_fmac_f32 v104, v44, v120
    v_mfma_f32_16x16x32_bf16 v[84:87], a[64:67], v[140:143], v[84:87]
    v_fmac_f32 v105, v45, v120
    v_fmac_f32 v106, v46, v120
    v_mfma_f32_16x16x32_bf16 v[88:91], a[68:71], v[140:143], v[88:91]
    ds_write_b128 v128, v[64:67] offset:1024
    v_fmac_f32 v107, v47, v120
    v_mfma_f32_16x16x32_bf16 v[92:95], a[72:75], v[140:143], v[92:95]
    v_fmac_f32 v108, v48, v120
    v_fmac_f32 v109, v49, v120
    v_mfma_f32_16x16x32_bf16 v[96:99], a[76:79], v[140:143], v[96:99]
    v_fmac_f32 v110, v50, v120
    s_waitcnt vmcnt(5)
    v_mfma_f32_16x16x32_bf16 v[80:83], a[100:103], v[144:147], v[80:83]
    ds_write_b128 v128, v[68:71] offset:2048
    v_fmac_f32 v111, v51, v120
    v_mfma_f32_16x16x32_bf16 v[84:87], a[104:107], v[144:147], v[84:87]
    v_fmac_f32 v112, v52, v120
    v_fmac_f32 v113, v53, v120
    v_mfma_f32_16x16x32_bf16 v[88:91], a[108:111], v[144:147], v[88:91]
    v_fmac_f32 v114, v54, v120
    v_fmac_f32 v115, v55, v120
    v_mfma_f32_16x16x32_bf16 v[92:95], a[112:115], v[144:147], v[92:95]
    ds_write_b128 v128, v[72:75] offset:3072
    v_fmac_f32 v116, v56, v120
    v_mfma_f32_16x16x32_bf16 v[96:99], a[116:119], v[144:147], v[96:99]
    v_fmac_f32 v117, v57, v120
    s_waitcnt vmcnt(4)
    v_mfma_f32_16x16x32_bf16 v[80:83], a[120:123], v[148:151], v[80:83]
    v_fmac_f32 v118, v58, v120
    v_fmac_f32 v119, v59, v120
    v_mfma_f32_16x16x32_bf16 v[84:87], a[124:127], v[148:151], v[84:87]
    ds_write_b128 v128, v[76:79] offset:4096
    v_mfma_f32_16x16x32_bf16 v[88:91], a[128:131], v[148:151], v[88:91]
    v_mfma_f32_16x16x32_bf16 v[92:95], a[132:135], v[148:151], v[92:95]
    v_mfma_f32_16x16x32_bf16 v[96:99], a[136:139], v[148:151], v[96:99]
    s_waitcnt lgkmcnt(0)
    s_barrier
    s_waitcnt vmcnt(3)
    v_mfma_f32_16x16x32_bf16 v[80:83], a[180:183], v[152:155], v[80:83]
    ds_read_b128 v[60:63], v129 offset:10240
    v_mfma_f32_16x16x32_bf16 v[84:87], a[184:187], v[152:155], v[84:87]
    ds_read_b128 v[64:67], v129 offset:11264
    v_mfma_f32_16x16x32_bf16 v[88:91], a[188:191], v[152:155], v[88:91]
    ds_read_b128 v[68:71], v129 offset:12288
    v_mfma_f32_16x16x32_bf16 v[92:95], a[192:195], v[152:155], v[92:95]
    ds_read_b128 v[72:75], v129 offset:13312
    v_mfma_f32_16x16x32_bf16 v[96:99], a[196:199], v[152:155], v[96:99]
    ds_read_b128 v[76:79], v129 offset:14336
    s_waitcnt vmcnt(2)
    v_mfma_f32_16x16x32_bf16 v[80:83], a[200:203], v[156:159], v[80:83]
    v_mfma_f32_16x16x32_bf16 v[84:87], a[204:207], v[156:159], v[84:87]
    v_mfma_f32_16x16x32_bf16 v[88:91], a[208:211], v[156:159], v[88:91]
    s_waitcnt lgkmcnt(0)
    v_fmac_f32 v100, v60, v120
    v_mfma_f32_16x16x32_bf16 v[92:95], a[212:215], v[156:159], v[92:95]
    v_fmac_f32 v101, v61, v120
    v_fmac_f32 v102, v62, v120
    v_mfma_f32_16x16x32_bf16 v[96:99], a[216:219], v[156:159], v[96:99]
    v_fmac_f32 v103, v63, v120
    s_waitcnt vmcnt(1)
    v_mfma_f32_16x16x32_bf16 v[80:83], a[240:243], v[160:163], v[80:83]
    v_fmac_f32 v104, v64, v120
    v_fmac_f32 v105, v65, v120
    v_mfma_f32_16x16x32_bf16 v[84:87], a[244:247], v[160:163], v[84:87]
    v_fmac_f32 v106, v66, v120
    v_fmac_f32 v107, v67, v120
    v_mfma_f32_16x16x32_bf16 v[88:91], a[248:251], v[160:163], v[88:91]
    v_fmac_f32 v108, v68, v120
    v_fmac_f32 v109, v69, v120
    v_mfma_f32_16x16x32_bf16 v[92:95], a[252:255], v[160:163], v[92:95]
    v_fmac_f32 v110, v70, v120
    v_fmac_f32 v111, v71, v120
    v_mfma_f32_16x16x32_bf16 v[96:99], v[232:235], v[160:163], v[96:99]
    v_fmac_f32 v112, v72, v120
    s_waitcnt vmcnt(0)
    v_mfma_f32_16x16x32_bf16 v[80:83], v[236:239], v[164:167], v[80:83]
    v_fmac_f32 v113, v73, v120
    v_fmac_f32 v114, v74, v120
    v_mfma_f32_16x16x32_bf16 v[84:87], v[240:243], v[164:167], v[84:87]
    v_fmac_f32 v115, v75, v120
    v_fmac_f32 v116, v76, v120
    v_mfma_f32_16x16x32_bf16 v[88:91], v[244:247], v[164:167], v[88:91]
    v_fmac_f32 v117, v77, v120
    v_fmac_f32 v118, v78, v120
    v_mfma_f32_16x16x32_bf16 v[92:95], v[248:251], v[164:167], v[92:95]
    v_fmac_f32 v119, v79, v120
    v_mfma_f32_16x16x32_bf16 v[96:99], v[252:255], v[164:167], v[96:99]
    v_pk_fma_f32 v[100:101], v[80:81], v[120:121], v[100:101]
    v_pk_fma_f32 v[102:103], v[82:83], v[120:121], v[102:103]
    v_pk_fma_f32 v[104:105], v[84:85], v[120:121], v[104:105]
    v_pk_fma_f32 v[106:107], v[86:87], v[120:121], v[106:107]
    v_cvt_pk_bf16_f32 v20, v100, v101
    v_cvt_pk_bf16_f32 v21, v102, v103
    v_cvt_pk_bf16_f32 v22, v104, v105
    v_cvt_pk_bf16_f32 v23, v106, v107
    buffer_store_dwordx4 v[20:23], v131, s[40:43], s72 offen
    v_pk_fma_f32 v[108:109], v[88:89], v[120:121], v[108:109]
    v_pk_fma_f32 v[110:111], v[90:91], v[120:121], v[110:111]
    v_pk_fma_f32 v[112:113], v[92:93], v[120:121], v[112:113]
    v_pk_fma_f32 v[114:115], v[94:95], v[120:121], v[114:115]
    v_cvt_pk_bf16_f32 v24, v115, v114
    v_cvt_pk_bf16_f32 v25, v113, v112
    v_cvt_pk_bf16_f32 v26, v111, v110
    v_cvt_pk_bf16_f32 v27, v109, v108
    s_mov_b32 exec_lo, s73
    buffer_store_dwordx4 v[24:27], v132, s[40:43], 0 offen
    s_mov_b32 exec_lo, -1
    v_pk_fma_f32 v[116:117], v[96:97], v[120:121], v[116:117]
    v_pk_fma_f32 v[118:119], v[98:99], v[120:121], v[118:119]
    v_cmp_lt_u32 vcc, 1, v2
    v_cvt_pk_bf16_f32 v28, v116, v117
    v_cvt_pk_bf16_f32 v30, v119, v118
    v_cvt_pk_bf16_f32 v29, v118, v119
    v_cvt_pk_bf16_f32 v31, v117, v116
    v_cndmask_b32 v28, v28, v30, vcc
    v_cndmask_b32 v29, v29, v31, vcc
    buffer_store_dwordx2 v[28:29], v133, s[40:43], 0 offen
    s_cmp_eq_u32 s6, 0
    s_cbranch_scc0 L_interleave_layers__spectral_fnet__dense_activation_squared_relu__prompt_kernel_nz_51
    s_mov_b64 exec, 0xffff
    buffer_store_dwordx3 v[24:26], v132, s[40:43], 0 offen
    buffer_store_short v27, v130, s[40:43], 0 offen offset:1278
    buffer_store_short_d16_hi v27, v130, s[40:43], 0 offen offset:640
    s_mov_b64 exec, -1
L_interleave_layers__spectral_fnet__dense_activation_squared_relu__prompt_kernel_nz_51:
L_end:
    s_endpgm
.p2align 4
.type L_cs,@object
L_cs:
.long 0x00000000, 0xb3563786, 0xb256b71d, 0x00000000
.long 0x0000b3bc, 0x00003599, 0x0000b689, 0x00000000
.long 0x2f00b389, 0xb2503685, 0xb200b618, 0x00000000
.long 0x000032cd, 0x000036b0, 0xb711bc00, 0x00000000
.long 0xafc0351e, 0x336a37b0, 0x3140b66d, 0x00000000
.long 0xb0b0350b, 0x0000b686, 0x0000b5d2, 0x00000000
.long 0x2f00b34e, 0x3200b6b1, 0x00003584, 0x00000000
.long 0x000035b2, 0x000036db, 0x0000368a, 0x00000000
.long 0x312835fd, 0xafc0b473, 0x00000000, 0x00000000
.long 0x0000b39a, 0x3180368f, 0x00000000, 0x00000000
.long 0xb256370b, 0xb2003638, 0x00000000, 0x00000000
.long 0x0000b59f, 0x00003687, 0x00000000, 0x00000000
.long 0x2f00b3e7, 0xb280b6b2, 0x00000000, 0x00000000
.long 0x0000b5b9, 0x0000358c, 0x00000000, 0x00000000
.long 0x0000b633, 0x32e5b705, 0x00000000, 0x00000000
.long 0x324a3683, 0x35ccbc00, 0x00000000, 0x00000000
.long 0xb0b03567, 0x32a0b732, 0xb2e8374d, 0x00000000
.long 0x0000357e, 0x0000b68f, 0x0000b71f, 0x00000000
.long 0x0000b6f5, 0xb300375e, 0xb2803735, 0x00000000
.long 0x000035d9, 0x36e5bc00, 0x3698bbff, 0x00000000
.long 0x3180b643, 0x3399b802, 0x0000b5fc, 0x00000000
.long 0xb7c3bc00, 0x0000b71d, 0x35313c00, 0x00000000
.long 0x00003612, 0x0000b64c, 0x0000b528, 0x00000000
.long 0x000036e2, 0x0000b65e, 0x000035ff, 0x00000000
.long 0x32e5b783, 0x00000000, 0x00000000, 0x00000000
.long 0x0000b71c, 0xb773bbff, 0x00000000, 0x00000000
.long 0xb3d03845, 0xb280b6ee, 0x00000000, 0x00000000
.long 0xb665bc00, 0x0000378f, 0x00000000, 0x00000000
.long 0x331037ae, 0xb32037da, 0x00000000, 0x00000000
.long 0x0000b772, 0x0000b692, 0x00000000, 0x00000000
.long 0xb300b783, 0x32a0b760, 0x00000000, 0x00000000
.long 0x3180b6c7, 0xb70c3c00, 0x00000000, 0x00000000
.long 0x332a37b5, 0x33b9383d, 0xb4c6b936, 0x00000000
.long 0xb7a5bc00, 0x0000b722, 0x000034c8, 0x00000000
.long 0xb20037f0, 0xb300b748, 0x3280b6e2, 0x00000000
.long 0x36eb3c00, 0xb64bbc00, 0xb300b7ed, 0x00000000
.long 0xb380b7fa, 0x3360b7dc, 0x3300b7a3, 0x00000000
.long 0xb7d03c01, 0x0000b778, 0x0000b69f, 0x00000000
.long 0x3200374a, 0xb28036e6, 0x3300378d, 0x00000000
.long 0x374cbc00, 0x0000360c, 0x000037bd, 0x00000000
.long 0xb2e0b7f0, 0x3388386e, 0x00000000, 0x00000000
.long 0x33b8b8ff, 0x3440b88a, 0x00000000, 0x00000000
.long 0xb33437a8, 0x0000b5e8, 0x00000000, 0x00000000
.long 0xb75ebbff, 0x000036f2, 0x00000000, 0x00000000
.long 0x33c0b82e, 0xb300b70a, 0x00000000, 0x00000000
.long 0xb699bc00, 0xb7d2bc00, 0x00000000, 0x00000000
.long 0x3380b7f2, 0x33c8b82f, 0x00000000, 0x00000000
.long 0xb6923c80, 0x374fbc00, 0x00000000, 0x00000000
.long 0xb3a7b844, 0xb320385a, 0xb300b700, 0x00000000
.long 0xb7253c00, 0x00003444, 0x372cbc00, 0x00000000
.long 0xb380380f, 0x00003713, 0xb370b78b, 0x00000000
.long 0x37e83c00, 0xb758bbff, 0x000036f9, 0x00000000
.long 0x3300b81a, 0xb240b97c, 0xb300381b, 0x00000000
.long 0xb7bebc00, 0x37d6bc01, 0x36ac3bff, 0x00000000
.long 0x3300b824, 0x3480b89e, 0xb200b810, 0x00000000
.long 0x00003619, 0x0000b702, 0x3755bc00, 0x00000000
.long 0x00000000, 0xb3da389b, 0x00000000, 0x00000000
.long 0x0000372f, 0xb7d4bc00, 0x00000000, 0x00000000
.long 0xb330383a, 0x3280b742, 0x00000000, 0x00000000
.long 0x000036f8, 0xb632bc00, 0x00000000, 0x00000000
.long 0x3340b7f8, 0xb450b882, 0x00000000, 0x00000000
.long 0x0000b7d4, 0xb77fbc00, 0x00000000, 0x00000000
.long 0x0000b670, 0xb40038de, 0x00000000, 0x00000000
.long 0xb30037ab, 0x0000380a, 0x00000000, 0x00000000
.long 0x312835fb, 0xb2e0b7a2, 0x00000000, 0x00000000
.long 0xb800bc00, 0x3728bc02, 0xb72f3bf4, 0x00000000
.long 0x00003716, 0x33b8387b, 0x000037a2, 0x00000000
.long 0xb7543c01, 0x3703bc00, 0xb724bc80, 0x00000000
.long 0x32c037e0, 0x329837ef, 0xb3c0b864, 0x00000000
.long 0xb8563ca0, 0xb7d7bc80, 0x0000377b, 0x00000000
.long 0xb300b76c, 0x000037df, 0xb340b7cd, 0x00000000
.long 0x000037c0, 0x3758bbff, 0x36403c00, 0x00000000
.long 0x0000b767, 0x0000b6d7, 0x00000000, 0x00000000
.long 0x000037aa, 0x37c0bc81, 0x00000000, 0x00000000
.long 0x345838e8, 0xb3003826, 0x00000000, 0x00000000
.long 0x0000b625, 0xb752bbff, 0x00000000, 0x00000000
.long 0x3200b7b5, 0x3300b746, 0x00000000, 0x00000000
.long 0x0000b781, 0x37d4bc01, 0x00000000, 0x00000000
.long 0x000036d2, 0xb30037aa, 0x00000000, 0x00000000
.long 0xb300b7e9, 0x0000b6f8, 0x00000000, 0x00000000
.long 0x3200b853, 0x000036cb, 0xb300381c, 0x00000000
.long 0xb6b43b7f, 0xb82d3ca0, 0xb51cbc00, 0x00000000
.long 0x0000387c, 0x0000b82e, 0x3300b858, 0x00000000
.long 0x0000b7bd, 0xb60bbc00, 0xb7e7bc7e, 0x00000000
.long 0x32803765, 0xb3b8b83d, 0x00003655, 0x00000000
.long 0x36a13b7a, 0xb500b910, 0x0000b818, 0x00000000
.long 0x0000b68c, 0x3440b98d, 0x33003785, 0x00000000
.long 0xb480b8e4, 0x36503bfd, 0x00003863, 0x00000000
.long 0xb330b863, 0xb503b986, 0x00000000, 0x00000000
.long 0xb5003bb7, 0x3480392a, 0x00000000, 0x00000000
.long 0x0000b6c3, 0xb3e0b803, 0x00000000, 0x00000000
.long 0xb7503c01, 0x3709bc00, 0x00000000, 0x00000000
.long 0xb380b80e, 0xb3e03808, 0x00000000, 0x00000000
.long 0xb6c03bfe, 0x0000b7da, 0x00000000, 0x00000000
.long 0x3380b83d, 0x3300b853, 0x00000000, 0x00000000
.long 0x370a3c40, 0xb6083aee, 0x00000000, 0x00000000
.long 0xb45f396e, 0x00000000, 0x3360392d, 0x00000000
.long 0xb7353bfc, 0x3480b921, 0x371cbb84, 0x00000000
.long 0xb3803853, 0xb3803829, 0xb4c4bc00, 0x00000000
.long 0x37f03c00, 0xb748bc80, 0x370fbc00, 0x00000000
.long 0xb44038af, 0x34deb953, 0xb75bbbff, 0x00000000
.long 0x3774bb83, 0xb6c6bbfc, 0x0000b7dd, 0x00000000
.long 0x0000b8b4, 0x00003842, 0x36403afb, 0x00000000
.long 0x00003659, 0x37c7bc40, 0xb78e3c45, 0x00000000
.long 0x342038a6, 0xb280b75d, 0x00000000, 0x00000000
.long 0x371e3bff, 0xb739bc42, 0x00000000, 0x00000000
.long 0xb320b8d0, 0x0000b733, 0x00000000, 0x00000000
.long 0x00003823, 0xb5e0bc03, 0x00000000, 0x00000000
.long 0x0000b5ec, 0x000037c4, 0x00000000, 0x00000000
.long 0x36923b80, 0x0000b8a2, 0x00000000, 0x00000000
.long 0xb3e0b8c9, 0xb300375e, 0x00000000, 0x00000000
.long 0x33a0389c, 0x36603b83, 0x00000000, 0x00000000
.long 0xb240b918, 0xb4e8b95a, 0x34e4b90b, 0x00000000
.long 0xb580bc41, 0x3718bbf5, 0xb740bbbd, 0x00000000
.long 0xb6b83b05, 0x3380387e, 0x000037ab, 0x00000000
.long 0x379ebc7f, 0x3714bbfb, 0xb78bbc01, 0x00000000
.long 0xb440b8fa, 0xb540399b, 0xb200b8d0, 0x00000000
.long 0xb6cc3b7f, 0x34803888, 0xb78abca2, 0x00000000
.long 0x34c0b998, 0xb6a9bbff, 0xb440b8b5, 0x00000000
.long 0xb6debc42, 0x0000b846, 0x00003810, 0x00000000
.long 0x32983769, 0x3320b79e, 0x00000000, 0x00000000
.long 0x3480b986, 0x376cbbfe, 0x00000000, 0x00000000
.long 0xb460388a, 0x00003895, 0x00000000, 0x00000000
.long 0x000037f3, 0xb7423bfc, 0x00000000, 0x00000000
.long 0xb3e0b860, 0x3180390d, 0x00000000, 0x00000000
.long 0x0000b844, 0xb6d2bb80, 0x00000000, 0x00000000
.long 0xb61a3add, 0xb3b03910, 0x00000000, 0x00000000
.long 0xb7e1bcbf, 0x37cabc82, 0x00000000, 0x00000000
L_tab_end:
.size L_cs, L_tab_end-L_cs
.section .rodata,"a"
.p2align 6
.amdhsa_kernel interleave_layers__spectral_fnet__dense_activation_squared_relu__prompt_kernel
  .amdhsa_next_free_vgpr 512
  .amdhsa_next_free_sgpr 102
  .amdhsa_accum_offset 256
  .amdhsa_group_segment_fixed_size 0
  .amdhsa_kernarg_size 104
  .amdhsa_user_sgpr_count 2
  .amdhsa_user_sgpr_kernarg_segment_ptr 1
  .amdhsa_system_sgpr_workgroup_id_x 1
  .amdhsa_float_denorm_mode_32 3
.end_amdhsa_kernel
```
